```python
import torch

def _softmax(x, axis=-1):
    return torch.softmax(x, dim=axis)

def _gelu(x):
    return torch.nn.functional.gelu(x, approximate='tanh')

def _silu(x):
    return torch.nn.functional.silu(x)

def _sigmoid(x):
    return torch.sigmoid(x)

def _layernorm(x, axis=-1, eps=1e-05):
    m = x.mean(dim=axis, keepdim=True)
    v = x.var(dim=axis, keepdim=True, unbiased=False)
    return (x - m) / torch.sqrt(v + eps)

def _scatter_add(tgt, idx, src, axis=0):
    return tgt.clone().index_add_(axis, idx, src)

def _segment_sum(src, seg, n):
    out = torch.zeros((n,) + src.shape[1:], dtype=src.dtype)
    return out.index_add_(0, seg, src)

def _pad(x, pw):
    flat = tuple((v for pair in reversed(pw) for v in pair))
    return torch.nn.functional.pad(x, flat)
kernel_name = 'adaLN_cond__grouped_kv_mqa__mixer_gmlp__prompt'

def setup_inputs():

    _w = lambda a: (lambda t: t.to(torch.bfloat16) if t.is_floating_point() else t)(torch.as_tensor(a))

    def _A_setup():
        B, S, D, H = (1, 2048, 1024, 32)
        Dh = D // H
        return {'x': _w((lambda *s: torch.randn(*s, dtype=torch.bfloat16) * 0.05)(B, S, D)), 'wq': _w((lambda *s: torch.randn(*s, dtype=torch.bfloat16) * 0.05)(D, H * Dh)), 'wk': _w((lambda *s: torch.randn(*s, dtype=torch.bfloat16) * 0.05)(D, Dh)), 'wv': _w((lambda *s: torch.randn(*s, dtype=torch.bfloat16) * 0.05)(D, Dh)), 'wo': _w((lambda *s: torch.randn(*s, dtype=torch.bfloat16) * 0.05)(H * Dh, D))}
    _A_in = _A_setup()

    def _B_setup():
        B, S, D, F = (1, 2048, 1024, 3584)
        Fh = F // 2
        return {'x': _w((lambda *s: torch.randn(*s, dtype=torch.bfloat16) * 0.05)(B, S, D)), 'w_in': _w((lambda *s: torch.randn(*s, dtype=torch.bfloat16) * 0.8)(D, 2 * Fh)), 'w_sp': _w(0.01 * (lambda *s: torch.randn(*s, dtype=torch.bfloat16) * 0.8)(S, S)), 'b_sp': _w(1.0 + 0.01 * (lambda *s: torch.randn(*s, dtype=torch.bfloat16) * 0.05)(S)), 'w_out': _w((lambda *s: torch.randn(*s, dtype=torch.bfloat16) * 0.05)(Fh, D))}
    _B_in = _B_setup()
    return {'A_x': _A_in['x'], 'A_wq': _A_in['wq'], 'A_wk': _A_in['wk'], 'A_wv': _A_in['wv'], 'A_wo': _A_in['wo'], 'B_x': _B_in['x'], 'B_w_in': _B_in['w_in'], 'B_w_sp': _B_in['w_sp'], 'B_b_sp': _B_in['b_sp'], 'B_w_out': _B_in['w_out'], 'c': _w((lambda *s: torch.randn(*s, dtype=torch.bfloat16) * 0.1)(1, 1024) * 8.0), 'w_mod': _w((lambda *s: torch.randn(*s, dtype=torch.bfloat16) * 0.1)(1024, 6 * 1024) * 1024 ** (-0.5) * 8.0)}

def reference(A_x, A_wq, A_wk, A_wv, A_wo, B_x, B_w_in, B_w_sp, B_b_sp, B_w_out, c, w_mod):

    def _A_ref(x, wq, wk, wv, wo):
        B, S, D = x.shape
        H = 32
        Dh = D // H
        q = (lambda x, *d: x.permute(*d))((x @ wq).reshape(B, S, H, Dh), 0, 2, 1, 3)
        k = x @ wk
        v = x @ wv
        scores = torch.einsum('bhqd,bkd->bhqk', q, k) * Dh ** (-0.5)
        p = _softmax(scores, axis=-1)
        o = torch.einsum('bhqk,bkd->bhqd', p, v)
        return (lambda x, *d: x.permute(*d))(o, 0, 2, 1, 3).reshape(B, S, H * Dh) @ wo

    def _B_ref(x, w_in, w_sp, b_sp, w_out):
        B, S, D = x.shape
        F = w_in.shape[-1]
        Fh = F // 2
        z = _gelu(torch.einsum('bsd,df->bsf', x, w_in))
        z1 = z[..., :Fh].clone()
        z2 = _layernorm(z[..., Fh:], axis=-1)
        g = torch.einsum('ts,bsf->btf', w_sp, z2) + b_sp[None, :, None]
        return torch.einsum('bsf,fd->bsd', z1 * g, w_out)
    x = A_x
    mod = (_silu(c) @ w_mod).reshape(c.shape[0], 6, 1, -1)
    sa, ca, ga, sb, cb, gb = (mod[:, 0].clone(), mod[:, 1].clone(), mod[:, 2].clone(), mod[:, 3].clone(), mod[:, 4].clone(), mod[:, 5].clone())
    h = _layernorm(x, axis=-1) * (1 + ca) + sa
    x = x + ga * _A_ref(h, A_wq, A_wk, A_wv, A_wo)
    h = _layernorm(x, axis=-1) * (1 + cb) + sb
    x = x + gb * _B_ref(h, B_w_in, B_w_sp, B_b_sp, B_w_out)
    return x
```

```asm
; @launch grid=(256,1,1) block=(512,1,1) lds=163840
.amdgcn_target "amdgcn-amd-amdhsa--gfx950"
.text
.globl adaLN_cond__grouped_kv_mqa__mixer_gmlp__prompt_kernel
.p2align 8
.type adaLN_cond__grouped_kv_mqa__mixer_gmlp__prompt_kernel,@function
adaLN_cond__grouped_kv_mqa__mixer_gmlp__prompt_kernel:
L_main_entry:
    s_cmp_ge_u32 s2, 256
    s_cbranch_scc1 L_main_exit
    s_load_dwordx16 s[4:19], s[0:1], 0
    s_load_dwordx8 s[20:27], s[0:1], 64
    s_load_dwordx4 s[28:31], s[0:1], 96
    s_load_dwordx2 s[32:33], s[0:1], 112
    v_and_b32 v1, 63, v0
    v_lshrrev_b32 v3, 6, v0
    v_lshlrev_b32 v2, 4, v1
    v_readfirstlane_b32 s3, v3
    s_bfe_u32 s34, s2, 0x20001
    s_lshl_b32 s34, s34, 2
    s_bfe_u32 s52, s2, 0x20003
    s_add_u32 s34, s34, s52
    s_and_b32 s35, s2, 1
    s_lshl_b32 s35, s35, 3
    s_lshr_b32 s52, s2, 5
    s_add_u32 s35, s35, s52
    s_cmp_lt_u32 s3, 4
    s_cbranch_scc1 L_mainc_go
    s_sub_u32 s93, s3, 4
    s_lshl_b32 s74, s93, 13
    s_lshl_b32 s52, s34, 3
    s_lshr_b32 s53, s35, 1
    s_add_u32 s52, s52, s53
    s_lshr_b32 s80, s52, 5
    s_and_b32 s81, s52, 31
    s_lshl_b32 s52, s80, 2
    s_add_u32 s52, s52, s93
    s_mul_i32 s53, s52, 786432
    s_lshl_b32 s54, s81, 7
    s_add_u32 s53, s53, s54
    s_lshl_b32 s52, s52, 7
    s_add_u32 s73, s74, 65536
    v_and_b32 v9, 31, v1
    v_lshlrev_b32 v9, 2, v9
    v_lshrrev_b32 v248, 3, v1
    v_mul_u32_u24 v248, 12288, v248
    v_bfe_u32 v8, v1, 4, 1
    v_lshlrev_b32 v8, 1, v8
    v_xor_b32 v8, v8, v1
    v_and_b32 v8, 7, v8
    v_lshl_add_u32 v248, v8, 4, v248
    v_xor_b32 v8, 64, v248
    v_add_u32 v249, 97280, v8
    v_add_u32 v250, 194560, v248
    v_add_u32 v251, 291840, v8
    s_waitcnt lgkmcnt(0)
    s_mov_b32 s44, s24
    s_mov_b32 s45, s25
    s_mov_b32 s46, 0x800
    s_mov_b32 s47, 0x00020000
    s_mov_b32 s48, s26
    s_mov_b32 s49, s27
    s_mov_b32 s50, 0xc00000
    s_mov_b32 s51, 0x00020000
    buffer_load_dword v14, v9, s[44:47], s52 offen
    s_bitcmp1_b32 s35, 0
    s_cbranch_scc1 L_mainh_mv
    s_mov_b32 m0, s73
    s_add_u32 s75, s53, 393216
    buffer_load_dwordx4 v248, s[48:51], s53 offen offset:0 nt lds
    buffer_load_dwordx4 v249, s[48:51], s53 offen offset:1024 nt lds
    buffer_load_dwordx4 v250, s[48:51], s53 offen offset:2048 nt lds
    buffer_load_dwordx4 v251, s[48:51], s53 offen offset:3072 nt lds
    s_add_u32 s73, s73, 4096
    s_mov_b32 m0, s73
    s_add_u32 s73, s73, 4096
    buffer_load_dwordx4 v248, s[48:51], s75 offen offset:0 nt lds
    buffer_load_dwordx4 v249, s[48:51], s75 offen offset:1024 nt lds
    buffer_load_dwordx4 v250, s[48:51], s75 offen offset:2048 nt lds
    buffer_load_dwordx4 v251, s[48:51], s75 offen offset:3072 nt lds
L_mainh_mv:
    s_mov_b32 s36, s32
    s_mov_b32 s37, s33
    s_mov_b32 s38, 0x2300000
    s_mov_b32 s39, 0x00020000
    s_mov_b32 s40, s30
    s_mov_b32 s41, s31
    s_mov_b32 s42, 0x100
    s_mov_b32 s43, 0x00020000
    s_lshr_b32 s54, s2, 6
    s_lshl_b32 s54, s54, 2
    s_add_u32 s54, s54, s93
    s_lshl_b32 s54, s54, 7
    v_mov_b32 v39, 0
    buffer_load_dword v15, v9, s[44:47], s54 offen
    v_lshlrev_b32 v23, 7, v1
    v_and_b32 v36, 48, v1
    s_add_u32 s52, s74, 65536
    s_getpc_b64 s[94:95]
L_mainh_pc:
    s_lshl_b32 s67, s80, 13
    s_lshl_b32 s53, s81, 8
    s_add_u32 s67, s67, s53
    s_add_u32 s67, s67, 0x8000
    v_lshrrev_b32 v32, 4, v1
    v_lshlrev_b32 v32, 3, v32
    v_bfe_u32 v8, v1, 2, 2
    v_add_u32 v32, v32, v8
    v_lshlrev_b32 v32, 7, v32
    v_bfe_u32 v8, v1, 3, 2
    v_lshl_add_u32 v32, v8, 5, v32
    v_and_b32 v8, 3, v1
    v_lshl_add_u32 v32, v8, 3, v32
    v_add_u32 v32, s52, v32
    v_xor_b32 v33, 32, v32
    v_xor_b32 v34, 64, v32
    v_xor_b32 v35, 96, v32
    s_bitcmp0_b32 s35, 0
    s_cbranch_scc1 L_mainh_nt
    s_and_b32 s52, s34, 3
    s_lshl_b32 s52, s52, 2
    s_bfe_u32 s53, s35, 0x20001
    s_add_u32 s56, s52, s53
    s_lshl_b32 s52, s56, 12
    s_add_u32 s48, s94, L_main_entry-L_mainh_pc
    s_addc_u32 s49, s95, -1
    s_mov_b32 s50, L_main_exit-L_main_entry
    s_mov_b32 s51, 0x00020000
    s_cmp_eq_u32 s93, 0
    s_cselect_b32 s48, s8, s48
    s_cselect_b32 s49, s9, s49
    s_cselect_b32 s50, 0x10000, s50
    s_cmp_eq_u32 s93, 1
    s_cselect_b32 s48, s10, s48
    s_cselect_b32 s49, s11, s49
    s_cselect_b32 s50, 0x10000, s50
    s_cmp_eq_u32 s93, 2
    s_cselect_b32 s50, 0, s50
    v_lshlrev_b32 v8, 6, v1
    buffer_load_dword v252, v8, s[48:51], s52 offen
L_mainh_nt:
    s_bfe_u32 s96, s2, 0x20001
    s_lshl_b32 s96, s96, 2
    s_bfe_u32 s52, s2, 0x20003
    s_add_u32 s96, s96, s52
    s_and_b32 s97, s2, 1
    s_lshl_b32 s97, s97, 3
    s_lshr_b32 s52, s2, 5
    s_add_u32 s97, s97, s52
    s_bfe_u32 s98, s2, 0x10002
    s_lshl_b32 s98, s98, 3
    s_bfe_u32 s52, s2, 0x30003
    s_add_u32 s98, s98, s52
    s_and_b32 s99, s2, 3
    s_lshl_b32 s99, s99, 2
    s_lshr_b32 s52, s2, 6
    s_add_u32 s99, s99, s52
    s_lshr_b32 s52, s99, 1
    s_lshl_b32 s53, s52, 2
    s_mul_i32 s54, s52, 3
    s_add_u32 s54, s54, 32
    s_and_b32 s63, s99, 1
    s_cmp_eq_u32 s63, 0
    s_cselect_b32 s62, 4, 3
    s_cselect_b32 s60, s53, s54
    s_cselect_b32 s61, s54, s53
    s_sub_u32 s61, s61, s62
    s_lshl_b32 s100, s60, 6
    s_add_u32 s100, s100, 3584
    s_lshl_b32 s101, s61, 6
    s_lshl_b32 s92, s62, 2
    v_mov_b32 v12, s100
    v_mov_b32 v13, s101
    v_add_u32 v8, 0, v1
    v_mul_u32_u24 v9, 2341, v8
    v_lshrrev_b32 v9, 16, v9
    v_mul_u32_u24 v10, 28, v9
    v_sub_u32 v10, v8, v10
    v_cmp_gt_u32 vcc, s92, v10
    v_bfe_u32 v11, v9, 2, 1
    v_lshlrev_b32 v11, 1, v11
    v_xor_b32 v10, v10, v11
    v_mul_u32_u24 v9, 7168, v9
    v_lshl_add_u32 v9, v10, 4, v9
    v_cndmask_b32 v10, v13, v12, vcc
    v_add_u32 v9, v9, v10
    v_subrev_u32 v16, 0, v9
    v_add_u32 v8, 64, v1
    v_mul_u32_u24 v9, 2341, v8
    v_lshrrev_b32 v9, 16, v9
    v_mul_u32_u24 v10, 28, v9
    v_sub_u32 v10, v8, v10
    v_cmp_gt_u32 vcc, s92, v10
    v_bfe_u32 v11, v9, 2, 1
    v_lshlrev_b32 v11, 1, v11
    v_xor_b32 v10, v10, v11
    v_mul_u32_u24 v9, 7168, v9
    v_lshl_add_u32 v9, v10, 4, v9
    v_cndmask_b32 v10, v13, v12, vcc
    v_add_u32 v9, v9, v10
    v_subrev_u32 v17, 1024, v9
    v_add_u32 v8, 128, v1
    v_mul_u32_u24 v9, 2341, v8
    v_lshrrev_b32 v9, 16, v9
    v_mul_u32_u24 v10, 28, v9
    v_sub_u32 v10, v8, v10
    v_cmp_gt_u32 vcc, s92, v10
    v_bfe_u32 v11, v9, 2, 1
    v_lshlrev_b32 v11, 1, v11
    v_xor_b32 v10, v10, v11
    v_mul_u32_u24 v9, 7168, v9
    v_lshl_add_u32 v9, v10, 4, v9
    v_cndmask_b32 v10, v13, v12, vcc
    v_add_u32 v9, v9, v10
    v_subrev_u32 v18, 2048, v9
    v_add_u32 v8, 192, v1
    v_mul_u32_u24 v9, 2341, v8
    v_lshrrev_b32 v9, 16, v9
    v_mul_u32_u24 v10, 28, v9
    v_sub_u32 v10, v8, v10
    v_cmp_gt_u32 vcc, s92, v10
    v_bfe_u32 v11, v9, 2, 1
    v_lshlrev_b32 v11, 1, v11
    v_xor_b32 v10, v10, v11
    v_mul_u32_u24 v9, 7168, v9
    v_lshl_add_u32 v9, v10, 4, v9
    v_cndmask_b32 v10, v13, v12, vcc
    v_add_u32 v9, v9, v10
    v_subrev_u32 v19, 3072, v9
    v_add_u32 v8, 256, v1
    v_mul_u32_u24 v9, 2341, v8
    v_lshrrev_b32 v9, 16, v9
    v_mul_u32_u24 v10, 28, v9
    v_sub_u32 v10, v8, v10
    v_cmp_gt_u32 vcc, s92, v10
    v_bfe_u32 v11, v9, 2, 1
    v_lshlrev_b32 v11, 1, v11
    v_xor_b32 v10, v10, v11
    v_mul_u32_u24 v9, 7168, v9
    v_lshl_add_u32 v9, v10, 4, v9
    v_cndmask_b32 v10, v13, v12, vcc
    v_add_u32 v9, v9, v10
    v_subrev_u32 v20, 0, v9
    v_add_u32 v8, 320, v1
    v_mul_u32_u24 v9, 2341, v8
    v_lshrrev_b32 v9, 16, v9
    v_mul_u32_u24 v10, 28, v9
    v_sub_u32 v10, v8, v10
    v_cmp_gt_u32 vcc, s92, v10
    v_bfe_u32 v11, v9, 2, 1
    v_lshlrev_b32 v11, 1, v11
    v_xor_b32 v10, v10, v11
    v_mul_u32_u24 v9, 7168, v9
    v_lshl_add_u32 v9, v10, 4, v9
    v_cndmask_b32 v10, v13, v12, vcc
    v_add_u32 v9, v9, v10
    v_subrev_u32 v21, 1024, v9
    v_add_u32 v8, 384, v1
    v_mul_u32_u24 v9, 2341, v8
    v_lshrrev_b32 v9, 16, v9
    v_mul_u32_u24 v10, 28, v9
    v_sub_u32 v10, v8, v10
    v_cmp_gt_u32 vcc, s92, v10
    v_bfe_u32 v11, v9, 2, 1
    v_lshlrev_b32 v11, 1, v11
    v_xor_b32 v10, v10, v11
    v_mul_u32_u24 v9, 7168, v9
    v_lshl_add_u32 v9, v10, 4, v9
    v_cndmask_b32 v10, v13, v12, vcc
    v_add_u32 v9, v9, v10
    v_subrev_u32 v22, 2048, v9
    v_lshrrev_b32 v28, 3, v1
    v_mul_u32_u24 v28, 7168, v28
    v_bfe_u32 v8, v1, 4, 1
    v_lshlrev_b32 v8, 1, v8
    v_xor_b32 v8, v8, v1
    v_and_b32 v8, 7, v8
    v_lshl_add_u32 v28, v8, 4, v28
    v_xor_b32 v8, 64, v28
    v_add_u32 v29, 56320, v8
    v_add_u32 v30, 112640, v28
    v_add_u32 v31, 168960, v8
    v_lshrrev_b32 v24, 3, v1
    v_lshlrev_b32 v24, 11, v24
    v_lshrrev_b32 v8, 4, v1
    v_xor_b32 v8, v8, v1
    v_and_b32 v8, 7, v8
    v_lshl_add_u32 v24, v8, 4, v24
    v_xor_b32 v8, 64, v24
    v_add_u32 v25, 15360, v8
    v_add_u32 v26, 30720, v24
    v_add_u32 v27, 46080, v8
    v_lshrrev_b32 v4, 3, v1
    v_mul_u32_u24 v4, 2048, v4
    v_bfe_u32 v9, v1, 4, 1
    v_lshlrev_b32 v9, 1, v9
    v_xor_b32 v9, v9, v1
    v_and_b32 v9, 7, v9
    v_lshl_add_u32 v4, v9, 4, v4
    v_xor_b32 v9, 64, v4
    v_add_u32 v5, 15360, v9
    v_add_u32 v6, 30720, v4
    v_add_u32 v7, 46080, v9
    s_bitcmp0_b32 s35, 0
    s_cbranch_scc1 L_mainh_nw
    s_waitcnt vmcnt(0)
    s_barrier
    s_branch L_mainh_mg
L_mainh_nw:
    s_waitcnt vmcnt(9)
    v_lshlrev_b32 v10, 16, v14
    v_and_b32 v11, 0xffff0000, v14
    v_mul_f32 v12, 0xbfb8aa3b, v10
    v_mul_f32 v13, 0xbfb8aa3b, v11
    v_exp_f32 v12, v12
    v_exp_f32 v13, v13
    s_nop 0
    v_add_f32 v12, 1.0, v12
    v_add_f32 v13, 1.0, v13
    v_rcp_f32 v12, v12
    v_rcp_f32 v13, v13
    s_nop 0
    v_mul_f32 v10, v10, v12
    v_mul_f32 v11, v11, v13
    v_cvt_pk_bf16_f32 v10, v10, v11
    ds_bpermute_b32 v96, v36, v10 offset:0
    ds_bpermute_b32 v97, v36, v10 offset:4
    ds_bpermute_b32 v98, v36, v10 offset:8
    ds_bpermute_b32 v99, v36, v10 offset:12
    ds_bpermute_b32 v100, v36, v10 offset:64
    ds_bpermute_b32 v101, v36, v10 offset:68
    ds_bpermute_b32 v102, v36, v10 offset:72
    ds_bpermute_b32 v103, v36, v10 offset:76
    s_waitcnt lgkmcnt(0)
    s_waitcnt vmcnt(1)
    s_cmp_eq_u32 s3, 6
    s_cbranch_scc0 L_mainh_role1
    buffer_load_dword v38, v39, s[40:43], 0 offen sc1
L_mainh_role1:
    s_barrier
    ds_read_b64_tr_b16 v[64:65], v32 offset:0
    ds_read_b64_tr_b16 v[66:67], v32 offset:512
    ds_read_b64_tr_b16 v[68:69], v33 offset:0
    ds_read_b64_tr_b16 v[70:71], v33 offset:512
    ds_read_b64_tr_b16 v[72:73], v34 offset:0
    ds_read_b64_tr_b16 v[74:75], v34 offset:512
    ds_read_b64_tr_b16 v[76:77], v35 offset:0
    ds_read_b64_tr_b16 v[78:79], v35 offset:512
    s_waitcnt lgkmcnt(0)
    ds_read_b64_tr_b16 v[80:81], v32 offset:4096
    ds_read_b64_tr_b16 v[82:83], v32 offset:4608
    ds_read_b64_tr_b16 v[84:85], v33 offset:4096
    ds_read_b64_tr_b16 v[86:87], v33 offset:4608
    ds_read_b64_tr_b16 v[88:89], v34 offset:4096
    ds_read_b64_tr_b16 v[90:91], v34 offset:4608
    ds_read_b64_tr_b16 v[92:93], v35 offset:4096
    ds_read_b64_tr_b16 v[94:95], v35 offset:4608
    v_mfma_f32_16x16x32_bf16 v[48:51], v[96:99], v[64:67], 0
    v_mfma_f32_16x16x32_bf16 v[52:55], v[96:99], v[68:71], 0
    v_mfma_f32_16x16x32_bf16 v[56:59], v[96:99], v[72:75], 0
    v_mfma_f32_16x16x32_bf16 v[60:63], v[96:99], v[76:79], 0
    s_waitcnt lgkmcnt(0)
    v_mfma_f32_16x16x32_bf16 v[48:51], v[100:103], v[80:83], v[48:51]
    v_mfma_f32_16x16x32_bf16 v[52:55], v[100:103], v[84:87], v[52:55]
    v_mfma_f32_16x16x32_bf16 v[56:59], v[100:103], v[88:91], v[56:59]
    v_mfma_f32_16x16x32_bf16 v[60:63], v[100:103], v[92:95], v[60:63]
    s_nop 6
    s_mov_b32 exec_lo, 0xffff0000
    s_mov_b32 exec_hi, 0x0
    v_mov_b32 v48, v52
    v_mov_b32 v49, v53
    s_mov_b32 exec_lo, 0x0
    s_mov_b32 exec_hi, 0xffff
    v_mov_b32 v48, v56
    v_mov_b32 v49, v57
    s_mov_b32 exec_lo, 0x0
    s_mov_b32 exec_hi, 0xffff0000
    v_mov_b32 v48, v60
    v_mov_b32 v49, v61
    s_mov_b64 exec, -1
    s_add_u32 s52, s74, 65536
    v_lshl_add_u32 v8, v1, 2, s52
    ds_write_b32 v8, v48
    s_waitcnt vmcnt(0) lgkmcnt(0)
L_mainh_mg:
    s_barrier
    s_cmp_eq_u32 s3, 6
    s_cbranch_scc0 L_mainh_role2
    s_bitcmp1_b32 s35, 0
    s_cbranch_scc1 L_mainh_mf
    v_lshlrev_b32 v9, 2, v1
    v_add_u32 v8, 65536, v9
    ds_read_b32 v48, v8 offset:0
    ds_read_b32 v49, v8 offset:8192
    ds_read_b32 v50, v8 offset:16384
    ds_read_b32 v51, v8 offset:24576
    s_and_b32 s52, s81, 3
    s_lshl_b32 s52, s52, 7
    s_add_u32 s52, s52, 0x160000
    v_lshlrev_b32 v8, 9, v1
    v_mov_b32 v10, 1
    s_mov_b32 s53, 0x8000
L_mainh_pn:
    s_waitcnt vmcnt(0)
    v_cmp_eq_u32 vcc, 0, v38
    s_sub_u32 s53, s53, 1
    s_cbranch_scc1 L_mainh_pnx
    s_cbranch_vccz L_mainh_pnx
    buffer_load_dword v38, v39, s[40:43], 0 offen sc1
    s_branch L_mainh_pn
L_mainh_pnx:
    s_waitcnt lgkmcnt(0)
    v_add_f32 v48, v48, v49
    v_add_f32 v50, v50, v51
    v_add_f32 v48, v48, v50
    v_and_b32 v48, -2, v48
    buffer_store_dword v48, v9, s[36:39], s67 offen sc1
    s_mov_b32 exec_hi, 0
    buffer_atomic_add v10, v8, s[36:39], s52 offen sc1
    s_mov_b64 exec, -1
L_mainh_mf:
L_mainh_role2:
    s_cmp_eq_u32 s3, 4
    s_cbranch_scc0 L_mainh_role3
    buffer_load_dword v38, v39, s[40:43], 0 offen sc1
L_mainh_role3:
    v_lshlrev_b32 v10, 16, v15
    v_and_b32 v11, 0xffff0000, v15
    v_mul_f32 v12, 0xbfb8aa3b, v10
    v_mul_f32 v13, 0xbfb8aa3b, v11
    v_exp_f32 v12, v12
    v_exp_f32 v13, v13
    s_nop 0
    v_add_f32 v12, 1.0, v12
    v_add_f32 v13, 1.0, v13
    v_rcp_f32 v12, v12
    v_rcp_f32 v13, v13
    s_nop 0
    v_mul_f32 v10, v10, v12
    v_mul_f32 v11, v11, v13
    v_cvt_pk_bf16_f32 v10, v10, v11
    ds_bpermute_b32 v40, v36, v10 offset:0
    ds_bpermute_b32 v41, v36, v10 offset:4
    ds_bpermute_b32 v42, v36, v10 offset:8
    ds_bpermute_b32 v43, v36, v10 offset:12
    ds_bpermute_b32 v44, v36, v10 offset:64
    ds_bpermute_b32 v45, v36, v10 offset:68
    ds_bpermute_b32 v46, v36, v10 offset:72
    ds_bpermute_b32 v47, v36, v10 offset:76
    s_waitcnt lgkmcnt(0)
    s_bitcmp0_b32 s35, 0
    s_cbranch_scc1 L_mainh_nq
    v_lshlrev_b32 v8, 6, v1
    s_mov_b32 s48, s6
    s_mov_b32 s49, s7
    s_mov_b32 s50, 0x200000
    s_mov_b32 s51, 0x00020000
    s_lshl_b32 s52, s80, 5
    s_add_u32 s52, s52, s81
    s_lshl_b32 s52, s52, 14
    s_lshl_b32 s53, s93, 12
    s_add_u32 s52, s52, s53
    buffer_load_dword v252, v8, s[48:51], s52 offen
L_mainh_nq:
    s_bitcmp0_b32 s35, 0
    s_cselect_b32 s58, s8, s10
    s_cselect_b32 s59, s9, s11
    s_mov_b32 s48, s58
    s_mov_b32 s49, s59
    s_mov_b32 s50, 0x10000
    s_mov_b32 s51, 0x00020000
    s_mov_b32 s44, s6
    s_mov_b32 s45, s7
    s_mov_b32 s46, 0x200000
    s_mov_b32 s47, 0x00020000
    v_lshrrev_b32 v3, 5, v1
    v_lshlrev_b32 v3, 5, v3
    v_xor_b32 v3, v3, v2
    s_lshl_b32 s72, s93, 17
    s_lshl_b32 s52, s35, 7
    s_add_u32 s72, s72, s52
    s_lshl_b32 s64, s93, 14
    s_add_u32 s65, s64, 98304
    s_and_b32 s66, s35, 1
    s_lshl_b32 s66, s66, 13
    s_and_b32 s56, s2, 31
    s_lshl_b32 s56, s56, 9
    s_add_u32 s56, s56, 0x160000
    s_mov_b32 m0, s65
    s_xor_b32 s55, s64, s66
    buffer_load_dwordx4 v3, s[48:51], s55 offen offset:0 lds
    buffer_load_dwordx4 v3, s[48:51], s55 offen offset:1024 lds
    buffer_load_dwordx4 v3, s[48:51], s55 offen offset:2048 lds
    buffer_load_dwordx4 v3, s[48:51], s55 offen offset:3072 lds
    s_add_u32 s64, s64, 4096
    s_add_u32 s65, s65, 4096
    s_mov_b32 m0, s65
    s_xor_b32 s55, s64, s66
    buffer_load_dwordx4 v3, s[48:51], s55 offen offset:0 lds
    buffer_load_dwordx4 v3, s[48:51], s55 offen offset:1024 lds
    buffer_load_dwordx4 v3, s[48:51], s55 offen offset:2048 lds
    buffer_load_dwordx4 v3, s[48:51], s55 offen offset:3072 lds
    s_add_u32 s64, s64, 4096
    s_add_u32 s65, s65, 4096
    s_mov_b32 m0, s65
    s_xor_b32 s55, s64, s66
    buffer_load_dwordx4 v3, s[48:51], s55 offen offset:0 lds
    buffer_load_dwordx4 v3, s[48:51], s55 offen offset:1024 lds
    buffer_load_dwordx4 v3, s[48:51], s55 offen offset:2048 lds
    buffer_load_dwordx4 v3, s[48:51], s55 offen offset:3072 lds
    s_add_u32 s64, s64, 4096
    s_add_u32 s65, s65, 4096
    s_mov_b32 m0, s65
    s_xor_b32 s55, s64, s66
    buffer_load_dwordx4 v3, s[48:51], s55 offen offset:0 lds
    buffer_load_dwordx4 v3, s[48:51], s55 offen offset:1024 lds
    buffer_load_dwordx4 v3, s[48:51], s55 offen offset:2048 lds
    buffer_load_dwordx4 v3, s[48:51], s55 offen offset:3072 lds
    s_add_u32 s64, s64, 4096
    s_add_u32 s65, s65, 4096
    s_cmp_eq_u32 s3, 5
    s_cbranch_scc0 L_mainh_role4
    s_lshl_b32 s52, s2, 11
    s_add_u32 s52, s52, 0x80000
    s_mul_i32 s53, s2, 768
    s_add_u32 s53, s53, 0x10000
    s_lshl_b32 s54, s2, 10
    s_add_u32 s54, s54, 0x140000
    s_cmp_lt_u32 s2, 80
    s_cselect_b32 s54, s54, 0x7f000000
    v_mov_b32 v8, -1
    v_mov_b32 v9, -1
    v_mov_b32 v10, -1
    v_mov_b32 v11, -1
    buffer_store_dwordx4 v[8:11], v2, s[36:39], s52 offen sc1
    buffer_store_dwordx4 v[8:11], v2, s[36:39], s52 offen offset:1024 sc1
    buffer_store_dwordx4 v[8:11], v2, s[36:39], s54 offen sc1
    s_mov_b32 exec_hi, 0xffff
    buffer_store_dwordx4 v[8:11], v2, s[36:39], s53 offen sc1
    s_mov_b64 exec, -1
L_mainh_role4:
    v_add_u32 v32, 65536, v32
    v_add_u32 v33, 65536, v33
    v_add_u32 v34, 65536, v34
    v_add_u32 v35, 65536, v35
    s_cmp_eq_u32 s3, 4
    s_cbranch_scc0 L_mainh_role5
    s_mov_b32 s53, 0x8000
L_mainh_pr:
    s_waitcnt vmcnt(0)
    v_cmp_eq_u32 vcc, 0, v38
    s_sub_u32 s53, s53, 1
    s_cbranch_scc1 L_mainh_prx
    s_cbranch_vccz L_mainh_prx
    buffer_load_dword v38, v39, s[40:43], 0 offen sc1
    s_branch L_mainh_pr
L_mainh_prx:
    s_mov_b64 exec, 15
    s_mov_b32 s53, 0x8000
L_mainh_pf:
    v_mov_b32 v10, 0
    buffer_atomic_add v10, v23, s[36:39], s56 offen sc0 sc1
    s_waitcnt vmcnt(0)
L_mainh_pfc:
    v_cmp_ne_u32 vcc, 32, v10
    s_sub_u32 s53, s53, 1
    s_cbranch_scc1 L_mainh_pfx
    s_cbranch_vccnz L_mainh_pf
L_mainh_pfx:
    s_mov_b64 exec, -1
L_mainh_role5:
    s_barrier
    s_barrier
    s_add_u32 s73, s74, 32768
    s_mov_b32 m0, s73
    s_add_u32 s75, s72, 65536
    buffer_load_dwordx4 v4, s[44:47], s72 offen offset:0  lds
    buffer_load_dwordx4 v5, s[44:47], s72 offen offset:1024  lds
    buffer_load_dwordx4 v6, s[44:47], s72 offen offset:2048  lds
    buffer_load_dwordx4 v7, s[44:47], s72 offen offset:3072  lds
    s_add_u32 s73, s73, 4096
    s_mov_b32 m0, s73
    s_add_u32 s73, s73, 4096
    buffer_load_dwordx4 v4, s[44:47], s75 offen offset:0  lds
    buffer_load_dwordx4 v5, s[44:47], s75 offen offset:1024  lds
    buffer_load_dwordx4 v6, s[44:47], s75 offen offset:2048  lds
    buffer_load_dwordx4 v7, s[44:47], s75 offen offset:3072  lds
    s_add_u32 s72, s72, 0x80000
    s_waitcnt vmcnt(8)
    s_barrier
    s_add_u32 s73, s74, 65536
    s_mov_b32 m0, s73
    s_add_u32 s75, s72, 65536
    buffer_load_dwordx4 v4, s[44:47], s72 offen offset:0  lds
    buffer_load_dwordx4 v5, s[44:47], s72 offen offset:1024  lds
    buffer_load_dwordx4 v6, s[44:47], s72 offen offset:2048  lds
    buffer_load_dwordx4 v7, s[44:47], s72 offen offset:3072  lds
    s_add_u32 s73, s73, 4096
    s_mov_b32 m0, s73
    s_add_u32 s73, s73, 4096
    buffer_load_dwordx4 v4, s[44:47], s75 offen offset:0  lds
    buffer_load_dwordx4 v5, s[44:47], s75 offen offset:1024  lds
    buffer_load_dwordx4 v6, s[44:47], s75 offen offset:2048  lds
    buffer_load_dwordx4 v7, s[44:47], s75 offen offset:3072  lds
    s_add_u32 s72, s72, 0x80000
    s_barrier
    s_cmp_eq_u32 s3, 5
    s_cbranch_scc0 L_mainh_role6
    s_lshl_b32 s54, s34, 3
    s_lshr_b32 s55, s35, 1
    s_add_u32 s54, s54, s55
    s_and_b32 s55, s35, 1
    s_and_b32 s53, s54, 1
    v_and_b32 v3, 15, v1
    v_lshrrev_b32 v10, 4, v1
    ds_read_b128 v[48:51], v2 offset:0
    ds_read_b128 v[52:55], v2 offset:1024
    ds_read_b128 v[56:59], v2 offset:8192
    ds_read_b128 v[60:63], v2 offset:9216
    ds_read_b128 v[64:67], v2 offset:16384
    ds_read_b128 v[68:71], v2 offset:17408
    ds_read_b128 v[72:75], v2 offset:24576
    ds_read_b128 v[76:79], v2 offset:25600
    s_lshr_b32 s52, s54, 1
    s_lshl_b32 s60, s55, 1
    s_add_u32 s52, s52, s60
    s_add_u32 s52, s52, 62
    s_and_b32 s52, s52, 63
    s_lshl_b32 s52, s52, 12
    s_lshl_b32 s60, s55, 11
    s_add_u32 s52, s52, s60
    s_cmp_eq_u32 s55, 0
    s_cselect_b32 s60, 8, 10
    s_cselect_b32 s61, 10, 8
    s_cselect_b32 s62, 0x3e8293ee, 1.0
    s_lshl_b32 s60, s53, s60
    s_add_u32 s52, s52, s60
    s_add_u32 s52, s52, 0x100000
    s_lshl_b32 s61, 1, s61
    s_add_u32 s61, s61, s52
    v_lshrrev_b32 v11, 5, v1
    v_lshlrev_b32 v11, 9, v11
    v_lshl_add_u32 v11, v3, 4, v11
    v_and_b32 v12, 1, v10
    v_lshl_add_u32 v11, v12, 3, v11
    v_mov_b32 v12, s62
    s_waitcnt lgkmcnt(0)
    v_pk_add_f32 v[48:49], v[48:49], v[56:57]
    v_pk_add_f32 v[50:51], v[50:51], v[58:59]
    v_pk_add_f32 v[52:53], v[52:53], v[60:61]
    v_pk_add_f32 v[54:55], v[54:55], v[62:63]
    v_pk_add_f32 v[64:65], v[64:65], v[72:73]
    v_pk_add_f32 v[66:67], v[66:67], v[74:75]
    v_pk_add_f32 v[68:69], v[68:69], v[76:77]
    v_pk_add_f32 v[70:71], v[70:71], v[78:79]
    v_pk_add_f32 v[48:49], v[48:49], v[64:65]
    v_pk_add_f32 v[50:51], v[50:51], v[66:67]
    v_pk_add_f32 v[52:53], v[52:53], v[68:69]
    v_pk_add_f32 v[54:55], v[54:55], v[70:71]
    v_pk_mul_f32 v[48:49], v[48:49], v[12:13] op_sel_hi:[1,0]
    v_pk_mul_f32 v[50:51], v[50:51], v[12:13] op_sel_hi:[1,0]
    v_pk_mul_f32 v[52:53], v[52:53], v[12:13] op_sel_hi:[1,0]
    v_pk_mul_f32 v[54:55], v[54:55], v[12:13] op_sel_hi:[1,0]
    v_cvt_pk_bf16_f32 v56, v48, v49
    v_cvt_pk_bf16_f32 v57, v50, v51
    v_cvt_pk_bf16_f32 v58, v52, v53
    v_cvt_pk_bf16_f32 v59, v54, v55
    buffer_store_dwordx2 v[56:57], v11, s[36:39], s52 offen sc1
    buffer_store_dwordx2 v[58:59], v11, s[36:39], s61 offen sc1
    v_pk_mul_f32 v[12:13], v[48:49], v[48:49]
    v_pk_fma_f32 v[12:13], v[50:51], v[50:51], v[12:13]
    v_pk_fma_f32 v[12:13], v[52:53], v[52:53], v[12:13]
    v_pk_fma_f32 v[12:13], v[54:55], v[54:55], v[12:13]
    v_add_f32 v12, v12, v13
    v_mov_b32 v13, v12
    s_nop 1
    v_permlane16_swap_b32 v13, v12
    s_nop 0
    v_add_f32 v12, v12, v13
    v_mov_b32 v13, v12
    s_nop 1
    v_permlane32_swap_b32 v13, v12
    s_nop 0
    v_add_f32 v12, v12, v13
    s_nop 1
    v_max_f32_dpp v12, v12, v12 quad_perm:[1,0,3,2] row_mask:0xf bank_mask:0xf
    s_nop 1
    v_max_f32_dpp v12, v12, v12 quad_perm:[2,3,0,1] row_mask:0xf bank_mask:0xf
    s_nop 1
    v_max_f32_dpp v12, v12, v12 row_half_mirror row_mask:0xf bank_mask:0xf
    s_nop 1
    v_max_f32_dpp v12, v12, v12 row_mirror row_mask:0xf bank_mask:0xf
    v_and_b32 v12, -2, v12
    v_mov_b32 v15, v12
L_mainh_role6:
    s_add_u32 s73, s74, 98304
    s_mov_b32 m0, s73
    s_add_u32 s75, s72, 65536
    buffer_load_dwordx4 v4, s[44:47], s72 offen offset:0  lds
    buffer_load_dwordx4 v5, s[44:47], s72 offen offset:1024  lds
    buffer_load_dwordx4 v6, s[44:47], s72 offen offset:2048  lds
    buffer_load_dwordx4 v7, s[44:47], s72 offen offset:3072  lds
    s_add_u32 s73, s73, 4096
    s_mov_b32 m0, s73
    s_add_u32 s73, s73, 4096
    buffer_load_dwordx4 v4, s[44:47], s75 offen offset:0  lds
    buffer_load_dwordx4 v5, s[44:47], s75 offen offset:1024  lds
    buffer_load_dwordx4 v6, s[44:47], s75 offen offset:2048  lds
    buffer_load_dwordx4 v7, s[44:47], s75 offen offset:3072  lds
    s_add_u32 s72, s72, 0x80000
    s_add_u32 s73, s74, 131072
    s_mov_b32 m0, s73
    s_add_u32 s75, s72, 65536
    buffer_load_dwordx4 v4, s[44:47], s72 offen offset:0  lds
    buffer_load_dwordx4 v5, s[44:47], s72 offen offset:1024  lds
    buffer_load_dwordx4 v6, s[44:47], s72 offen offset:2048  lds
    buffer_load_dwordx4 v7, s[44:47], s72 offen offset:3072  lds
    s_add_u32 s73, s73, 4096
    s_mov_b32 m0, s73
    s_add_u32 s73, s73, 4096
    buffer_load_dwordx4 v4, s[44:47], s75 offen offset:0  lds
    buffer_load_dwordx4 v5, s[44:47], s75 offen offset:1024  lds
    buffer_load_dwordx4 v6, s[44:47], s75 offen offset:2048  lds
    buffer_load_dwordx4 v7, s[44:47], s75 offen offset:3072  lds
    s_add_u32 s72, s72, 0x80000
    s_cmp_eq_u32 s3, 4
    s_cbranch_scc0 L_mainh_role7
    s_lshl_b32 s52, s34, 9
    s_add_u32 s52, s52, 0x154000
    v_lshlrev_b32 v14, 7, v1
    s_mov_b64 exec, 15
    s_mov_b32 s53, 0x8000
L_mainh_ph:
    v_mov_b32 v13, 0
    buffer_atomic_add v13, v14, s[36:39], s52 offen sc0 sc1
    s_waitcnt vmcnt(0)
L_mainh_phc:
    v_cmp_ne_u32 vcc, 15, v13
    s_sub_u32 s53, s53, 1
    s_cbranch_scc1 L_mainh_phx
    s_cbranch_vccnz L_mainh_ph
L_mainh_phx:
    s_mov_b64 exec, -1
L_mainh_role7:
    s_cmp_eq_u32 s3, 5
    s_cbranch_scc0 L_mainh_role8
    s_lshl_b32 s52, s34, 4
    s_add_u32 s52, s52, s35
    s_lshl_b32 s52, s52, 2
    s_add_u32 s52, s52, 0x156000
    s_waitcnt vmcnt(0)
    s_mov_b64 exec, 1
    buffer_store_dword v15, v2, s[36:39], s52 offen sc1
    s_mov_b64 exec, -1
L_mainh_role8:
    s_waitcnt vmcnt(24)
    s_barrier
    s_waitcnt vmcnt(16)
    s_mov_b32 s34, s98
    s_mov_b32 s35, s99
    s_waitcnt lgkmcnt(0)
    s_barrier
    s_waitcnt vmcnt(0)
    s_barrier
    s_cmp_eq_u32 s3, 5
    s_cbranch_scc0 L_mainh_role9
    s_mov_b32 s54, 0x156000
    s_mov_b32 s53, 0x8000
L_mainh_pk:
    buffer_load_dwordx4 v[8:11], v2, s[36:39], s54 offen sc1
    s_waitcnt vmcnt(0)
L_mainh_pkc:
    v_or_b32 v12, v8, v9
    v_or3_b32 v12, v12, v10, v11
    v_and_b32 v12, 1, v12
    v_cmp_ne_u32 vcc, 0, v12
    s_sub_u32 s53, s53, 1
    s_cbranch_scc1 L_mainh_pkx
    s_cbranch_vccnz L_mainh_pk
L_mainh_pkx:
    s_mov_b64 exec, -1
    s_cmp_eq_u32 s2, 0
    s_cselect_b32 s42, s42, 0
    v_mov_b32 v8, 0
    buffer_store_dword v8, v39, s[40:43], 0 offen sc1
L_mainh_role9:
    s_add_u32 s40, s32, 0x100000
    s_addc_u32 s41, s33, 0
    s_mov_b32 s42, 0x40000
    s_mov_b32 s43, 0x00020000
    s_mov_b32 s78, s74
    s_barrier
    s_and_b32 s79, s78, 0x1ffff
    s_mov_b32 m0, s79
    s_add_u32 s75, s78, 4096
    buffer_load_dwordx4 v2, s[40:43], s78 offen offset:0 sc1 lds
    buffer_load_dwordx4 v2, s[40:43], s78 offen offset:1024 sc1 lds
    buffer_load_dwordx4 v2, s[40:43], s78 offen offset:2048 sc1 lds
    buffer_load_dwordx4 v2, s[40:43], s78 offen offset:3072 sc1 lds
    s_add_u32 s79, s79, 4096
    s_mov_b32 m0, s79
    s_add_u32 s78, s78, 0x8000
    buffer_load_dwordx4 v2, s[40:43], s75 offen offset:0 sc1 lds
    buffer_load_dwordx4 v2, s[40:43], s75 offen offset:1024 sc1 lds
    buffer_load_dwordx4 v2, s[40:43], s75 offen offset:2048 sc1 lds
    buffer_load_dwordx4 v2, s[40:43], s75 offen offset:3072 sc1 lds
    v_lshrrev_b32 v4, 3, v1
    v_mul_u32_u24 v4, 2048, v4
    v_bfe_u32 v8, v1, 4, 2
    v_lshlrev_b32 v8, 1, v8
    v_xor_b32 v8, v8, v1
    v_and_b32 v8, 7, v8
    v_lshl_add_u32 v4, v8, 4, v4
    v_xor_b32 v8, 0, v4
    v_add_u32 v5, 15360, v8
    v_add_u32 v6, 30720, v4
    v_add_u32 v7, 46080, v8
    s_add_u32 s52, s74, 65536
    v_add_u32 v37, s52, v2
    s_lshl_b32 s77, s2, 15
    s_add_u32 s77, s77, s74
    s_lshr_b32 s80, s2, 6
    s_and_b32 s81, s2, 63
    s_mul_i32 s82, s2, 1171
    s_lshr_b32 s82, s82, 16
    s_mul_i32 s83, s82, 56
    s_sub_u32 s83, s2, s83
    s_and_b32 s82, s82, 3
    s_lshl_b32 s52, s82, 2
    s_add_u32 s52, s52, s93
    s_lshl_b32 s52, s52, 8
    s_add_u32 s52, s52, 8192
    s_lshl_b32 s53, s93, 12
    s_lshl_b32 s54, s97, 8
    s_add_u32 s53, s53, s54
    v_cmp_gt_u32 vcc, 32, v1
    v_lshlrev_b32 v9, 8, v36
    v_sub_u32 v9, s52, v9
    v_mov_b32 v10, s53
    v_cndmask_b32 v9, v10, v9, vcc
    v_and_b32 v10, 255, v2
    v_add_u32 v9, v9, v10
    s_cmp_eq_u32 s93, 2
    s_cselect_b32 s52, 1.0, 0
    v_mov_b32 v11, s52
    v_cndmask_b32 v38, v11, 0, vcc
    v_cmp_gt_u32 vcc, 16, v1
    s_add_u32 s53, s74, 135168
    v_add_u32 v39, s53, v10
    v_cndmask_b32 v38, v38, 1.0, vcc
    v_lshlrev_b32 v3, 2, v1
    s_add_u32 s52, s74, 138752
    v_add_u32 v10, s52, v3
    v_add_u32 v11, 138752, v3
    v_and_b32 v12, 1, v1
    v_lshlrev_b32 v12, 6, v12
    v_lshrrev_b32 v8, 1, v36
    v_add_u32 v12, v12, v8
    s_setprio 3
    s_waitcnt vmcnt(0)
    s_barrier
    s_and_b32 s79, s78, 0x1ffff
    s_mov_b32 m0, s79
    s_add_u32 s75, s78, 4096
    buffer_load_dwordx4 v2, s[40:43], s78 offen offset:0 sc1 lds
    buffer_load_dwordx4 v2, s[40:43], s78 offen offset:1024 sc1 lds
    buffer_load_dwordx4 v2, s[40:43], s78 offen offset:2048 sc1 lds
    buffer_load_dwordx4 v2, s[40:43], s78 offen offset:3072 sc1 lds
    s_add_u32 s79, s79, 4096
    s_mov_b32 m0, s79
    s_add_u32 s78, s78, 0x8000
    buffer_load_dwordx4 v2, s[40:43], s75 offen offset:0 sc1 lds
    buffer_load_dwordx4 v2, s[40:43], s75 offen offset:1024 sc1 lds
    buffer_load_dwordx4 v2, s[40:43], s75 offen offset:2048 sc1 lds
    buffer_load_dwordx4 v2, s[40:43], s75 offen offset:3072 sc1 lds
    s_and_b32 s79, s78, 0x1ffff
    s_mov_b32 m0, s79
    s_add_u32 s75, s78, 4096
    buffer_load_dwordx4 v2, s[40:43], s78 offen offset:0 sc1 lds
    buffer_load_dwordx4 v2, s[40:43], s78 offen offset:1024 sc1 lds
    buffer_load_dwordx4 v2, s[40:43], s78 offen offset:2048 sc1 lds
    buffer_load_dwordx4 v2, s[40:43], s78 offen offset:3072 sc1 lds
    s_add_u32 s79, s79, 4096
    s_mov_b32 m0, s79
    s_add_u32 s78, s78, 0x8000
    buffer_load_dwordx4 v2, s[40:43], s75 offen offset:0 sc1 lds
    buffer_load_dwordx4 v2, s[40:43], s75 offen offset:1024 sc1 lds
    buffer_load_dwordx4 v2, s[40:43], s75 offen offset:2048 sc1 lds
    buffer_load_dwordx4 v2, s[40:43], s75 offen offset:3072 sc1 lds
    s_waitcnt vmcnt(8)
    s_barrier
    s_and_b32 s79, s78, 0x1ffff
    s_mov_b32 m0, s79
    s_add_u32 s75, s78, 4096
    buffer_load_dwordx4 v2, s[40:43], s78 offen offset:0 sc1 lds
    buffer_load_dwordx4 v2, s[40:43], s78 offen offset:1024 sc1 lds
    buffer_load_dwordx4 v2, s[40:43], s78 offen offset:2048 sc1 lds
    buffer_load_dwordx4 v2, s[40:43], s78 offen offset:3072 sc1 lds
    s_add_u32 s79, s79, 4096
    s_mov_b32 m0, s79
    s_add_u32 s78, s78, 0x8000
    buffer_load_dwordx4 v2, s[40:43], s75 offen offset:0 sc1 lds
    buffer_load_dwordx4 v2, s[40:43], s75 offen offset:1024 sc1 lds
    buffer_load_dwordx4 v2, s[40:43], s75 offen offset:2048 sc1 lds
    buffer_load_dwordx4 v2, s[40:43], s75 offen offset:3072 sc1 lds
    s_mov_b32 s48, s26
    s_mov_b32 s49, s27
    s_mov_b32 s50, 0xc00000
    s_mov_b32 s51, 0x00020000
    s_lshl_b32 s52, s80, 2
    s_add_u32 s52, s52, s93
    s_mul_i32 s53, s52, 786432
    s_lshl_b32 s54, s81, 7
    s_add_u32 s53, s53, s54
    s_add_u32 s53, s53, 4096
    s_add_u32 s73, s74, 131072
    s_mov_b32 m0, s73
    s_add_u32 s75, s53, 393216
    buffer_load_dwordx4 v248, s[48:51], s53 offen offset:0 nt lds
    buffer_load_dwordx4 v249, s[48:51], s53 offen offset:1024 nt lds
    buffer_load_dwordx4 v250, s[48:51], s53 offen offset:2048 nt lds
    buffer_load_dwordx4 v251, s[48:51], s53 offen offset:3072 nt lds
    s_add_u32 s73, s73, 4096
    s_mov_b32 m0, s73
    s_add_u32 s73, s73, 4096
    buffer_load_dwordx4 v248, s[48:51], s75 offen offset:0 nt lds
    buffer_load_dwordx4 v249, s[48:51], s75 offen offset:1024 nt lds
    buffer_load_dwordx4 v250, s[48:51], s75 offen offset:2048 nt lds
    buffer_load_dwordx4 v251, s[48:51], s75 offen offset:3072 nt lds
    s_mov_b32 s48, s18
    s_mov_b32 s49, s19
    s_mov_b32 s50, 0x800000
    s_mov_b32 s51, 0x00020000
    buffer_load_dword v252, v23, s[48:51], s77 offen
    s_waitcnt vmcnt(17)
    s_barrier
    s_and_b32 s79, s78, 0x1ffff
    s_mov_b32 m0, s79
    s_add_u32 s75, s78, 4096
    buffer_load_dwordx4 v2, s[40:43], s78 offen offset:0 sc1 lds
    buffer_load_dwordx4 v2, s[40:43], s78 offen offset:1024 sc1 lds
    buffer_load_dwordx4 v2, s[40:43], s78 offen offset:2048 sc1 lds
    buffer_load_dwordx4 v2, s[40:43], s78 offen offset:3072 sc1 lds
    s_add_u32 s79, s79, 4096
    s_mov_b32 m0, s79
    s_add_u32 s78, s78, 0x8000
    buffer_load_dwordx4 v2, s[40:43], s75 offen offset:0 sc1 lds
    buffer_load_dwordx4 v2, s[40:43], s75 offen offset:1024 sc1 lds
    buffer_load_dwordx4 v2, s[40:43], s75 offen offset:2048 sc1 lds
    buffer_load_dwordx4 v2, s[40:43], s75 offen offset:3072 sc1 lds
    s_mov_b32 s48, s22
    s_mov_b32 s49, s23
    s_mov_b32 s50, 0x380000
    s_mov_b32 s51, 0x00020000
    buffer_load_dword v252, v23, s[48:51], s77 offen
    s_mov_b32 s48, s16
    s_mov_b32 s49, s17
    s_mov_b32 s50, 0x700000
    s_mov_b32 s51, 0x00020000
    buffer_load_dword v252, v23, s[48:51], s77 offen
    s_waitcnt vmcnt(11)
    ds_read_b64_tr_b16 v[128:129], v32 offset:0
    ds_read_b64_tr_b16 v[130:131], v32 offset:512
    ds_read_b64_tr_b16 v[132:133], v33 offset:0
    ds_read_b64_tr_b16 v[134:135], v33 offset:512
    ds_read_b64_tr_b16 v[136:137], v34 offset:0
    ds_read_b64_tr_b16 v[138:139], v34 offset:512
    ds_read_b64_tr_b16 v[140:141], v35 offset:0
    ds_read_b64_tr_b16 v[142:143], v35 offset:512
    s_waitcnt lgkmcnt(0)
    ds_read_b64_tr_b16 v[144:145], v32 offset:4096
    ds_read_b64_tr_b16 v[146:147], v32 offset:4608
    ds_read_b64_tr_b16 v[148:149], v33 offset:4096
    ds_read_b64_tr_b16 v[150:151], v33 offset:4608
    ds_read_b64_tr_b16 v[152:153], v34 offset:4096
    ds_read_b64_tr_b16 v[154:155], v34 offset:4608
    ds_read_b64_tr_b16 v[156:157], v35 offset:4096
    ds_read_b64_tr_b16 v[158:159], v35 offset:4608
    v_mfma_f32_16x16x32_bf16 v[112:115], v[40:43], v[128:131], 0
    v_mfma_f32_16x16x32_bf16 v[116:119], v[40:43], v[132:135], 0
    v_mfma_f32_16x16x32_bf16 v[120:123], v[40:43], v[136:139], 0
    v_mfma_f32_16x16x32_bf16 v[124:127], v[40:43], v[140:143], 0
    s_waitcnt lgkmcnt(0)
    v_mfma_f32_16x16x32_bf16 v[112:115], v[44:47], v[144:147], v[112:115]
    v_mfma_f32_16x16x32_bf16 v[116:119], v[44:47], v[148:151], v[116:119]
    v_mfma_f32_16x16x32_bf16 v[120:123], v[44:47], v[152:155], v[120:123]
    v_mfma_f32_16x16x32_bf16 v[124:127], v[44:47], v[156:159], v[124:127]
    s_nop 6
    s_mov_b32 exec_lo, 0xffff0000
    s_mov_b32 exec_hi, 0x0
    v_mov_b32 v112, v116
    v_mov_b32 v113, v117
    s_mov_b32 exec_lo, 0x0
    s_mov_b32 exec_hi, 0xffff
    v_mov_b32 v112, v120
    v_mov_b32 v113, v121
    s_mov_b32 exec_lo, 0x0
    s_mov_b32 exec_hi, 0xffff0000
    v_mov_b32 v112, v124
    v_mov_b32 v113, v125
    s_mov_b64 exec, -1
    ds_write_b32 v10, v112
    s_waitcnt lgkmcnt(0)
    s_waitcnt vmcnt(19)
    s_barrier
    s_cmp_eq_u32 s3, 5
    s_cbranch_scc0 L_mainh_role10
    ds_read_b32 v112, v11 offset:0
    ds_read_b32 v113, v11 offset:8192
    ds_read_b32 v114, v11 offset:16384
    ds_read_b32 v115, v11 offset:24576
    s_lshl_b32 s52, s80, 14
    s_lshl_b32 s53, s81, 8
    s_add_u32 s52, s52, s53
    s_add_u32 s52, s52, 0x10000
    s_waitcnt lgkmcnt(0)
    v_add_f32 v112, v112, v113
    v_add_f32 v114, v114, v115
    v_add_f32 v112, v112, v114
    v_and_b32 v112, -2, v112
    buffer_store_dword v112, v3, s[36:39], s52 offen sc1
L_mainh_role10:
    s_and_b32 s79, s78, 0x1ffff
    s_mov_b32 m0, s79
    s_add_u32 s75, s78, 4096
    buffer_load_dwordx4 v2, s[40:43], s78 offen offset:0 sc1 lds
    buffer_load_dwordx4 v2, s[40:43], s78 offen offset:1024 sc1 lds
    buffer_load_dwordx4 v2, s[40:43], s78 offen offset:2048 sc1 lds
    buffer_load_dwordx4 v2, s[40:43], s78 offen offset:3072 sc1 lds
    s_add_u32 s79, s79, 4096
    s_mov_b32 m0, s79
    s_add_u32 s78, s78, 0x8000
    buffer_load_dwordx4 v2, s[40:43], s75 offen offset:0 sc1 lds
    buffer_load_dwordx4 v2, s[40:43], s75 offen offset:1024 sc1 lds
    buffer_load_dwordx4 v2, s[40:43], s75 offen offset:2048 sc1 lds
    buffer_load_dwordx4 v2, s[40:43], s75 offen offset:3072 sc1 lds
    s_mov_b32 s44, s12
    s_mov_b32 s45, s13
    s_mov_b32 s46, 0x200000
    s_mov_b32 s47, 0x00020000
    s_lshl_b32 s72, s93, 18
    s_lshl_b32 s52, s97, 7
    s_add_u32 s72, s72, s52
    s_add_u32 s53, s72, 0x10000
    s_add_u32 s75, s53, 131072
    buffer_load_dwordx4 v[48:51], v4, s[44:47], s53 offen offset:0
    buffer_load_dwordx4 v[52:55], v5, s[44:47], s53 offen offset:1024
    buffer_load_dwordx4 v[56:59], v6, s[44:47], s53 offen offset:2048
    buffer_load_dwordx4 v[60:63], v7, s[44:47], s53 offen offset:3072
    buffer_load_dwordx4 v[64:67], v4, s[44:47], s75 offen offset:0
    buffer_load_dwordx4 v[68:71], v5, s[44:47], s75 offen offset:1024
    buffer_load_dwordx4 v[72:75], v6, s[44:47], s75 offen offset:2048
    buffer_load_dwordx4 v[76:79], v7, s[44:47], s75 offen offset:3072
    s_add_u32 s53, s53, 0x100000
    s_add_u32 s75, s53, 131072
    buffer_load_dwordx4 v[80:83], v4, s[44:47], s53 offen offset:0
    buffer_load_dwordx4 v[84:87], v5, s[44:47], s53 offen offset:1024
    buffer_load_dwordx4 v[88:91], v6, s[44:47], s53 offen offset:2048
    buffer_load_dwordx4 v[92:95], v7, s[44:47], s53 offen offset:3072
    buffer_load_dwordx4 v[96:99], v4, s[44:47], s75 offen offset:0
    buffer_load_dwordx4 v[100:103], v5, s[44:47], s75 offen offset:1024
    buffer_load_dwordx4 v[104:107], v6, s[44:47], s75 offen offset:2048
    buffer_load_dwordx4 v[108:111], v7, s[44:47], s75 offen offset:3072
    s_waitcnt vmcnt(26)
    s_barrier
    s_and_b32 s79, s78, 0x1ffff
    s_mov_b32 m0, s79
    s_add_u32 s75, s78, 4096
    buffer_load_dwordx4 v2, s[40:43], s78 offen offset:0 sc1 lds
    buffer_load_dwordx4 v2, s[40:43], s78 offen offset:1024 sc1 lds
    buffer_load_dwordx4 v2, s[40:43], s78 offen offset:2048 sc1 lds
    buffer_load_dwordx4 v2, s[40:43], s78 offen offset:3072 sc1 lds
    s_add_u32 s79, s79, 4096
    s_mov_b32 m0, s79
    s_add_u32 s78, s78, 0x8000
    buffer_load_dwordx4 v2, s[40:43], s75 offen offset:0 sc1 lds
    buffer_load_dwordx4 v2, s[40:43], s75 offen offset:1024 sc1 lds
    buffer_load_dwordx4 v2, s[40:43], s75 offen offset:2048 sc1 lds
    buffer_load_dwordx4 v2, s[40:43], s75 offen offset:3072 sc1 lds
    s_add_u32 s48, s94, L_mainc_tail-L_mainh_pc
    s_addc_u32 s49, s95, 0
    s_mov_b32 s50, L_main_exit-L_mainc_tail
    s_mov_b32 s51, 0x00020000
    s_lshl_b32 s52, s93, 13
    buffer_load_dword v252, v23, s[48:51], s52 offen
    s_mov_b32 s48, s16
    s_mov_b32 s49, s17
    s_mov_b32 s50, 0x700000
    s_mov_b32 s51, 0x00020000
    s_lshl_b32 s52, s82, 2
    s_add_u32 s52, s52, s93
    s_mul_i32 s53, s52, 458752
    s_lshl_b32 s54, s83, 7
    s_add_u32 s53, s53, s54
    s_add_u32 s73, s74, 131072
    s_mov_b32 m0, s73
    s_add_u32 s75, s53, 229376
    buffer_load_dwordx4 v28, s[48:51], s53 offen offset:0  lds
    buffer_load_dwordx4 v29, s[48:51], s53 offen offset:1024  lds
    buffer_load_dwordx4 v30, s[48:51], s53 offen offset:2048  lds
    buffer_load_dwordx4 v31, s[48:51], s53 offen offset:3072  lds
    s_add_u32 s73, s73, 4096
    s_mov_b32 m0, s73
    s_add_u32 s73, s73, 4096
    buffer_load_dwordx4 v28, s[48:51], s75 offen offset:0  lds
    buffer_load_dwordx4 v29, s[48:51], s75 offen offset:1024  lds
    buffer_load_dwordx4 v30, s[48:51], s75 offen offset:2048  lds
    buffer_load_dwordx4 v31, s[48:51], s75 offen offset:3072  lds
    s_mul_i32 s53, s93, 114688
    s_waitcnt vmcnt(32)
    buffer_load_dwordx4 v[160:163], v16, s[48:51], s53 offen offset:0
    buffer_load_dwordx4 v[164:167], v17, s[48:51], s53 offen offset:1024
    buffer_load_dwordx4 v[168:171], v18, s[48:51], s53 offen offset:2048
    buffer_load_dwordx4 v[172:175], v19, s[48:51], s53 offen offset:3072
    buffer_load_dwordx4 v[176:179], v20, s[48:51], s53 offen offset:0
    buffer_load_dwordx4 v[180:183], v21, s[48:51], s53 offen offset:1024
    buffer_load_dwordx4 v[184:187], v22, s[48:51], s53 offen offset:2048
    s_add_u32 s53, s53, 458752
    buffer_load_dwordx4 v[188:191], v16, s[48:51], s53 offen offset:0
    buffer_load_dwordx4 v[192:195], v17, s[48:51], s53 offen offset:1024
    buffer_load_dwordx4 v[196:199], v18, s[48:51], s53 offen offset:2048
    buffer_load_dwordx4 v[200:203], v19, s[48:51], s53 offen offset:3072
    buffer_load_dwordx4 v[204:207], v20, s[48:51], s53 offen offset:0
    buffer_load_dwordx4 v[208:211], v21, s[48:51], s53 offen offset:1024
    buffer_load_dwordx4 v[212:215], v22, s[48:51], s53 offen offset:2048
    s_add_u32 s53, s53, 458752
    buffer_load_dwordx4 v[216:219], v16, s[48:51], s53 offen offset:0
    buffer_load_dwordx4 v[220:223], v17, s[48:51], s53 offen offset:1024
    buffer_load_dwordx4 v[224:227], v18, s[48:51], s53 offen offset:2048
    buffer_load_dwordx4 v[228:231], v19, s[48:51], s53 offen offset:3072
    buffer_load_dwordx4 v[232:235], v20, s[48:51], s53 offen offset:0
    buffer_load_dwordx4 v[236:239], v21, s[48:51], s53 offen offset:1024
    buffer_load_dwordx4 v[240:243], v22, s[48:51], s53 offen offset:2048
    s_add_u32 s53, s53, 458752
    s_waitcnt vmcnt(54)
    s_barrier
    s_waitcnt vmcnt(40)
    s_and_b32 s79, s78, 0x1ffff
    s_mov_b32 m0, s79
    s_add_u32 s75, s78, 4096
    buffer_load_dwordx4 v2, s[40:43], s78 offen offset:0 sc1 lds
    buffer_load_dwordx4 v2, s[40:43], s78 offen offset:1024 sc1 lds
    buffer_load_dwordx4 v2, s[40:43], s78 offen offset:2048 sc1 lds
    buffer_load_dwordx4 v2, s[40:43], s78 offen offset:3072 sc1 lds
    s_add_u32 s79, s79, 4096
    s_mov_b32 m0, s79
    s_add_u32 s78, s78, 0x8000
    buffer_load_dwordx4 v2, s[40:43], s75 offen offset:0 sc1 lds
    buffer_load_dwordx4 v2, s[40:43], s75 offen offset:1024 sc1 lds
    buffer_load_dwordx4 v2, s[40:43], s75 offen offset:2048 sc1 lds
    buffer_load_dwordx4 v2, s[40:43], s75 offen offset:3072 sc1 lds
    s_mov_b32 s54, 0x10000
    s_mov_b32 s55, 0x14000
    s_mov_b32 s56, 0x18000
    s_mov_b32 s57, 0x1c000
    s_mov_b32 s53, 0x8000
L_mainh_pm:
    buffer_load_dwordx4 v[112:115], v9, s[36:39], s54 offen sc1
    buffer_load_dwordx4 v[116:119], v9, s[36:39], s55 offen sc1
    buffer_load_dwordx4 v[120:123], v9, s[36:39], s56 offen sc1
    buffer_load_dwordx4 v[124:127], v9, s[36:39], s57 offen sc1
    s_waitcnt vmcnt(0)
L_mainh_pmc:
    v_or_b32 v14, v112, v113
    v_or3_b32 v14, v14, v114, v115
    v_or3_b32 v14, v14, v116, v117
    v_or3_b32 v14, v14, v118, v119
    v_or3_b32 v14, v14, v120, v121
    v_or3_b32 v14, v14, v122, v123
    v_or3_b32 v14, v14, v124, v125
    v_or3_b32 v14, v14, v126, v127
    v_and_b32 v14, 1, v14
    v_cmp_ne_u32 vcc, 0, v14
    s_sub_u32 s53, s53, 1
    s_cbranch_scc1 L_mainh_pmx
    s_cbranch_vccnz L_mainh_pm
L_mainh_pmx:
    s_mov_b64 exec, -1
    v_add_f32 v112, v112, v116
    v_add_f32 v113, v113, v117
    v_add_f32 v114, v114, v118
    v_add_f32 v115, v115, v119
    v_add_f32 v120, v120, v124
    v_add_f32 v121, v121, v125
    v_add_f32 v122, v122, v126
    v_add_f32 v123, v123, v127
    v_add_f32 v112, v112, v120
    v_add_f32 v113, v113, v121
    v_add_f32 v114, v114, v122
    v_add_f32 v115, v115, v123
    v_cvt_pk_bf16_f32 v116, v112, v113
    v_cvt_pk_bf16_f32 v117, v114, v115
    v_lshlrev_b32 v112, 16, v116
    v_and_b32 v113, 0xffff0000, v116
    v_lshlrev_b32 v114, 16, v117
    v_and_b32 v115, 0xffff0000, v117
    v_add_f32 v112, v112, v38
    v_add_f32 v113, v113, v38
    v_add_f32 v114, v114, v38
    v_add_f32 v115, v115, v38
    v_cvt_pk_bf16_f32 v116, v112, v113
    v_cvt_pk_bf16_f32 v117, v114, v115
    v_lshlrev_b32 v244, 16, v116
    v_and_b32 v245, 0xffff0000, v116
    v_lshlrev_b32 v246, 16, v117
    v_and_b32 v247, 0xffff0000, v117
    ds_bpermute_b32 v40, v12, v116 offset:0
    ds_bpermute_b32 v41, v12, v117 offset:0
    ds_bpermute_b32 v42, v12, v116 offset:4
    ds_bpermute_b32 v43, v12, v117 offset:4
    ds_bpermute_b32 v44, v12, v116 offset:32
    ds_bpermute_b32 v45, v12, v117 offset:32
    ds_bpermute_b32 v46, v12, v116 offset:36
    ds_bpermute_b32 v47, v12, v117 offset:36
    s_waitcnt lgkmcnt(0)
    ds_read_b64_tr_b16 v[128:129], v32 offset:0
    ds_read_b64_tr_b16 v[130:131], v32 offset:512
    ds_read_b64_tr_b16 v[132:133], v33 offset:0
    ds_read_b64_tr_b16 v[134:135], v33 offset:512
    ds_read_b64_tr_b16 v[136:137], v34 offset:0
    ds_read_b64_tr_b16 v[138:139], v34 offset:512
    ds_read_b64_tr_b16 v[140:141], v35 offset:0
    ds_read_b64_tr_b16 v[142:143], v35 offset:512
    s_waitcnt lgkmcnt(0)
    ds_read_b64_tr_b16 v[144:145], v32 offset:4096
    ds_read_b64_tr_b16 v[146:147], v32 offset:4608
    ds_read_b64_tr_b16 v[148:149], v33 offset:4096
    ds_read_b64_tr_b16 v[150:151], v33 offset:4608
    ds_read_b64_tr_b16 v[152:153], v34 offset:4096
    ds_read_b64_tr_b16 v[154:155], v34 offset:4608
    ds_read_b64_tr_b16 v[156:157], v35 offset:4096
    ds_read_b64_tr_b16 v[158:159], v35 offset:4608
    v_mfma_f32_16x16x32_bf16 v[112:115], v[40:43], v[128:131], 0
    v_mfma_f32_16x16x32_bf16 v[116:119], v[40:43], v[132:135], 0
    v_mfma_f32_16x16x32_bf16 v[120:123], v[40:43], v[136:139], 0
    v_mfma_f32_16x16x32_bf16 v[124:127], v[40:43], v[140:143], 0
    s_waitcnt lgkmcnt(0)
    v_mfma_f32_16x16x32_bf16 v[112:115], v[44:47], v[144:147], v[112:115]
    v_mfma_f32_16x16x32_bf16 v[116:119], v[44:47], v[148:151], v[116:119]
    v_mfma_f32_16x16x32_bf16 v[120:123], v[44:47], v[152:155], v[120:123]
    v_mfma_f32_16x16x32_bf16 v[124:127], v[44:47], v[156:159], v[124:127]
    s_nop 6
    s_mov_b32 exec_lo, 0xffff0000
    s_mov_b32 exec_hi, 0x0
    v_mov_b32 v112, v116
    v_mov_b32 v113, v117
    s_mov_b32 exec_lo, 0x0
    s_mov_b32 exec_hi, 0xffff
    v_mov_b32 v112, v120
    v_mov_b32 v113, v121
    s_mov_b32 exec_lo, 0x0
    s_mov_b32 exec_hi, 0xffff0000
    v_mov_b32 v112, v124
    v_mov_b32 v113, v125
    s_mov_b64 exec, -1
    ds_write_b32 v10, v112
    ds_write_b32 v10, v113 offset:256
    s_waitcnt lgkmcnt(0)
    s_waitcnt vmcnt(38)
    s_barrier
    s_add_u32 s73, s74, 0
    s_mov_b32 m0, s73
    s_add_u32 s75, s72, 131072
    buffer_load_dwordx4 v4, s[44:47], s72 offen offset:0  lds
    buffer_load_dwordx4 v5, s[44:47], s72 offen offset:1024  lds
    buffer_load_dwordx4 v6, s[44:47], s72 offen offset:2048  lds
    buffer_load_dwordx4 v7, s[44:47], s72 offen offset:3072  lds
    s_add_u32 s73, s73, 4096
    s_mov_b32 m0, s73
    s_add_u32 s73, s73, 4096
    buffer_load_dwordx4 v4, s[44:47], s75 offen offset:0  lds
    buffer_load_dwordx4 v5, s[44:47], s75 offen offset:1024  lds
    buffer_load_dwordx4 v6, s[44:47], s75 offen offset:2048  lds
    buffer_load_dwordx4 v7, s[44:47], s75 offen offset:3072  lds
    s_add_u32 s72, s72, 0x100000
    s_cmp_eq_u32 s3, 5
    s_cbranch_scc0 L_mainh_role11
    ds_read_b32 v112, v11 offset:0
    ds_read_b32 v113, v11 offset:8192
    ds_read_b32 v114, v11 offset:16384
    ds_read_b32 v115, v11 offset:24576
    s_mul_i32 s52, s82, 28672
    s_lshl_b32 s53, s83, 8
    s_add_u32 s52, s52, s53
    s_add_u32 s52, s52, 0x20000
    s_cmp_lt_u32 s2, 224
    s_cselect_b32 s52, s52, 0x7f000000
    s_waitcnt lgkmcnt(0)
    v_add_f32 v112, v112, v113
    v_add_f32 v114, v114, v115
    v_add_f32 v112, v112, v114
    v_and_b32 v112, -2, v112
    buffer_store_dword v112, v3, s[36:39], s52 offen sc1
L_mainh_role11:
    s_cmp_eq_u32 s3, 6
    s_cbranch_scc0 L_mainh_role12
    ds_read_b32 v112, v11 offset:256
    ds_read_b32 v113, v11 offset:8448
    ds_read_b32 v114, v11 offset:16640
    ds_read_b32 v115, v11 offset:24832
    s_mul_i32 s52, s82, 28672
    s_lshl_b32 s53, s83, 8
    s_add_u32 s52, s52, s53
    s_add_u32 s52, s52, 0x23800
    s_cmp_lt_u32 s2, 224
    s_cselect_b32 s52, s52, 0x7f000000
    s_waitcnt lgkmcnt(0)
    v_add_f32 v112, v112, v113
    v_add_f32 v114, v114, v115
    v_add_f32 v112, v112, v114
    v_and_b32 v112, -2, v112
    buffer_store_dword v112, v3, s[36:39], s52 offen sc1
L_mainh_role12:
    s_mov_b32 s48, s4
    s_mov_b32 s49, s5
    s_mov_b32 s50, 0x400000
    s_mov_b32 s51, 0x00020000
    s_lshl_b32 s53, s96, 2
    s_add_u32 s53, s53, s93
    s_lshl_b32 s53, s53, 16
    s_lshl_b32 s52, s97, 7
    s_add_u32 s53, s53, s52
    s_add_u32 s52, s74, 131072
    s_mov_b32 m0, s52
    s_mov_b32 exec_lo, 0
    ds_write_b128 v39, v[244:247]
    s_mov_b32 exec_lo, -1
    buffer_load_dwordx4 v24, s[48:51], s53 offen offset:0 lds
    buffer_load_dwordx4 v25, s[48:51], s53 offen offset:1024 lds
    buffer_load_dwordx4 v26, s[48:51], s53 offen offset:2048 lds
    buffer_load_dwordx4 v27, s[48:51], s53 offen offset:3072 lds
    s_waitcnt vmcnt(12)
    s_barrier
    s_add_u32 s73, s74, 32768
    s_mov_b32 m0, s73
    s_add_u32 s75, s72, 131072
    buffer_load_dwordx4 v4, s[44:47], s72 offen offset:0  lds
    buffer_load_dwordx4 v5, s[44:47], s72 offen offset:1024  lds
    buffer_load_dwordx4 v6, s[44:47], s72 offen offset:2048  lds
    buffer_load_dwordx4 v7, s[44:47], s72 offen offset:3072  lds
    s_add_u32 s73, s73, 4096
    s_mov_b32 m0, s73
    s_add_u32 s73, s73, 4096
    buffer_load_dwordx4 v4, s[44:47], s75 offen offset:0  lds
    buffer_load_dwordx4 v5, s[44:47], s75 offen offset:1024  lds
    buffer_load_dwordx4 v6, s[44:47], s75 offen offset:2048  lds
    buffer_load_dwordx4 v7, s[44:47], s75 offen offset:3072  lds
    s_add_u32 s72, s72, 0x100000
    s_waitcnt vmcnt(0) lgkmcnt(0)
    s_setprio 0
    s_barrier
    ds_write_b128 v37, v[48:51] offset:0
    ds_write_b128 v37, v[52:55] offset:1024
    ds_write_b128 v37, v[56:59] offset:2048
    ds_write_b128 v37, v[60:63] offset:3072
    ds_write_b128 v37, v[64:67] offset:4096
    ds_write_b128 v37, v[68:71] offset:5120
    ds_write_b128 v37, v[72:75] offset:6144
    ds_write_b128 v37, v[76:79] offset:7168
    s_waitcnt lgkmcnt(4)
    s_waitcnt lgkmcnt(0)
    s_barrier
    s_cmp_eq_u32 s3, 4
    s_cbranch_scc0 L_mainh_role13
    s_lshl_b32 s54, s96, 1
    s_add_u32 s54, s54, 1
    s_lshl_b32 s52, s54, 9
    s_add_u32 s52, s52, 0x140000
    v_lshlrev_b32 v14, 7, v1
    s_mov_b64 exec, 15
    s_mov_b32 s53, 0x8000
L_mainh_pb:
    v_mov_b32 v13, 0
    buffer_atomic_add v13, v14, s[36:39], s52 offen sc0 sc1
    s_waitcnt vmcnt(0)
L_mainh_pbc:
    v_cmp_ne_u32 vcc, 15, v13
    s_sub_u32 s53, s53, 1
    s_cbranch_scc1 L_mainh_pbx
    s_cbranch_vccnz L_mainh_pb
L_mainh_pbx:
    s_mov_b64 exec, -1
L_mainh_role13:
    s_barrier
    ds_write_b128 v37, v[80:83] offset:32768
    ds_write_b128 v37, v[84:87] offset:33792
    ds_write_b128 v37, v[88:91] offset:34816
    ds_write_b128 v37, v[92:95] offset:35840
    ds_write_b128 v37, v[96:99] offset:36864
    ds_write_b128 v37, v[100:103] offset:37888
    ds_write_b128 v37, v[104:107] offset:38912
    ds_write_b128 v37, v[108:111] offset:39936
    s_waitcnt lgkmcnt(4)
    s_mul_i32 s73, s93, 7168
    v_add_u32 v38, s73, v2
    s_mov_b32 s44, s16
    s_mov_b32 s45, s17
    s_mov_b32 s46, 0x700000
    s_mov_b32 s47, 0x00020000
    s_mul_i32 s72, s93, 114688
    s_add_u32 s72, s72, 1376256
    v_lshrrev_b32 v4, 3, v1
    v_mul_u32_u24 v4, 2048, v4
    v_bfe_u32 v8, v1, 4, 2
    v_lshlrev_b32 v8, 1, v8
    v_xor_b32 v8, v8, v1
    v_and_b32 v8, 7, v8
    v_lshl_add_u32 v4, v8, 4, v4
    v_xor_b32 v8, 0, v4
    v_add_u32 v5, 15360, v8
    v_add_u32 v6, 30720, v4
    v_add_u32 v7, 46080, v8
    v_lshrrev_b32 v8, 1, v1
    v_cmp_gt_u32 vcc, s92, v8
    v_mov_b32 v14, s100
    v_mov_b32 v15, s101
    v_min_u32 v9, 880, v2
    v_cndmask_b32 v8, v15, v14, vcc
    v_lshl_add_u32 v248, v8, 1, v9
    v_mov_b32 v250, v39
    v_and_b32 v8, 15, v1
    v_lshlrev_b32 v8, 3, v8
    v_lshl_add_u32 v251, v36, 12, v8
    s_waitcnt lgkmcnt(0)
    s_barrier
    s_cmp_lt_u32 s93, 2
    s_cbranch_scc1 L_mainh_ut
    s_and_b32 s52, s93, 1
    s_mul_i32 s53, s52, 14336
    s_add_u32 s54, s53, 0x20000
    s_add_u32 s55, s53, 0x27000
    s_add_u32 s56, s53, 0x2e000
    s_add_u32 s57, s53, 0x35000
    s_mov_b32 s53, 0x8000
L_mainh_pu:
    buffer_load_dwordx4 v[112:115], v248, s[36:39], s54 offen sc1
    buffer_load_dwordx4 v[116:119], v248, s[36:39], s55 offen sc1
    buffer_load_dwordx4 v[120:123], v248, s[36:39], s56 offen sc1
    buffer_load_dwordx4 v[124:127], v248, s[36:39], s57 offen sc1
    s_waitcnt vmcnt(0)
L_mainh_puc:
    v_or_b32 v14, v112, v113
    v_or3_b32 v14, v14, v114, v115
    v_or3_b32 v14, v14, v116, v117
    v_or3_b32 v14, v14, v118, v119
    v_or3_b32 v14, v14, v120, v121
    v_or3_b32 v14, v14, v122, v123
    v_or3_b32 v14, v14, v124, v125
    v_or3_b32 v14, v14, v126, v127
    v_and_b32 v14, 1, v14
    v_cmp_ne_u32 vcc, 0, v14
    s_sub_u32 s53, s53, 1
    s_cbranch_scc1 L_mainh_pux
    s_cbranch_vccnz L_mainh_pu
L_mainh_pux:
    s_mov_b64 exec, -1
    v_add_f32 v112, v112, v116
    v_add_f32 v113, v113, v117
    v_add_f32 v114, v114, v118
    v_add_f32 v115, v115, v119
    v_add_f32 v120, v120, v124
    v_add_f32 v121, v121, v125
    v_add_f32 v122, v122, v126
    v_add_f32 v123, v123, v127
    v_add_f32 v112, v112, v120
    v_add_f32 v113, v113, v121
    v_add_f32 v114, v114, v122
    v_add_f32 v115, v115, v123
    s_lshl_b32 s52, s52, 10
    s_add_u32 s52, s52, 143360
    v_add_u32 v8, s52, v2
    ds_write_b128 v8, v[112:115]
L_mainh_ut:
    s_barrier
    ds_write_b128 v38, v[160:163] offset:0
    ds_write_b128 v38, v[164:167] offset:1024
    ds_write_b128 v38, v[168:171] offset:2048
    ds_write_b128 v38, v[172:175] offset:3072
    ds_write_b128 v38, v[176:179] offset:4096
    ds_write_b128 v38, v[180:183] offset:5120
    ds_write_b128 v38, v[184:187] offset:6144
    s_waitcnt lgkmcnt(4)
    ds_write_b128 v38, v[188:191] offset:28672
    ds_write_b128 v38, v[192:195] offset:29696
    ds_write_b128 v38, v[196:199] offset:30720
    ds_write_b128 v38, v[200:203] offset:31744
    ds_write_b128 v38, v[204:207] offset:32768
    ds_write_b128 v38, v[208:211] offset:33792
    ds_write_b128 v38, v[212:215] offset:34816
    s_waitcnt lgkmcnt(4)
    ds_write_b128 v38, v[216:219] offset:57344
    ds_write_b128 v38, v[220:223] offset:58368
    ds_write_b128 v38, v[224:227] offset:59392
    ds_write_b128 v38, v[228:231] offset:60416
    ds_write_b128 v38, v[232:235] offset:61440
    ds_write_b128 v38, v[236:239] offset:62464
    ds_write_b128 v38, v[240:243] offset:63488
    s_waitcnt lgkmcnt(4)
    s_waitcnt lgkmcnt(0)
    s_nop 0
    s_barrier
    s_add_u32 s77, s73, 86016
    s_mov_b32 m0, s77
    s_add_u32 s75, s77, 4096
    buffer_load_dwordx4 v16, s[44:47], s72 offen offset:0 lds
    buffer_load_dwordx4 v17, s[44:47], s72 offen offset:1024 lds
    buffer_load_dwordx4 v18, s[44:47], s72 offen offset:2048 lds
    buffer_load_dwordx4 v19, s[44:47], s72 offen offset:3072 lds
    s_mov_b32 m0, s75
    s_nop 0
    buffer_load_dwordx4 v20, s[44:47], s72 offen offset:0 lds
    buffer_load_dwordx4 v21, s[44:47], s72 offen offset:1024 lds
    buffer_load_dwordx4 v22, s[44:47], s72 offen offset:2048 lds
    s_add_u32 s72, s72, 458752
    s_nop 0
    s_barrier
    s_add_u32 s77, s73, 114688
    s_mov_b32 m0, s77
    s_add_u32 s75, s77, 4096
    buffer_load_dwordx4 v16, s[44:47], s72 offen offset:0 lds
    buffer_load_dwordx4 v17, s[44:47], s72 offen offset:1024 lds
    buffer_load_dwordx4 v18, s[44:47], s72 offen offset:2048 lds
    buffer_load_dwordx4 v19, s[44:47], s72 offen offset:3072 lds
    s_mov_b32 m0, s75
    s_nop 0
    buffer_load_dwordx4 v20, s[44:47], s72 offen offset:0 lds
    buffer_load_dwordx4 v21, s[44:47], s72 offen offset:1024 lds
    buffer_load_dwordx4 v22, s[44:47], s72 offen offset:2048 lds
    s_add_u32 s72, s72, 458752
    s_nop 0
    s_barrier
    s_add_u32 s77, s73, 0
    s_mov_b32 m0, s77
    s_add_u32 s75, s77, 4096
    buffer_load_dwordx4 v16, s[44:47], s72 offen offset:0 lds
    buffer_load_dwordx4 v17, s[44:47], s72 offen offset:1024 lds
    buffer_load_dwordx4 v18, s[44:47], s72 offen offset:2048 lds
    buffer_load_dwordx4 v19, s[44:47], s72 offen offset:3072 lds
    s_mov_b32 m0, s75
    s_nop 0
    buffer_load_dwordx4 v20, s[44:47], s72 offen offset:0 lds
    buffer_load_dwordx4 v21, s[44:47], s72 offen offset:1024 lds
    buffer_load_dwordx4 v22, s[44:47], s72 offen offset:2048 lds
    s_add_u32 s72, s72, 458752
    s_waitcnt vmcnt(14)
    s_barrier
    s_add_u32 s77, s73, 28672
    s_mov_b32 m0, s77
    s_add_u32 s75, s77, 4096
    buffer_load_dwordx4 v16, s[44:47], s72 offen offset:0 lds
    buffer_load_dwordx4 v17, s[44:47], s72 offen offset:1024 lds
    buffer_load_dwordx4 v18, s[44:47], s72 offen offset:2048 lds
    buffer_load_dwordx4 v19, s[44:47], s72 offen offset:3072 lds
    s_mov_b32 m0, s75
    s_nop 0
    buffer_load_dwordx4 v20, s[44:47], s72 offen offset:0 lds
    buffer_load_dwordx4 v21, s[44:47], s72 offen offset:1024 lds
    buffer_load_dwordx4 v22, s[44:47], s72 offen offset:2048 lds
    s_add_u32 s72, s72, 458752
    s_lshl_b32 s53, s98, 2
    s_add_u32 s53, s53, s93
    s_lshl_b32 s53, s53, 8
    s_add_u32 s58, s53, 0xc0000
    s_add_u32 s59, s53, 0xc4000
    s_add_u32 s60, s53, 0xc8000
    s_add_u32 s61, s53, 0xcc000
    buffer_load_dwordx2 v[224:225], v251, s[36:39], s58 offen sc1
    buffer_load_dwordx2 v[232:233], v251, s[36:39], s58 offen offset:128 sc1
    buffer_load_dwordx2 v[226:227], v251, s[36:39], s59 offen sc1
    buffer_load_dwordx2 v[234:235], v251, s[36:39], s59 offen offset:128 sc1
    buffer_load_dwordx2 v[228:229], v251, s[36:39], s60 offen sc1
    buffer_load_dwordx2 v[236:237], v251, s[36:39], s60 offen offset:128 sc1
    buffer_load_dwordx2 v[230:231], v251, s[36:39], s61 offen sc1
    buffer_load_dwordx2 v[238:239], v251, s[36:39], s61 offen offset:128 sc1
    s_waitcnt vmcnt(22)
    s_barrier
    s_add_u32 s77, s73, 57344
    s_mov_b32 m0, s77
    s_add_u32 s75, s77, 4096
    buffer_load_dwordx4 v16, s[44:47], s72 offen offset:0 lds
    buffer_load_dwordx4 v17, s[44:47], s72 offen offset:1024 lds
    buffer_load_dwordx4 v18, s[44:47], s72 offen offset:2048 lds
    buffer_load_dwordx4 v19, s[44:47], s72 offen offset:3072 lds
    s_mov_b32 m0, s75
    s_nop 0
    buffer_load_dwordx4 v20, s[44:47], s72 offen offset:0 lds
    buffer_load_dwordx4 v21, s[44:47], s72 offen offset:1024 lds
    buffer_load_dwordx4 v22, s[44:47], s72 offen offset:2048 lds
    s_add_u32 s72, s72, 458752
    s_waitcnt vmcnt(22)
    s_barrier
    s_add_u32 s77, s73, 86016
    s_mov_b32 m0, s77
    s_add_u32 s75, s77, 4096
    buffer_load_dwordx4 v16, s[44:47], s72 offen offset:0 lds
    buffer_load_dwordx4 v17, s[44:47], s72 offen offset:1024 lds
    buffer_load_dwordx4 v18, s[44:47], s72 offen offset:2048 lds
    buffer_load_dwordx4 v19, s[44:47], s72 offen offset:3072 lds
    s_mov_b32 m0, s75
    s_nop 0
    buffer_load_dwordx4 v20, s[44:47], s72 offen offset:0 lds
    buffer_load_dwordx4 v21, s[44:47], s72 offen offset:1024 lds
    buffer_load_dwordx4 v22, s[44:47], s72 offen offset:2048 lds
    s_add_u32 s72, s72, 458752
    s_mov_b32 s53, 0x8000
    s_waitcnt vmcnt(14)
    s_branch L_mainh_ptc
L_mainh_pt:
    buffer_load_dwordx2 v[224:225], v251, s[36:39], s58 offen sc1
    buffer_load_dwordx2 v[232:233], v251, s[36:39], s58 offen offset:128 sc1
    buffer_load_dwordx2 v[226:227], v251, s[36:39], s59 offen sc1
    buffer_load_dwordx2 v[234:235], v251, s[36:39], s59 offen offset:128 sc1
    buffer_load_dwordx2 v[228:229], v251, s[36:39], s60 offen sc1
    buffer_load_dwordx2 v[236:237], v251, s[36:39], s60 offen offset:128 sc1
    buffer_load_dwordx2 v[230:231], v251, s[36:39], s61 offen sc1
    buffer_load_dwordx2 v[238:239], v251, s[36:39], s61 offen offset:128 sc1
    s_waitcnt vmcnt(0)
L_mainh_ptc:
    v_or_b32 v14, v225, v227
    v_or3_b32 v14, v14, v229, v231
    v_or3_b32 v14, v14, v233, v235
    v_or3_b32 v14, v14, v237, v239
    v_and_b32 v14, 1, v14
    v_cmp_ne_u32 vcc, 0, v14
    s_sub_u32 s53, s53, 1
    s_cbranch_scc1 L_mainh_ptx
    s_cbranch_vccnz L_mainh_pt
L_mainh_ptx:
    s_mov_b64 exec, -1
    s_waitcnt vmcnt(22)
    s_barrier
    s_add_u32 s77, s73, 114688
    s_mov_b32 m0, s77
    s_add_u32 s75, s77, 4096
    buffer_load_dwordx4 v16, s[44:47], s72 offen offset:0 lds
    buffer_load_dwordx4 v17, s[44:47], s72 offen offset:1024 lds
    buffer_load_dwordx4 v18, s[44:47], s72 offen offset:2048 lds
    buffer_load_dwordx4 v19, s[44:47], s72 offen offset:3072 lds
    s_mov_b32 m0, s75
    s_nop 0
    buffer_load_dwordx4 v20, s[44:47], s72 offen offset:0 lds
    buffer_load_dwordx4 v21, s[44:47], s72 offen offset:1024 lds
    buffer_load_dwordx4 v22, s[44:47], s72 offen offset:2048 lds
    s_add_u32 s72, s72, 458752
    v_add_f32 v224, v224, v226
    v_add_f32 v225, v225, v227
    v_add_f32 v232, v232, v234
    v_add_f32 v233, v233, v235
    v_add_f32 v228, v228, v230
    v_add_f32 v229, v229, v231
    v_add_f32 v236, v236, v238
    v_add_f32 v237, v237, v239
    v_add_f32 v224, v224, v228
    s_waitcnt vmcnt(14)
    s_barrier
    s_add_u32 s77, s73, 0
    s_mov_b32 m0, s77
    s_add_u32 s75, s77, 4096
    buffer_load_dwordx4 v16, s[44:47], s72 offen offset:0 lds
    buffer_load_dwordx4 v17, s[44:47], s72 offen offset:1024 lds
    buffer_load_dwordx4 v18, s[44:47], s72 offen offset:2048 lds
    buffer_load_dwordx4 v19, s[44:47], s72 offen offset:3072 lds
    s_mov_b32 m0, s75
    s_nop 0
    buffer_load_dwordx4 v20, s[44:47], s72 offen offset:0 lds
    buffer_load_dwordx4 v21, s[44:47], s72 offen offset:1024 lds
    buffer_load_dwordx4 v22, s[44:47], s72 offen offset:2048 lds
    s_add_u32 s72, s72, 458752
    v_add_f32 v225, v225, v229
    v_add_f32 v232, v232, v236
    v_add_f32 v233, v233, v237
    v_mov_b32 v8, v224
    v_mov_b32 v9, v225
    v_mov_b32 v10, v232
    v_mov_b32 v11, v233
    s_nop 0
    v_permlane16_swap_b32 v8, v224
    s_waitcnt vmcnt(14)
    s_barrier
    s_add_u32 s77, s73, 28672
    s_mov_b32 m0, s77
    s_add_u32 s75, s77, 4096
    buffer_load_dwordx4 v16, s[44:47], s72 offen offset:0 lds
    buffer_load_dwordx4 v17, s[44:47], s72 offen offset:1024 lds
    buffer_load_dwordx4 v18, s[44:47], s72 offen offset:2048 lds
    buffer_load_dwordx4 v19, s[44:47], s72 offen offset:3072 lds
    s_mov_b32 m0, s75
    s_nop 0
    buffer_load_dwordx4 v20, s[44:47], s72 offen offset:0 lds
    buffer_load_dwordx4 v21, s[44:47], s72 offen offset:1024 lds
    buffer_load_dwordx4 v22, s[44:47], s72 offen offset:2048 lds
    s_add_u32 s72, s72, 458752
    v_permlane16_swap_b32 v9, v225
    v_permlane16_swap_b32 v10, v232
    v_permlane16_swap_b32 v11, v233
    s_nop 0
    v_add_f32 v224, v224, v8
    v_add_f32 v225, v225, v9
    v_add_f32 v232, v232, v10
    v_add_f32 v233, v233, v11
    v_mov_b32 v8, v224
    s_waitcnt vmcnt(14)
    s_barrier
    s_add_u32 s77, s73, 57344
    s_mov_b32 m0, s77
    s_add_u32 s75, s77, 4096
    buffer_load_dwordx4 v16, s[44:47], s72 offen offset:0 lds
    buffer_load_dwordx4 v17, s[44:47], s72 offen offset:1024 lds
    buffer_load_dwordx4 v18, s[44:47], s72 offen offset:2048 lds
    buffer_load_dwordx4 v19, s[44:47], s72 offen offset:3072 lds
    s_mov_b32 m0, s75
    s_nop 0
    buffer_load_dwordx4 v20, s[44:47], s72 offen offset:0 lds
    buffer_load_dwordx4 v21, s[44:47], s72 offen offset:1024 lds
    buffer_load_dwordx4 v22, s[44:47], s72 offen offset:2048 lds
    s_add_u32 s72, s72, 458752
    v_mov_b32 v9, v225
    v_mov_b32 v10, v232
    v_mov_b32 v11, v233
    s_nop 0
    v_permlane32_swap_b32 v8, v224
    v_permlane32_swap_b32 v9, v225
    v_permlane32_swap_b32 v10, v232
    v_permlane32_swap_b32 v11, v233
    s_nop 0
    s_waitcnt vmcnt(14)
    s_barrier
    s_add_u32 s77, s73, 86016
    s_mov_b32 m0, s77
    s_add_u32 s75, s77, 4096
    buffer_load_dwordx4 v16, s[44:47], s72 offen offset:0 lds
    buffer_load_dwordx4 v17, s[44:47], s72 offen offset:1024 lds
    buffer_load_dwordx4 v18, s[44:47], s72 offen offset:2048 lds
    buffer_load_dwordx4 v19, s[44:47], s72 offen offset:3072 lds
    s_mov_b32 m0, s75
    s_nop 0
    buffer_load_dwordx4 v20, s[44:47], s72 offen offset:0 lds
    buffer_load_dwordx4 v21, s[44:47], s72 offen offset:1024 lds
    buffer_load_dwordx4 v22, s[44:47], s72 offen offset:2048 lds
    s_add_u32 s72, s72, 458752
    v_add_f32 v224, v224, v8
    v_add_f32 v225, v225, v9
    v_add_f32 v232, v232, v10
    v_add_f32 v233, v233, v11
    v_mul_f32 v224, 0xba800000, v224
    v_mul_f32 v225, 0x3a800000, v225
    v_mul_f32 v232, 0xba800000, v232
    v_mul_f32 v233, 0x3a800000, v233
    v_fma_f32 v225, -v224, v224, v225
    s_waitcnt vmcnt(14)
    s_barrier
    s_add_u32 s77, s73, 114688
    s_mov_b32 m0, s77
    s_add_u32 s75, s77, 4096
    buffer_load_dwordx4 v16, s[44:47], s72 offen offset:0 lds
    buffer_load_dwordx4 v17, s[44:47], s72 offen offset:1024 lds
    buffer_load_dwordx4 v18, s[44:47], s72 offen offset:2048 lds
    buffer_load_dwordx4 v19, s[44:47], s72 offen offset:3072 lds
    s_mov_b32 m0, s75
    s_nop 0
    buffer_load_dwordx4 v20, s[44:47], s72 offen offset:0 lds
    buffer_load_dwordx4 v21, s[44:47], s72 offen offset:1024 lds
    buffer_load_dwordx4 v22, s[44:47], s72 offen offset:2048 lds
    s_add_u32 s72, s72, 458752
    v_max_f32 v225, 0, v225
    v_add_f32 v225, 0x3727c5ac, v225
    v_fma_f32 v233, -v232, v232, v233
    v_max_f32 v233, 0, v233
    v_add_f32 v233, 0x3727c5ac, v233
    v_rsq_f32 v228, v225
    v_rsq_f32 v230, v233
    s_nop 0
    s_add_u32 s48, s94, L_mainc_wepi-L_mainh_pc
    s_addc_u32 s49, s95, 0
    s_mov_b32 s50, L_main_exit-L_mainc_wepi
    s_mov_b32 s51, 0x00020000
    s_lshl_b32 s52, s93, 13
    buffer_load_dword v252, v23, s[48:51], s52 offen
    s_waitcnt vmcnt(15)
    s_barrier
    s_add_u32 s77, s73, 0
    s_mov_b32 m0, s77
    s_add_u32 s75, s77, 4096
    buffer_load_dwordx4 v16, s[44:47], s72 offen offset:0 lds
    buffer_load_dwordx4 v17, s[44:47], s72 offen offset:1024 lds
    buffer_load_dwordx4 v18, s[44:47], s72 offen offset:2048 lds
    buffer_load_dwordx4 v19, s[44:47], s72 offen offset:3072 lds
    s_mov_b32 m0, s75
    s_nop 0
    buffer_load_dwordx4 v20, s[44:47], s72 offen offset:0 lds
    buffer_load_dwordx4 v21, s[44:47], s72 offen offset:1024 lds
    buffer_load_dwordx4 v22, s[44:47], s72 offen offset:2048 lds
    s_add_u32 s72, s72, 458752
    v_mul_f32 v229, v224, v228
    v_mul_f32 v231, v232, v230
    s_lshl_b32 s53, s93, 8
    s_add_u32 s53, s53, 145408
    v_and_b32 v9, 255, v2
    v_add_u32 v9, s53, v9
    ds_write_b128 v9, v[228:231]
    s_waitcnt lgkmcnt(0)
    s_waitcnt vmcnt(15)
    s_barrier
    s_mov_b32 s48, s22
    s_mov_b32 s49, s23
    s_mov_b32 s50, 0x380000
    s_mov_b32 s51, 0x00020000
    s_lshl_b32 s84, s93, 17
    s_lshl_b32 s52, s97, 7
    s_add_u32 s84, s84, s52
    s_add_u32 s84, s84, 2097152
    s_waitcnt vmcnt(8)
    s_barrier
    s_add_u32 s75, s84, 65536
    buffer_load_dwordx4 v[16:19], v4, s[48:51], s84 offen offset:0
    buffer_load_dwordx4 v[20:23], v5, s[48:51], s84 offen offset:1024
    buffer_load_dwordx4 v[24:27], v6, s[48:51], s84 offen offset:2048
    buffer_load_dwordx4 v[28:31], v7, s[48:51], s84 offen offset:3072
    buffer_load_dwordx4 v[32:35], v4, s[48:51], s75 offen offset:0
    buffer_load_dwordx4 v[36:39], v5, s[48:51], s75 offen offset:1024
    buffer_load_dwordx4 v[40:43], v6, s[48:51], s75 offen offset:2048
    buffer_load_dwordx4 v[44:47], v7, s[48:51], s75 offen offset:3072
    s_add_u32 s84, s84, 0x80000
    s_waitcnt vmcnt(8)
    s_barrier
    s_add_u32 s75, s84, 65536
    buffer_load_dwordx4 v[48:51], v4, s[48:51], s84 offen offset:0
    buffer_load_dwordx4 v[52:55], v5, s[48:51], s84 offen offset:1024
    buffer_load_dwordx4 v[56:59], v6, s[48:51], s84 offen offset:2048
    buffer_load_dwordx4 v[60:63], v7, s[48:51], s84 offen offset:3072
    buffer_load_dwordx4 v[64:67], v4, s[48:51], s75 offen offset:0
    buffer_load_dwordx4 v[68:71], v5, s[48:51], s75 offen offset:1024
    buffer_load_dwordx4 v[72:75], v6, s[48:51], s75 offen offset:2048
    buffer_load_dwordx4 v[76:79], v7, s[48:51], s75 offen offset:3072
    s_add_u32 s84, s84, 0x80000
    s_add_u32 s75, s84, 65536
    buffer_load_dwordx4 v[80:83], v4, s[48:51], s84 offen offset:0
    buffer_load_dwordx4 v[84:87], v5, s[48:51], s84 offen offset:1024
    buffer_load_dwordx4 v[88:91], v6, s[48:51], s84 offen offset:2048
    buffer_load_dwordx4 v[92:95], v7, s[48:51], s84 offen offset:3072
    buffer_load_dwordx4 v[96:99], v4, s[48:51], s75 offen offset:0
    buffer_load_dwordx4 v[100:103], v5, s[48:51], s75 offen offset:1024
    buffer_load_dwordx4 v[104:107], v6, s[48:51], s75 offen offset:2048
    buffer_load_dwordx4 v[108:111], v7, s[48:51], s75 offen offset:3072
    s_sub_u32 s84, s84, 3145728
    s_mov_b32 s44, s18
    s_mov_b32 s45, s19
    s_mov_b32 s46, 0x800000
    s_mov_b32 s47, 0x00020000
    s_add_u32 s40, s32, 0x1500000
    s_addc_u32 s41, s33, 0
    s_mov_b32 s42, 0x700000
    s_mov_b32 s43, 0x00020000
    v_lshrrev_b32 v240, 3, v1
    v_lshlrev_b32 v240, 12, v240
    v_bfe_u32 v8, v1, 4, 1
    v_lshlrev_b32 v8, 1, v8
    v_lshrrev_b32 v9, 5, v1
    v_or_b32 v8, v8, v9
    v_xor_b32 v8, v8, v1
    v_and_b32 v8, 7, v8
    v_lshl_add_u32 v240, v8, 4, v240
    v_xor_b32 v8, 64, v240
    v_add_u32 v241, 31744, v8
    v_add_u32 v242, 63488, v240
    v_add_u32 v243, 95232, v8
    s_lshl_b32 s78, s34, 19
    s_lshl_b32 s52, s93, 17
    s_add_u32 s78, s78, s52
    s_lshr_b32 s52, s93, 1
    s_mul_i32 s79, s52, 114688
    s_and_b32 s52, s93, 1
    s_lshl_b32 s52, s52, 12
    s_add_u32 s79, s79, s52
    s_lshl_b32 s52, s92, 4
    s_add_u32 s52, s52, s101
    s_lshl_b32 s52, s52, 5
    s_add_u32 s79, s79, s52
    s_lshl_b32 s73, s93, 12
    s_add_u32 s77, s73, 16384
    s_andn2_b32 s81, s93, s35
    s_and_b32 s81, s81, 1
    s_mov_b32 s89, 0
    s_mov_b32 s90, 0
    s_barrier
    s_lshl_b32 s72, s89, 7
    s_mov_b32 m0, s73
    s_add_u32 s72, s72, s78
    buffer_load_dwordx4 v240, s[44:47], s72 offen offset:0 lds
    buffer_load_dwordx4 v241, s[44:47], s72 offen offset:1024 lds
    buffer_load_dwordx4 v242, s[44:47], s72 offen offset:2048 lds
    buffer_load_dwordx4 v243, s[44:47], s72 offen offset:3072 lds
    s_add_u32 s73, s73, 0x8000
    s_and_b32 s73, s73, 131071
    s_add_u32 s89, s89, 1
    s_lshl_b32 s72, s89, 7
    s_mov_b32 m0, s73
    s_add_u32 s72, s72, s78
    buffer_load_dwordx4 v240, s[44:47], s72 offen offset:0 lds
    buffer_load_dwordx4 v241, s[44:47], s72 offen offset:1024 lds
    buffer_load_dwordx4 v242, s[44:47], s72 offen offset:2048 lds
    buffer_load_dwordx4 v243, s[44:47], s72 offen offset:3072 lds
    s_add_u32 s73, s73, 0x8000
    s_and_b32 s73, s73, 131071
    s_add_u32 s89, s89, 1
    s_lshl_b32 s72, s89, 7
    s_mov_b32 m0, s73
    s_add_u32 s72, s72, s78
    buffer_load_dwordx4 v240, s[44:47], s72 offen offset:0 lds
    buffer_load_dwordx4 v241, s[44:47], s72 offen offset:1024 lds
    buffer_load_dwordx4 v242, s[44:47], s72 offen offset:2048 lds
    buffer_load_dwordx4 v243, s[44:47], s72 offen offset:3072 lds
    s_add_u32 s73, s73, 0x8000
    s_and_b32 s73, s73, 131071
    s_add_u32 s89, s89, 1
    s_waitcnt vmcnt(24)
    s_add_u32 s75, s84, 65536
    buffer_load_dwordx4 v[112:115], v4, s[48:51], s84 offen offset:0
    buffer_load_dwordx4 v[116:119], v5, s[48:51], s84 offen offset:1024
    buffer_load_dwordx4 v[120:123], v6, s[48:51], s84 offen offset:2048
    buffer_load_dwordx4 v[124:127], v7, s[48:51], s84 offen offset:3072
    buffer_load_dwordx4 v[128:131], v4, s[48:51], s75 offen offset:0
    buffer_load_dwordx4 v[132:135], v5, s[48:51], s75 offen offset:1024
    buffer_load_dwordx4 v[136:139], v6, s[48:51], s75 offen offset:2048
    buffer_load_dwordx4 v[140:143], v7, s[48:51], s75 offen offset:3072
    s_add_u32 s84, s84, 0x80000
    s_add_u32 s75, s84, 65536
    buffer_load_dwordx4 v[144:147], v4, s[48:51], s84 offen offset:0
    buffer_load_dwordx4 v[148:151], v5, s[48:51], s84 offen offset:1024
    buffer_load_dwordx4 v[152:155], v6, s[48:51], s84 offen offset:2048
    buffer_load_dwordx4 v[156:159], v7, s[48:51], s84 offen offset:3072
    buffer_load_dwordx4 v[160:163], v4, s[48:51], s75 offen offset:0
    buffer_load_dwordx4 v[164:167], v5, s[48:51], s75 offen offset:1024
    buffer_load_dwordx4 v[168:171], v6, s[48:51], s75 offen offset:2048
    buffer_load_dwordx4 v[172:175], v7, s[48:51], s75 offen offset:3072
    s_add_u32 s84, s84, 0x80000
    s_add_u32 s75, s84, 65536
    buffer_load_dwordx4 v[176:179], v4, s[48:51], s84 offen offset:0
    buffer_load_dwordx4 v[180:183], v5, s[48:51], s84 offen offset:1024
    buffer_load_dwordx4 v[184:187], v6, s[48:51], s84 offen offset:2048
    buffer_load_dwordx4 v[188:191], v7, s[48:51], s84 offen offset:3072
    buffer_load_dwordx4 v[192:195], v4, s[48:51], s75 offen offset:0
    buffer_load_dwordx4 v[196:199], v5, s[48:51], s75 offen offset:1024
    buffer_load_dwordx4 v[200:203], v6, s[48:51], s75 offen offset:2048
    buffer_load_dwordx4 v[204:207], v7, s[48:51], s75 offen offset:3072
    s_add_u32 s84, s84, 0x80000
    s_barrier
    s_cmp_eq_u32 s3, 4
    s_cbranch_scc0 L_mainh_role14
    s_xor_b32 s54, s35, 1
    s_lshl_b32 s52, s54, 9
    s_add_u32 s52, s52, 0x148000
    v_lshlrev_b32 v14, 7, v1
    s_mov_b64 exec, 15
    s_mov_b32 s53, 0x8000
L_mainh_pz:
    v_mov_b32 v13, 0
    buffer_atomic_add v13, v14, s[36:39], s52 offen sc0 sc1
    s_waitcnt vmcnt(0)
L_mainh_pzc:
    v_cmp_ne_u32 vcc, 15, v13
    s_sub_u32 s53, s53, 1
    s_cbranch_scc1 L_mainh_pzx
    s_cbranch_vccnz L_mainh_pz
L_mainh_pzx:
    s_mov_b64 exec, -1
L_mainh_role14:
    s_barrier
    s_mul_i32 s72, s90, 229376
    s_mov_b32 m0, s77
    s_add_u32 s72, s72, s79
    s_cmp_eq_u32 s81, 1
    s_cbranch_scc1 L_mainh_zs1
    buffer_load_dwordx4 v2, s[40:43], s72 offen offset:2048 sc1 lds
    buffer_load_dwordx4 v2, s[40:43], s72 offen offset:3072 sc1 lds
L_mainh_zs1:
    buffer_load_dwordx4 v2, s[40:43], s72 offen offset:0 sc1 lds
    buffer_load_dwordx4 v2, s[40:43], s72 offen offset:1024 sc1 lds
    s_add_u32 s77, s77, 0x8000
    s_and_b32 s77, s77, 131071
    s_add_u32 s90, s90, 1
    s_mul_i32 s72, s90, 229376
    s_mov_b32 m0, s77
    s_add_u32 s72, s72, s79
    s_cmp_eq_u32 s81, 1
    s_cbranch_scc1 L_mainh_zs2
    buffer_load_dwordx4 v2, s[40:43], s72 offen offset:2048 sc1 lds
    buffer_load_dwordx4 v2, s[40:43], s72 offen offset:3072 sc1 lds
L_mainh_zs2:
    buffer_load_dwordx4 v2, s[40:43], s72 offen offset:0 sc1 lds
    buffer_load_dwordx4 v2, s[40:43], s72 offen offset:1024 sc1 lds
    s_add_u32 s77, s77, 0x8000
    s_and_b32 s77, s77, 131071
    s_add_u32 s90, s90, 1
    s_mul_i32 s72, s90, 229376
    s_mov_b32 m0, s77
    s_add_u32 s72, s72, s79
    s_cmp_eq_u32 s81, 1
    s_cbranch_scc1 L_mainh_zs3
    buffer_load_dwordx4 v2, s[40:43], s72 offen offset:2048 sc1 lds
    buffer_load_dwordx4 v2, s[40:43], s72 offen offset:3072 sc1 lds
L_mainh_zs3:
    buffer_load_dwordx4 v2, s[40:43], s72 offen offset:0 sc1 lds
    buffer_load_dwordx4 v2, s[40:43], s72 offen offset:1024 sc1 lds
    s_add_u32 s77, s77, 0x8000
    s_and_b32 s77, s77, 131071
    s_add_u32 s90, s90, 1
    s_waitcnt vmcnt(8)
    s_cmp_eq_u32 s81, 0
    s_cbranch_scc1 L_mainh_zs4
    s_waitcnt vmcnt(4)
L_mainh_zs4:
    s_mov_b32 s76, 29
L_mainh_sl:
    s_barrier
    s_lshl_b32 s72, s89, 7
    s_mov_b32 m0, s73
    s_add_u32 s72, s72, s78
    buffer_load_dwordx4 v240, s[44:47], s72 offen offset:0 lds
    buffer_load_dwordx4 v241, s[44:47], s72 offen offset:1024 lds
    buffer_load_dwordx4 v242, s[44:47], s72 offen offset:2048 lds
    buffer_load_dwordx4 v243, s[44:47], s72 offen offset:3072 lds
    s_add_u32 s73, s73, 0x8000
    s_and_b32 s73, s73, 131071
    s_mul_i32 s72, s89, 229376
    s_mov_b32 m0, s77
    s_add_u32 s72, s72, s79
    s_cmp_eq_u32 s81, 1
    s_cbranch_scc1 L_mainh_zs5
    buffer_load_dwordx4 v2, s[40:43], s72 offen offset:2048 sc1 lds
    buffer_load_dwordx4 v2, s[40:43], s72 offen offset:3072 sc1 lds
L_mainh_zs5:
    buffer_load_dwordx4 v2, s[40:43], s72 offen offset:0 sc1 lds
    buffer_load_dwordx4 v2, s[40:43], s72 offen offset:1024 sc1 lds
    s_add_u32 s77, s77, 0x8000
    s_and_b32 s77, s77, 131071
    s_add_u32 s89, s89, 1
    s_waitcnt vmcnt(12)
    s_cmp_eq_u32 s81, 0
    s_cbranch_scc1 L_mainh_zs6
    s_waitcnt vmcnt(8)
L_mainh_zs6:
    s_sub_u32 s76, s76, 1
    s_cmp_lg_u32 s76, 0
    s_cbranch_scc1 L_mainh_sl
    s_barrier
    s_add_u32 s75, s84, 65536
    buffer_load_dwordx4 v[208:211], v4, s[48:51], s84 offen offset:0
    buffer_load_dwordx4 v[212:215], v5, s[48:51], s84 offen offset:1024
    buffer_load_dwordx4 v[216:219], v6, s[48:51], s84 offen offset:2048
    buffer_load_dwordx4 v[220:223], v7, s[48:51], s84 offen offset:3072
    buffer_load_dwordx4 v[224:227], v4, s[48:51], s75 offen offset:0
    buffer_load_dwordx4 v[228:231], v5, s[48:51], s75 offen offset:1024
    buffer_load_dwordx4 v[232:235], v6, s[48:51], s75 offen offset:2048
    buffer_load_dwordx4 v[236:239], v7, s[48:51], s75 offen offset:3072
    s_add_u32 s84, s84, 0x80000
    s_waitcnt vmcnt(14)
    s_barrier
    s_waitcnt vmcnt(8)
    s_barrier
    v_add_u32 v8, s74, v2
    v_add_u32 v9, 65536, v8
    s_waitcnt vmcnt(0)
    s_barrier
    s_mov_b32 exec_lo, 0
    ds_write_b128 v250, v[244:247]
    s_mov_b32 exec_lo, -1
    ds_write_b128 v8, v[16:19] offset:0
    ds_write_b128 v8, v[20:23] offset:1024
    ds_write_b128 v8, v[24:27] offset:2048
    ds_write_b128 v8, v[28:31] offset:3072
    ds_write_b128 v8, v[32:35] offset:4096
    ds_write_b128 v8, v[36:39] offset:5120
    ds_write_b128 v8, v[40:43] offset:6144
    ds_write_b128 v8, v[44:47] offset:7168
    s_waitcnt lgkmcnt(4)
    ds_write_b128 v8, v[48:51] offset:32768
    ds_write_b128 v8, v[52:55] offset:33792
    ds_write_b128 v8, v[56:59] offset:34816
    ds_write_b128 v8, v[60:63] offset:35840
    ds_write_b128 v8, v[64:67] offset:36864
    ds_write_b128 v8, v[68:71] offset:37888
    ds_write_b128 v8, v[72:75] offset:38912
    ds_write_b128 v8, v[76:79] offset:39936
    s_waitcnt lgkmcnt(4)
    s_waitcnt lgkmcnt(0)
    s_barrier
    s_cmp_eq_u32 s3, 4
    s_cbranch_scc0 L_mainh_role15
    s_lshl_b32 s54, s96, 1
    s_lshl_b32 s52, s54, 9
    s_add_u32 s52, s52, 0x14c000
    v_lshlrev_b32 v14, 7, v1
    s_mov_b64 exec, 15
    s_mov_b32 s53, 0x8000
L_mainh_py:
    v_mov_b32 v13, 0
    buffer_atomic_add v13, v14, s[36:39], s52 offen sc0 sc1
    s_waitcnt vmcnt(0)
L_mainh_pyc:
    v_cmp_ne_u32 vcc, 7, v13
    s_sub_u32 s53, s53, 1
    s_cbranch_scc1 L_mainh_pyx
    s_cbranch_vccnz L_mainh_py
L_mainh_pyx:
    s_mov_b64 exec, -1
L_mainh_role15:
    s_barrier
    ds_write_b128 v9, v[80:83] offset:0
    ds_write_b128 v9, v[84:87] offset:1024
    ds_write_b128 v9, v[88:91] offset:2048
    ds_write_b128 v9, v[92:95] offset:3072
    ds_write_b128 v9, v[96:99] offset:4096
    ds_write_b128 v9, v[100:103] offset:5120
    ds_write_b128 v9, v[104:107] offset:6144
    ds_write_b128 v9, v[108:111] offset:7168
    s_waitcnt lgkmcnt(4)
    ds_write_b128 v9, v[112:115] offset:32768
    ds_write_b128 v9, v[116:119] offset:33792
    ds_write_b128 v9, v[120:123] offset:34816
    ds_write_b128 v9, v[124:127] offset:35840
    ds_write_b128 v9, v[128:131] offset:36864
    ds_write_b128 v9, v[132:135] offset:37888
    ds_write_b128 v9, v[136:139] offset:38912
    ds_write_b128 v9, v[140:143] offset:39936
    s_waitcnt lgkmcnt(4)
    s_waitcnt lgkmcnt(0)
    s_barrier
    s_cmp_eq_u32 s3, 4
    s_cbranch_scc0 L_mainh_role16
    s_add_u32 s54, s54, 1
    s_lshl_b32 s52, s54, 9
    s_add_u32 s52, s52, 0x14c000
    v_lshlrev_b32 v14, 7, v1
    s_mov_b64 exec, 15
    s_mov_b32 s53, 0x8000
L_mainh_pw:
    v_mov_b32 v13, 0
    buffer_atomic_add v13, v14, s[36:39], s52 offen sc0 sc1
    s_waitcnt vmcnt(0)
L_mainh_pwc:
    v_cmp_ne_u32 vcc, 7, v13
    s_sub_u32 s53, s53, 1
    s_cbranch_scc1 L_mainh_pwx
    s_cbranch_vccnz L_mainh_pw
L_mainh_pwx:
    s_mov_b64 exec, -1
L_mainh_role16:
    s_barrier
    ds_write_b128 v8, v[144:147] offset:0
    ds_write_b128 v8, v[148:151] offset:1024
    ds_write_b128 v8, v[152:155] offset:2048
    ds_write_b128 v8, v[156:159] offset:3072
    ds_write_b128 v8, v[160:163] offset:4096
    ds_write_b128 v8, v[164:167] offset:5120
    ds_write_b128 v8, v[168:171] offset:6144
    ds_write_b128 v8, v[172:175] offset:7168
    s_waitcnt lgkmcnt(4)
    s_waitcnt lgkmcnt(0)
    s_barrier
    ds_write_b128 v8, v[176:179] offset:32768
    ds_write_b128 v8, v[180:183] offset:33792
    ds_write_b128 v8, v[184:187] offset:34816
    ds_write_b128 v8, v[188:191] offset:35840
    ds_write_b128 v8, v[192:195] offset:36864
    ds_write_b128 v8, v[196:199] offset:37888
    ds_write_b128 v8, v[200:203] offset:38912
    ds_write_b128 v8, v[204:207] offset:39936
    s_waitcnt lgkmcnt(4)
    s_waitcnt lgkmcnt(0)
    s_barrier
    ds_write_b128 v9, v[208:211] offset:0
    ds_write_b128 v9, v[212:215] offset:1024
    ds_write_b128 v9, v[216:219] offset:2048
    ds_write_b128 v9, v[220:223] offset:3072
    ds_write_b128 v9, v[224:227] offset:4096
    ds_write_b128 v9, v[228:231] offset:5120
    ds_write_b128 v9, v[232:235] offset:6144
    ds_write_b128 v9, v[236:239] offset:7168
    s_waitcnt lgkmcnt(4)
    s_waitcnt lgkmcnt(0)
    s_barrier
    s_barrier
    s_branch L_main_end
L_mainc_redo:
    s_nop 15
    s_mov_b32 s54, 0
    v_mov_b32 v9, 0xff800000
    v_mov_b32 v10, 0xff800000
L_mainc_mx:
    buffer_load_dwordx4 v[184:187], v2, s[48:51], s54 offen sc1
    buffer_load_dwordx4 v[188:191], v2, s[48:51], s54 offen offset:1024 sc1
    s_waitcnt vmcnt(0)
    v_mfma_f32_32x32x16_bf16 v[96:111], v[184:187], v[48:51], 0
    v_mfma_f32_32x32x16_bf16 v[96:111], v[188:191], v[52:55], v[96:111]
    v_mfma_f32_32x32x16_bf16 v[112:127], v[184:187], v[56:59], 0
    v_mfma_f32_32x32x16_bf16 v[112:127], v[188:191], v[60:63], v[112:127]
    s_nop 15
    v_max3_f32 v9, v9, v96, v97
    v_max3_f32 v9, v9, v98, v99
    v_max3_f32 v9, v9, v100, v101
    v_max3_f32 v9, v9, v102, v103
    v_max3_f32 v9, v9, v104, v105
    v_max3_f32 v9, v9, v106, v107
    v_max3_f32 v9, v9, v108, v109
    v_max3_f32 v9, v9, v110, v111
    v_max3_f32 v10, v10, v112, v113
    v_max3_f32 v10, v10, v114, v115
    v_max3_f32 v10, v10, v116, v117
    v_max3_f32 v10, v10, v118, v119
    v_max3_f32 v10, v10, v120, v121
    v_max3_f32 v10, v10, v122, v123
    v_max3_f32 v10, v10, v124, v125
    v_max3_f32 v10, v10, v126, v127
    s_add_u32 s54, s54, 4096
    s_cmp_lt_u32 s54, 262144
    s_cbranch_scc1 L_mainc_mx
    v_mov_b32 v11, v9
    v_mov_b32 v12, v10
    s_nop 0
    v_permlane32_swap_b32 v11, v9
    v_permlane32_swap_b32 v12, v10
    s_nop 0
    v_max_f32 v9, v9, v11
    v_max_f32 v10, v10, v12
    v_sub_f32 v64, 0, v9
    v_sub_f32 v80, 0, v10
    v_mov_b32 v144, 0
    v_mov_b32 v160, 0
    v_sub_f32 v65, 0, v9
    v_sub_f32 v81, 0, v10
    v_mov_b32 v145, 0
    v_mov_b32 v161, 0
    v_sub_f32 v66, 0, v9
    v_sub_f32 v82, 0, v10
    v_mov_b32 v146, 0
    v_mov_b32 v162, 0
    v_sub_f32 v67, 0, v9
    v_sub_f32 v83, 0, v10
    v_mov_b32 v147, 0
    v_mov_b32 v163, 0
    v_sub_f32 v68, 0, v9
    v_sub_f32 v84, 0, v10
    v_mov_b32 v148, 0
    v_mov_b32 v164, 0
    v_sub_f32 v69, 0, v9
    v_sub_f32 v85, 0, v10
    v_mov_b32 v149, 0
    v_mov_b32 v165, 0
    v_sub_f32 v70, 0, v9
    v_sub_f32 v86, 0, v10
    v_mov_b32 v150, 0
    v_mov_b32 v166, 0
    v_sub_f32 v71, 0, v9
    v_sub_f32 v87, 0, v10
    v_mov_b32 v151, 0
    v_mov_b32 v167, 0
    v_sub_f32 v72, 0, v9
    v_sub_f32 v88, 0, v10
    v_mov_b32 v152, 0
    v_mov_b32 v168, 0
    v_sub_f32 v73, 0, v9
    v_sub_f32 v89, 0, v10
    v_mov_b32 v153, 0
    v_mov_b32 v169, 0
    v_sub_f32 v74, 0, v9
    v_sub_f32 v90, 0, v10
    v_mov_b32 v154, 0
    v_mov_b32 v170, 0
    v_sub_f32 v75, 0, v9
    v_sub_f32 v91, 0, v10
    v_mov_b32 v155, 0
    v_mov_b32 v171, 0
    v_sub_f32 v76, 0, v9
    v_sub_f32 v92, 0, v10
    v_mov_b32 v156, 0
    v_mov_b32 v172, 0
    v_sub_f32 v77, 0, v9
    v_sub_f32 v93, 0, v10
    v_mov_b32 v157, 0
    v_mov_b32 v173, 0
    v_sub_f32 v78, 0, v9
    v_sub_f32 v94, 0, v10
    v_mov_b32 v158, 0
    v_mov_b32 v174, 0
    v_sub_f32 v79, 0, v9
    v_sub_f32 v95, 0, v10
    v_mov_b32 v159, 0
    v_mov_b32 v175, 0
    v_mov_b32 v176, 0
    v_mov_b32 v177, 0
    v_mov_b32 v178, 0
    v_mov_b32 v179, 0
    v_mov_b32 v180, 0
    v_mov_b32 v181, 0
    v_mov_b32 v182, 0
    v_mov_b32 v183, 0
    s_mov_b32 s54, 0
L_mainc_pl:
    s_add_u32 s55, s54, 253952
    s_and_b32 s55, s55, 0x3ffff
    buffer_load_dwordx4 v[184:187], v2, s[48:51], s55 offen sc1
    buffer_load_dwordx4 v[188:191], v2, s[48:51], s55 offen offset:1024 sc1
    buffer_load_dwordx4 v[200:203], v2, s[48:51], s54 offen offset:2048 sc1
    buffer_load_dwordx4 v[204:207], v2, s[48:51], s54 offen offset:3072 sc1
    s_waitcnt vmcnt(0)
    v_mfma_f32_32x32x16_bf16 v[96:111], v[184:187], v[48:51], v[64:79]
    v_mfma_f32_32x32x16_bf16 v[96:111], v[188:191], v[52:55], v[96:111]
    v_mfma_f32_32x32x16_bf16 v[112:127], v[184:187], v[56:59], v[80:95]
    v_mfma_f32_32x32x16_bf16 v[112:127], v[188:191], v[60:63], v[112:127]
    s_nop 15
    v_exp_f32 v96, v96
    v_exp_f32 v97, v97
    v_exp_f32 v98, v98
    v_exp_f32 v99, v99
    v_exp_f32 v100, v100
    v_exp_f32 v101, v101
    v_exp_f32 v102, v102
    v_exp_f32 v103, v103
    v_exp_f32 v104, v104
    v_exp_f32 v105, v105
    v_exp_f32 v106, v106
    v_exp_f32 v107, v107
    v_exp_f32 v108, v108
    v_exp_f32 v109, v109
    v_exp_f32 v110, v110
    v_exp_f32 v111, v111
    v_exp_f32 v112, v112
    v_exp_f32 v113, v113
    v_exp_f32 v114, v114
    v_exp_f32 v115, v115
    v_exp_f32 v116, v116
    v_exp_f32 v117, v117
    v_exp_f32 v118, v118
    v_exp_f32 v119, v119
    v_exp_f32 v120, v120
    v_exp_f32 v121, v121
    v_exp_f32 v122, v122
    v_exp_f32 v123, v123
    v_exp_f32 v124, v124
    v_exp_f32 v125, v125
    v_exp_f32 v126, v126
    v_exp_f32 v127, v127
    s_nop 1
    v_smfmac_f32_32x32x32_bf16 v[144:159], v[200:203], v[96:103], v212
    v_smfmac_f32_16x16x64_bf16 v[176:179], v[208:211], v[96:103], v212
    v_smfmac_f32_32x32x32_bf16 v[144:159], v[204:207], v[104:111], v212
    v_smfmac_f32_16x16x64_bf16 v[176:179], v[208:211], v[104:111], v212
    v_smfmac_f32_32x32x32_bf16 v[160:175], v[200:203], v[112:119], v212
    v_smfmac_f32_16x16x64_bf16 v[180:183], v[208:211], v[112:119], v212
    v_smfmac_f32_32x32x32_bf16 v[160:175], v[204:207], v[120:127], v212
    v_smfmac_f32_16x16x64_bf16 v[180:183], v[208:211], v[120:127], v212
    s_add_u32 s54, s54, 4096
    s_cmp_lt_u32 s54, 262144
    s_nop 15
    s_cbranch_scc1 L_mainc_pl
    s_cmp_eq_u32 s75, 0
    s_cbranch_scc1 L_mainc_rb
    v_rcp_f32 v10, v176
    s_nop 0
    v_pk_mul_f32 v[144:145], v[144:145], v[10:11] op_sel_hi:[1,0]
    v_pk_mul_f32 v[146:147], v[146:147], v[10:11] op_sel_hi:[1,0]
    v_pk_mul_f32 v[148:149], v[148:149], v[10:11] op_sel_hi:[1,0]
    v_pk_mul_f32 v[150:151], v[150:151], v[10:11] op_sel_hi:[1,0]
    v_cvt_pk_bf16_f32 v32, v144, v145
    v_cvt_pk_bf16_f32 v33, v146, v147
    v_cvt_pk_bf16_f32 v34, v148, v149
    v_cvt_pk_bf16_f32 v35, v150, v151
    buffer_store_dwordx4 v[32:35], v245, s[36:39], s78 offen offset:0 sc1
    v_pk_mul_f32 v[152:153], v[152:153], v[10:11] op_sel_hi:[1,0]
    v_pk_mul_f32 v[154:155], v[154:155], v[10:11] op_sel_hi:[1,0]
    v_pk_mul_f32 v[156:157], v[156:157], v[10:11] op_sel_hi:[1,0]
    v_pk_mul_f32 v[158:159], v[158:159], v[10:11] op_sel_hi:[1,0]
    v_cvt_pk_bf16_f32 v36, v152, v153
    v_cvt_pk_bf16_f32 v37, v154, v155
    v_cvt_pk_bf16_f32 v38, v156, v157
    v_cvt_pk_bf16_f32 v39, v158, v159
    buffer_store_dwordx4 v[36:39], v245, s[36:39], s78 offen offset:512 sc1
    s_lshl_b32 s81, s82, 2
    s_add_u32 s81, s81, s3
    s_lshl_b32 s81, s81, 7
    s_add_u32 s81, s81, 0x140000
    v_mov_b32 v6, 1
    s_waitcnt vmcnt(0)
    s_mov_b64 exec, 1
    buffer_atomic_add v6, v2, s[36:39], s81 offen sc1
    s_mov_b64 exec, -1
L_mainc_rb:
    v_rcp_f32 v10, v180
    s_branch L_mainc_fin
L_mainn_go:
    s_barrier
    s_barrier
    ds_read_b128 v[80:83], v4 offset:0
    ds_read_b64_tr_b16 v[96:97], v6 offset:0
    ds_read_b64_tr_b16 v[98:99], v6 offset:256
    ds_read_b128 v[84:87], v4 offset:2048
    ds_read_b128 v[88:91], v4 offset:4096
    ds_read_b128 v[92:95], v4 offset:6144
    ds_read_b64_tr_b16 v[100:101], v6 offset:1024
    ds_read_b64_tr_b16 v[102:103], v6 offset:1280
L_mainn_sl:
    s_waitcnt lgkmcnt(0)
    v_mfma_f32_16x16x32_bf16 v[16:19], v[96:99], v[80:83], v[16:19]
    ds_read_b128 v[112:115], v5 offset:0
    v_mfma_f32_16x16x32_bf16 v[20:23], v[96:99], v[84:87], v[20:23]
    ds_read_b64_tr_b16 v[128:129], v6 offset:8192
    v_mfma_f32_16x16x32_bf16 v[24:27], v[96:99], v[88:91], v[24:27]
    ds_read_b64_tr_b16 v[130:131], v6 offset:8448
    v_mfma_f32_16x16x32_bf16 v[28:31], v[96:99], v[92:95], v[28:31]
    ds_read_b128 v[116:119], v5 offset:2048
    v_mfma_f32_16x16x32_bf16 v[32:35], v[100:103], v[80:83], v[32:35]
    ds_read_b128 v[120:123], v5 offset:4096
    v_mfma_f32_16x16x32_bf16 v[36:39], v[100:103], v[84:87], v[36:39]
    ds_read_b128 v[124:127], v5 offset:6144
    v_mfma_f32_16x16x32_bf16 v[40:43], v[100:103], v[88:91], v[40:43]
    ds_read_b64_tr_b16 v[132:133], v6 offset:9216
    v_mfma_f32_16x16x32_bf16 v[44:47], v[100:103], v[92:95], v[44:47]
    ds_read_b64_tr_b16 v[134:135], v6 offset:9472
    s_waitcnt lgkmcnt(0)
    v_mfma_f32_16x16x32_bf16 v[16:19], v[128:131], v[112:115], v[16:19]
    s_waitcnt lgkmcnt(0)
    v_mfma_f32_16x16x32_bf16 v[20:23], v[128:131], v[116:119], v[20:23]
    s_barrier
    v_mfma_f32_16x16x32_bf16 v[24:27], v[128:131], v[120:123], v[24:27]
    ds_read_b128 v[80:83], v4 offset:32768
    v_mfma_f32_16x16x32_bf16 v[28:31], v[128:131], v[124:127], v[28:31]
    ds_read_b64_tr_b16 v[96:97], v6 offset:32768
    v_mfma_f32_16x16x32_bf16 v[32:35], v[132:135], v[112:115], v[32:35]
    ds_read_b64_tr_b16 v[98:99], v6 offset:33024
    v_mfma_f32_16x16x32_bf16 v[36:39], v[132:135], v[116:119], v[36:39]
    ds_read_b128 v[84:87], v4 offset:34816
    v_mfma_f32_16x16x32_bf16 v[40:43], v[132:135], v[120:123], v[40:43]
    ds_read_b128 v[88:91], v4 offset:36864
    v_mfma_f32_16x16x32_bf16 v[44:47], v[132:135], v[124:127], v[44:47]
    ds_read_b128 v[92:95], v4 offset:38912
    ds_read_b64_tr_b16 v[100:101], v6 offset:33792
    ds_read_b64_tr_b16 v[102:103], v6 offset:34048
    s_sub_u32 s73, s73, 1
    s_waitcnt lgkmcnt(0)
    v_mfma_f32_16x16x32_bf16 v[16:19], v[96:99], v[80:83], v[16:19]
    ds_read_b128 v[112:115], v5 offset:32768
    v_mfma_f32_16x16x32_bf16 v[20:23], v[96:99], v[84:87], v[20:23]
    ds_read_b64_tr_b16 v[128:129], v6 offset:40960
    v_mfma_f32_16x16x32_bf16 v[24:27], v[96:99], v[88:91], v[24:27]
    ds_read_b64_tr_b16 v[130:131], v6 offset:41216
    v_mfma_f32_16x16x32_bf16 v[28:31], v[96:99], v[92:95], v[28:31]
    ds_read_b128 v[116:119], v5 offset:34816
    v_mfma_f32_16x16x32_bf16 v[32:35], v[100:103], v[80:83], v[32:35]
    ds_read_b128 v[120:123], v5 offset:36864
    v_mfma_f32_16x16x32_bf16 v[36:39], v[100:103], v[84:87], v[36:39]
    ds_read_b128 v[124:127], v5 offset:38912
    v_mfma_f32_16x16x32_bf16 v[40:43], v[100:103], v[88:91], v[40:43]
    ds_read_b64_tr_b16 v[132:133], v6 offset:41984
    v_mfma_f32_16x16x32_bf16 v[44:47], v[100:103], v[92:95], v[44:47]
    ds_read_b64_tr_b16 v[134:135], v6 offset:42240
    v_xor_b32 v4, 0x10000, v4
    v_xor_b32 v5, 0x10000, v5
    v_xor_b32 v6, 0x10000, v6
    s_waitcnt lgkmcnt(0)
    v_mfma_f32_16x16x32_bf16 v[16:19], v[128:131], v[112:115], v[16:19]
    s_waitcnt lgkmcnt(0)
    v_mfma_f32_16x16x32_bf16 v[20:23], v[128:131], v[116:119], v[20:23]
    s_barrier
    v_mfma_f32_16x16x32_bf16 v[24:27], v[128:131], v[120:123], v[24:27]
    ds_read_b128 v[80:83], v4 offset:0
    v_mfma_f32_16x16x32_bf16 v[28:31], v[128:131], v[124:127], v[28:31]
    ds_read_b64_tr_b16 v[96:97], v6 offset:0
    v_mfma_f32_16x16x32_bf16 v[32:35], v[132:135], v[112:115], v[32:35]
    ds_read_b64_tr_b16 v[98:99], v6 offset:256
    v_mfma_f32_16x16x32_bf16 v[36:39], v[132:135], v[116:119], v[36:39]
    ds_read_b128 v[84:87], v4 offset:2048
    v_mfma_f32_16x16x32_bf16 v[40:43], v[132:135], v[120:123], v[40:43]
    ds_read_b128 v[88:91], v4 offset:4096
    v_mfma_f32_16x16x32_bf16 v[44:47], v[132:135], v[124:127], v[44:47]
    ds_read_b128 v[92:95], v4 offset:6144
    ds_read_b64_tr_b16 v[100:101], v6 offset:1024
    ds_read_b64_tr_b16 v[102:103], v6 offset:1280
    s_cmp_lg_u32 s73, 0
    s_cbranch_scc1 L_mainn_sl
    s_waitcnt lgkmcnt(0)
    v_mfma_f32_16x16x32_bf16 v[16:19], v[96:99], v[80:83], v[16:19]
    ds_read_b128 v[112:115], v5 offset:0
    v_mfma_f32_16x16x32_bf16 v[20:23], v[96:99], v[84:87], v[20:23]
    ds_read_b64_tr_b16 v[128:129], v6 offset:8192
    v_mfma_f32_16x16x32_bf16 v[24:27], v[96:99], v[88:91], v[24:27]
    ds_read_b64_tr_b16 v[130:131], v6 offset:8448
    v_mfma_f32_16x16x32_bf16 v[28:31], v[96:99], v[92:95], v[28:31]
    ds_read_b128 v[116:119], v5 offset:2048
    v_mfma_f32_16x16x32_bf16 v[32:35], v[100:103], v[80:83], v[32:35]
    ds_read_b128 v[120:123], v5 offset:4096
    v_mfma_f32_16x16x32_bf16 v[36:39], v[100:103], v[84:87], v[36:39]
    ds_read_b128 v[124:127], v5 offset:6144
    v_mfma_f32_16x16x32_bf16 v[40:43], v[100:103], v[88:91], v[40:43]
    ds_read_b64_tr_b16 v[132:133], v6 offset:9216
    v_mfma_f32_16x16x32_bf16 v[44:47], v[100:103], v[92:95], v[44:47]
    ds_read_b64_tr_b16 v[134:135], v6 offset:9472
    s_waitcnt lgkmcnt(8)
    ds_read_b128 v[144:147], v7 offset:0
    ds_read_b128 v[152:155], v7 offset:1024
    s_waitcnt lgkmcnt(0)
    v_mfma_f32_16x16x32_bf16 v[16:19], v[128:131], v[112:115], v[16:19]
    s_waitcnt lgkmcnt(0)
    v_mfma_f32_16x16x32_bf16 v[20:23], v[128:131], v[116:119], v[20:23]
    s_barrier
    v_mfma_f32_16x16x32_bf16 v[24:27], v[128:131], v[120:123], v[24:27]
    ds_read_b128 v[80:83], v4 offset:32768
    v_mfma_f32_16x16x32_bf16 v[28:31], v[128:131], v[124:127], v[28:31]
    ds_read_b64_tr_b16 v[96:97], v6 offset:32768
    v_mfma_f32_16x16x32_bf16 v[32:35], v[132:135], v[112:115], v[32:35]
    ds_read_b64_tr_b16 v[98:99], v6 offset:33024
    v_mfma_f32_16x16x32_bf16 v[36:39], v[132:135], v[116:119], v[36:39]
    ds_read_b128 v[84:87], v4 offset:34816
    v_mfma_f32_16x16x32_bf16 v[40:43], v[132:135], v[120:123], v[40:43]
    ds_read_b128 v[88:91], v4 offset:36864
    v_mfma_f32_16x16x32_bf16 v[44:47], v[132:135], v[124:127], v[44:47]
    ds_read_b128 v[92:95], v4 offset:38912
    ds_read_b64_tr_b16 v[100:101], v6 offset:33792
    ds_read_b64_tr_b16 v[102:103], v6 offset:34048
    s_waitcnt lgkmcnt(0)
    v_mfma_f32_16x16x32_bf16 v[16:19], v[96:99], v[80:83], v[16:19]
    ds_read_b128 v[112:115], v5 offset:32768
    v_mfma_f32_16x16x32_bf16 v[20:23], v[96:99], v[84:87], v[20:23]
    ds_read_b64_tr_b16 v[128:129], v6 offset:40960
    v_mfma_f32_16x16x32_bf16 v[24:27], v[96:99], v[88:91], v[24:27]
    ds_read_b64_tr_b16 v[130:131], v6 offset:41216
    v_mfma_f32_16x16x32_bf16 v[28:31], v[96:99], v[92:95], v[28:31]
    ds_read_b128 v[116:119], v5 offset:34816
    v_mfma_f32_16x16x32_bf16 v[32:35], v[100:103], v[80:83], v[32:35]
    ds_read_b128 v[120:123], v5 offset:36864
    v_mfma_f32_16x16x32_bf16 v[36:39], v[100:103], v[84:87], v[36:39]
    ds_read_b128 v[124:127], v5 offset:38912
    v_mfma_f32_16x16x32_bf16 v[40:43], v[100:103], v[88:91], v[40:43]
    ds_read_b64_tr_b16 v[132:133], v6 offset:41984
    v_mfma_f32_16x16x32_bf16 v[44:47], v[100:103], v[92:95], v[44:47]
    ds_read_b64_tr_b16 v[134:135], v6 offset:42240
    s_waitcnt lgkmcnt(8)
    ds_read_b128 v[160:163], v7 offset:8192
    ds_read_b128 v[168:171], v7 offset:9216
    s_waitcnt lgkmcnt(0)
    s_barrier
    v_mfma_f32_16x16x32_bf16 v[16:19], v[128:131], v[112:115], v[16:19]
    v_lshlrev_b32 v80, 16, v144
    v_and_b32 v81, 0xffff0000, v144
    v_mfma_f32_16x16x32_bf16 v[20:23], v[128:131], v[116:119], v[20:23]
    v_lshlrev_b32 v82, 16, v145
    v_and_b32 v83, 0xffff0000, v145
    v_mfma_f32_16x16x32_bf16 v[24:27], v[128:131], v[120:123], v[24:27]
    v_lshlrev_b32 v84, 16, v146
    v_and_b32 v85, 0xffff0000, v146
    v_mfma_f32_16x16x32_bf16 v[28:31], v[128:131], v[124:127], v[28:31]
    v_lshlrev_b32 v86, 16, v147
    v_and_b32 v87, 0xffff0000, v147
    v_mfma_f32_16x16x32_bf16 v[32:35], v[132:135], v[112:115], v[32:35]
    v_lshlrev_b32 v96, 16, v152
    v_and_b32 v97, 0xffff0000, v152
    v_mfma_f32_16x16x32_bf16 v[36:39], v[132:135], v[116:119], v[36:39]
    v_lshlrev_b32 v98, 16, v153
    v_and_b32 v99, 0xffff0000, v153
    v_mfma_f32_16x16x32_bf16 v[40:43], v[132:135], v[120:123], v[40:43]
    v_lshlrev_b32 v100, 16, v154
    v_and_b32 v101, 0xffff0000, v154
    v_mfma_f32_16x16x32_bf16 v[44:47], v[132:135], v[124:127], v[44:47]
    v_lshlrev_b32 v102, 16, v155
    v_and_b32 v103, 0xffff0000, v155
    v_lshlrev_b32 v176, 16, v160
    v_and_b32 v177, 0xffff0000, v160
    v_lshlrev_b32 v178, 16, v161
    v_and_b32 v179, 0xffff0000, v161
    v_lshlrev_b32 v180, 16, v162
    v_and_b32 v181, 0xffff0000, v162
    v_lshlrev_b32 v182, 16, v163
    v_and_b32 v183, 0xffff0000, v163
    v_lshlrev_b32 v192, 16, v168
    v_and_b32 v193, 0xffff0000, v168
    v_lshlrev_b32 v194, 16, v169
    v_and_b32 v195, 0xffff0000, v169
    v_lshlrev_b32 v196, 16, v170
    v_and_b32 v197, 0xffff0000, v170
    v_lshlrev_b32 v198, 16, v171
    v_and_b32 v199, 0xffff0000, v171
    v_pk_mul_f32 v[16:17], v[16:17], v[80:81]
    v_pk_mul_f32 v[18:19], v[18:19], v[82:83]
    v_pk_mul_f32 v[32:33], v[32:33], v[84:85]
    v_pk_mul_f32 v[34:35], v[34:35], v[86:87]
    v_cvt_pk_bf16_f32 v144, v16, v17
    v_cvt_pk_bf16_f32 v145, v18, v19
    v_cvt_pk_bf16_f32 v146, v32, v33
    v_cvt_pk_bf16_f32 v147, v34, v35
    buffer_store_dwordx4 v[144:147], v2, s[36:39], s58 offen offset:0 sc1
    v_pk_mul_f32 v[20:21], v[20:21], v[96:97]
    v_pk_mul_f32 v[22:23], v[22:23], v[98:99]
    v_pk_mul_f32 v[36:37], v[36:37], v[100:101]
    v_pk_mul_f32 v[38:39], v[38:39], v[102:103]
    v_cvt_pk_bf16_f32 v152, v20, v21
    v_cvt_pk_bf16_f32 v153, v22, v23
    v_cvt_pk_bf16_f32 v154, v36, v37
    v_cvt_pk_bf16_f32 v155, v38, v39
    buffer_store_dwordx4 v[152:155], v2, s[36:39], s58 offen offset:1024 sc1
    v_pk_mul_f32 v[24:25], v[24:25], v[176:177]
    v_pk_mul_f32 v[26:27], v[26:27], v[178:179]
    v_pk_mul_f32 v[40:41], v[40:41], v[180:181]
    v_pk_mul_f32 v[42:43], v[42:43], v[182:183]
    v_cvt_pk_bf16_f32 v160, v24, v25
    v_cvt_pk_bf16_f32 v161, v26, v27
    v_cvt_pk_bf16_f32 v162, v40, v41
    v_cvt_pk_bf16_f32 v163, v42, v43
    buffer_store_dwordx4 v[160:163], v2, s[36:39], s59 offen offset:0 sc1
    v_pk_mul_f32 v[28:29], v[28:29], v[192:193]
    v_pk_mul_f32 v[30:31], v[30:31], v[194:195]
    v_pk_mul_f32 v[44:45], v[44:45], v[196:197]
    v_pk_mul_f32 v[46:47], v[46:47], v[198:199]
    v_cvt_pk_bf16_f32 v168, v28, v29
    v_cvt_pk_bf16_f32 v169, v30, v31
    v_cvt_pk_bf16_f32 v170, v44, v45
    v_cvt_pk_bf16_f32 v171, v46, v47
    buffer_store_dwordx4 v[168:171], v2, s[36:39], s59 offen offset:1024 sc1
    s_branch L_mainc_sy
L_mainc_go:
    s_waitcnt lgkmcnt(0)
    s_mov_b32 s36, s32
    s_mov_b32 s37, s33
    s_mov_b32 s38, 0x2300000
    s_mov_b32 s39, 0x00020000
    s_lshl_b32 s52, s2, 2
    s_add_u32 s52, s52, s3
    s_cmp_lg_u32 s52, 128
    s_cbranch_scc1 L_mainc_non
    s_mov_b32 s40, s30
    s_mov_b32 s41, s31
    s_mov_b32 s42, 0x100
    s_mov_b32 s43, 0x00020000
    v_mov_b32 v8, 0
    v_mov_b32 v9, 0
    v_mov_b32 v10, 0
    v_mov_b32 v11, 0
    v_mov_b32 v12, -1
    v_mov_b32 v13, -1
    v_mov_b32 v14, -1
    v_mov_b32 v15, -1
    s_mov_b32 s52, 0x160000
    buffer_store_dwordx4 v[8:11], v2, s[36:39], s52 offen offset:0 sc1
    buffer_store_dwordx4 v[8:11], v2, s[36:39], s52 offen offset:1024 sc1
    buffer_store_dwordx4 v[8:11], v2, s[36:39], s52 offen offset:2048 sc1
    buffer_store_dwordx4 v[8:11], v2, s[36:39], s52 offen offset:3072 sc1
    s_mov_b32 s52, 0x161000
    buffer_store_dwordx4 v[8:11], v2, s[36:39], s52 offen offset:0 sc1
    buffer_store_dwordx4 v[8:11], v2, s[36:39], s52 offen offset:1024 sc1
    buffer_store_dwordx4 v[8:11], v2, s[36:39], s52 offen offset:2048 sc1
    buffer_store_dwordx4 v[8:11], v2, s[36:39], s52 offen offset:3072 sc1
    s_mov_b32 s52, 0x162000
    buffer_store_dwordx4 v[8:11], v2, s[36:39], s52 offen offset:0 sc1
    buffer_store_dwordx4 v[8:11], v2, s[36:39], s52 offen offset:1024 sc1
    buffer_store_dwordx4 v[8:11], v2, s[36:39], s52 offen offset:2048 sc1
    buffer_store_dwordx4 v[8:11], v2, s[36:39], s52 offen offset:3072 sc1
    s_mov_b32 s52, 0x163000
    buffer_store_dwordx4 v[8:11], v2, s[36:39], s52 offen offset:0 sc1
    buffer_store_dwordx4 v[8:11], v2, s[36:39], s52 offen offset:1024 sc1
    buffer_store_dwordx4 v[8:11], v2, s[36:39], s52 offen offset:2048 sc1
    buffer_store_dwordx4 v[8:11], v2, s[36:39], s52 offen offset:3072 sc1
    s_mov_b32 s52, 0x154000
    buffer_store_dwordx4 v[12:15], v2, s[36:39], s52 offen offset:0 sc1
    buffer_store_dwordx4 v[12:15], v2, s[36:39], s52 offen offset:1024 sc1
    buffer_store_dwordx4 v[12:15], v2, s[36:39], s52 offen offset:2048 sc1
    buffer_store_dwordx4 v[12:15], v2, s[36:39], s52 offen offset:3072 sc1
    s_mov_b32 s52, 0x155000
    buffer_store_dwordx4 v[12:15], v2, s[36:39], s52 offen offset:0 sc1
    buffer_store_dwordx4 v[12:15], v2, s[36:39], s52 offen offset:1024 sc1
    buffer_store_dwordx4 v[12:15], v2, s[36:39], s52 offen offset:2048 sc1
    buffer_store_dwordx4 v[12:15], v2, s[36:39], s52 offen offset:3072 sc1
    s_mov_b32 s52, 0x156000
    buffer_store_dwordx4 v[12:15], v2, s[36:39], s52 offen offset:0 sc1
    s_waitcnt vmcnt(0)
    s_mov_b64 exec, 1
    buffer_store_dword v12, v2, s[40:43], 0 offen sc1
    s_mov_b64 exec, -1
L_mainc_non:
    s_and_b32 s52, s35, 1
    s_or_b32 s52, s52, s3
    s_cbranch_scc1 L_mainc_inv
    s_lshl_b32 s52, s34, 3
    s_lshr_b32 s53, s35, 1
    s_add_u32 s52, s52, s53
    s_lshl_b32 s52, s52, 8
    s_add_u32 s52, s52, 0x8000
    v_mov_b32 v8, -1
    v_lshlrev_b32 v9, 2, v1
    buffer_store_dword v8, v9, s[36:39], s52 offen sc1
L_mainc_inv:
    s_mov_b32 s40, s4
    s_mov_b32 s41, s5
    s_mov_b32 s42, 0x400000
    s_mov_b32 s43, 0x00020000
    s_lshl_b32 s54, s34, 3
    s_lshr_b32 s55, s35, 1
    s_add_u32 s54, s54, s55
    s_and_b32 s55, s35, 1
    v_lshrrev_b32 v5, 5, v1
    v_xor_b32 v6, v5, v1
    v_and_b32 v6, 31, v6
    v_lshlrev_b32 v7, 11, v5
    v_lshl_add_u32 v7, v6, 4, v7
    s_lshl_b32 s52, s54, 15
    s_lshl_b32 s53, s3, 9
    s_add_u32 s52, s52, s53
    s_lshl_b32 s56, s3, 13
    s_mov_b32 s53, s56
    s_lshl_b32 s57, s3, 14
    s_add_u32 s57, s57, 98304
    s_lshl_b32 s58, s3, 11
    s_add_u32 s58, s58, 90112
    s_lshl_b32 s59, s55, 9
    v_xor_b32 v5, s59, v2
    v_add_u32 v5, s58, v5
    v_and_b32 v3, 15, v1
    v_lshrrev_b32 v4, 4, v1
    v_xor_b32 v10, v3, v4
    v_lshlrev_b32 v10, 4, v10
    v_lshl_add_u32 v10, v3, 9, v10
    v_add_u32 v10, s56, v10
    s_lshl_b32 s59, s55, 8
    v_xor_b32 v10, s59, v10
    v_lshrrev_b32 v12, 4, v1
    v_lshlrev_b32 v12, 3, v12
    v_bfe_u32 v13, v1, 2, 2
    v_add_u32 v12, v12, v13
    v_lshlrev_b32 v12, 6, v12
    v_and_b32 v13, 1, v4
    v_lshl_add_u32 v12, v13, 5, v12
    v_and_b32 v13, 3, v1
    v_lshl_add_u32 v12, v13, 3, v12
    v_add_u32 v12, s57, v12
    v_xor_b32 v13, 32, v12
    v_pk_mov_b32 v[144:145], 0, 0
    v_pk_mov_b32 v[146:147], 0, 0
    v_pk_mov_b32 v[148:149], 0, 0
    v_pk_mov_b32 v[150:151], 0, 0
    v_pk_mov_b32 v[152:153], 0, 0
    v_pk_mov_b32 v[154:155], 0, 0
    v_pk_mov_b32 v[156:157], 0, 0
    v_pk_mov_b32 v[158:159], 0, 0
    v_pk_mov_b32 v[160:161], 0, 0
    v_pk_mov_b32 v[162:163], 0, 0
    v_pk_mov_b32 v[164:165], 0, 0
    v_pk_mov_b32 v[166:167], 0, 0
    v_pk_mov_b32 v[168:169], 0, 0
    v_pk_mov_b32 v[170:171], 0, 0
    v_pk_mov_b32 v[172:173], 0, 0
    v_pk_mov_b32 v[174:175], 0, 0
    v_pk_mov_b32 v[176:177], 0, 0
    v_pk_mov_b32 v[200:201], 0, 0
    v_pk_mov_b32 v[178:179], 0, 0
    v_pk_mov_b32 v[202:203], 0, 0
    v_pk_mov_b32 v[180:181], 0, 0
    v_pk_mov_b32 v[204:205], 0, 0
    v_pk_mov_b32 v[182:183], 0, 0
    v_pk_mov_b32 v[206:207], 0, 0
    v_bfe_u32 v14, v1, 2, 1
    v_add_u32 v14, -1, v14
    v_and_b32 v15, 3, v1
    v_add_u32 v15, -1, v15
    v_ashrrev_i32 v15, 31, v15
    v_and_b32 v15, 0x3f803f80, v15
    v_and_b32 v208, v15, v14
    v_mov_b32 v209, v208
    v_xor_b32 v210, v15, v208
    v_mov_b32 v211, v210
    v_mov_b32 v212, 0xdddd
    s_waitcnt vmcnt(0)
    s_barrier
    s_mov_b32 m0, s53
    v_xor_b32 v6, 0, v7
    buffer_load_dwordx4 v6, s[40:43], s52 offen lds
    s_add_u32 s53, s53, 1024
    s_add_u32 s52, s52, 4096
    s_mov_b32 m0, s53
    v_xor_b32 v6, 32, v7
    buffer_load_dwordx4 v6, s[40:43], s52 offen lds
    s_add_u32 s53, s53, 1024
    s_add_u32 s52, s52, 4096
    s_mov_b32 m0, s53
    v_xor_b32 v6, 64, v7
    buffer_load_dwordx4 v6, s[40:43], s52 offen lds
    s_add_u32 s53, s53, 1024
    s_add_u32 s52, s52, 4096
    s_mov_b32 m0, s53
    v_xor_b32 v6, 96, v7
    buffer_load_dwordx4 v6, s[40:43], s52 offen lds
    s_add_u32 s53, s53, 1024
    s_add_u32 s52, s52, 4096
    s_mov_b32 m0, s53
    v_xor_b32 v6, 128, v7
    buffer_load_dwordx4 v6, s[40:43], s52 offen lds
    s_add_u32 s53, s53, 1024
    s_add_u32 s52, s52, 4096
    s_mov_b32 m0, s53
    v_xor_b32 v6, 160, v7
    buffer_load_dwordx4 v6, s[40:43], s52 offen lds
    s_add_u32 s53, s53, 1024
    s_add_u32 s52, s52, 4096
    s_mov_b32 m0, s53
    v_xor_b32 v6, 192, v7
    buffer_load_dwordx4 v6, s[40:43], s52 offen lds
    s_add_u32 s53, s53, 1024
    s_add_u32 s52, s52, 4096
    s_mov_b32 m0, s53
    v_xor_b32 v6, 224, v7
    buffer_load_dwordx4 v6, s[40:43], s52 offen lds
    s_add_u32 s53, s53, 1024
    s_add_u32 s52, s52, 4096
    v_mov_b32 v6, v5
    v_lshl_add_u32 v7, v4, 5, s58
    s_lshl_b32 s52, s3, 10
    s_add_u32 s84, s52, 0x9000
    s_add_u32 s85, s52, 0x8000
    s_add_u32 s86, s52, 0xb000
    s_add_u32 s87, s52, 0xa000
    s_add_u32 s88, s52, 0xd000
    s_add_u32 s89, s52, 0xc000
    s_add_u32 s90, s52, 0xf000
    s_add_u32 s91, s52, 0xe000
    s_barrier
    s_waitcnt vmcnt(0)
    v_xor_b32 v11, 0, v10
    ds_read_b128 v[48:51], v11
    v_xor_b32 v11, 64, v10
    ds_read_b128 v[52:55], v11
    v_xor_b32 v11, 128, v10
    ds_read_b128 v[56:59], v11
    v_xor_b32 v11, 192, v10
    ds_read_b128 v[60:63], v11
    v_xor_b32 v11, 256, v10
    ds_read_b128 v[64:67], v11
    v_xor_b32 v11, 320, v10
    ds_read_b128 v[68:71], v11
    v_xor_b32 v11, 384, v10
    ds_read_b128 v[72:75], v11
    v_xor_b32 v11, 448, v10
    ds_read_b128 v[76:79], v11
    s_waitcnt lgkmcnt(7)
    v_lshlrev_b32 v80, 16, v48
    v_and_b32 v81, 0xffff0000, v48
    v_lshlrev_b32 v82, 16, v49
    v_and_b32 v83, 0xffff0000, v49
    v_lshlrev_b32 v84, 16, v50
    v_and_b32 v85, 0xffff0000, v50
    v_lshlrev_b32 v86, 16, v51
    v_and_b32 v87, 0xffff0000, v51
    v_pk_mul_f32 v[14:15], v[80:81], v[80:81]
    v_pk_add_f32 v[8:9], v[80:81], v[82:83]
    v_pk_fma_f32 v[14:15], v[82:83], v[82:83], v[14:15]
    v_pk_add_f32 v[8:9], v[8:9], v[84:85]
    v_pk_fma_f32 v[14:15], v[84:85], v[84:85], v[14:15]
    v_pk_add_f32 v[8:9], v[8:9], v[86:87]
    v_pk_fma_f32 v[14:15], v[86:87], v[86:87], v[14:15]
    s_waitcnt lgkmcnt(6)
    v_lshlrev_b32 v88, 16, v52
    v_and_b32 v89, 0xffff0000, v52
    v_lshlrev_b32 v90, 16, v53
    v_and_b32 v91, 0xffff0000, v53
    v_lshlrev_b32 v92, 16, v54
    v_and_b32 v93, 0xffff0000, v54
    v_lshlrev_b32 v94, 16, v55
    v_and_b32 v95, 0xffff0000, v55
    v_pk_add_f32 v[8:9], v[8:9], v[88:89]
    v_pk_fma_f32 v[14:15], v[88:89], v[88:89], v[14:15]
    v_pk_add_f32 v[8:9], v[8:9], v[90:91]
    v_pk_fma_f32 v[14:15], v[90:91], v[90:91], v[14:15]
    v_pk_add_f32 v[8:9], v[8:9], v[92:93]
    v_pk_fma_f32 v[14:15], v[92:93], v[92:93], v[14:15]
    v_pk_add_f32 v[8:9], v[8:9], v[94:95]
    v_pk_fma_f32 v[14:15], v[94:95], v[94:95], v[14:15]
    s_waitcnt lgkmcnt(5)
    v_lshlrev_b32 v96, 16, v56
    v_and_b32 v97, 0xffff0000, v56
    v_lshlrev_b32 v98, 16, v57
    v_and_b32 v99, 0xffff0000, v57
    v_lshlrev_b32 v100, 16, v58
    v_and_b32 v101, 0xffff0000, v58
    v_lshlrev_b32 v102, 16, v59
    v_and_b32 v103, 0xffff0000, v59
    v_pk_add_f32 v[8:9], v[8:9], v[96:97]
    v_pk_fma_f32 v[14:15], v[96:97], v[96:97], v[14:15]
    v_pk_add_f32 v[8:9], v[8:9], v[98:99]
    v_pk_fma_f32 v[14:15], v[98:99], v[98:99], v[14:15]
    v_pk_add_f32 v[8:9], v[8:9], v[100:101]
    v_pk_fma_f32 v[14:15], v[100:101], v[100:101], v[14:15]
    v_pk_add_f32 v[8:9], v[8:9], v[102:103]
    v_pk_fma_f32 v[14:15], v[102:103], v[102:103], v[14:15]
    s_waitcnt lgkmcnt(4)
    v_lshlrev_b32 v104, 16, v60
    v_and_b32 v105, 0xffff0000, v60
    v_lshlrev_b32 v106, 16, v61
    v_and_b32 v107, 0xffff0000, v61
    v_lshlrev_b32 v108, 16, v62
    v_and_b32 v109, 0xffff0000, v62
    v_lshlrev_b32 v110, 16, v63
    v_and_b32 v111, 0xffff0000, v63
    v_pk_add_f32 v[8:9], v[8:9], v[104:105]
    v_pk_fma_f32 v[14:15], v[104:105], v[104:105], v[14:15]
    v_pk_add_f32 v[8:9], v[8:9], v[106:107]
    v_pk_fma_f32 v[14:15], v[106:107], v[106:107], v[14:15]
    v_pk_add_f32 v[8:9], v[8:9], v[108:109]
    v_pk_fma_f32 v[14:15], v[108:109], v[108:109], v[14:15]
    v_pk_add_f32 v[8:9], v[8:9], v[110:111]
    v_pk_fma_f32 v[14:15], v[110:111], v[110:111], v[14:15]
    s_waitcnt lgkmcnt(3)
    v_lshlrev_b32 v112, 16, v64
    v_and_b32 v113, 0xffff0000, v64
    v_lshlrev_b32 v114, 16, v65
    v_and_b32 v115, 0xffff0000, v65
    v_lshlrev_b32 v116, 16, v66
    v_and_b32 v117, 0xffff0000, v66
    v_lshlrev_b32 v118, 16, v67
    v_and_b32 v119, 0xffff0000, v67
    v_pk_add_f32 v[8:9], v[8:9], v[112:113]
    v_pk_fma_f32 v[14:15], v[112:113], v[112:113], v[14:15]
    v_pk_add_f32 v[8:9], v[8:9], v[114:115]
    v_pk_fma_f32 v[14:15], v[114:115], v[114:115], v[14:15]
    v_pk_add_f32 v[8:9], v[8:9], v[116:117]
    v_pk_fma_f32 v[14:15], v[116:117], v[116:117], v[14:15]
    v_pk_add_f32 v[8:9], v[8:9], v[118:119]
    v_pk_fma_f32 v[14:15], v[118:119], v[118:119], v[14:15]
    s_waitcnt lgkmcnt(2)
    v_lshlrev_b32 v120, 16, v68
    v_and_b32 v121, 0xffff0000, v68
    v_lshlrev_b32 v122, 16, v69
    v_and_b32 v123, 0xffff0000, v69
    v_lshlrev_b32 v124, 16, v70
    v_and_b32 v125, 0xffff0000, v70
    v_lshlrev_b32 v126, 16, v71
    v_and_b32 v127, 0xffff0000, v71
    v_pk_add_f32 v[8:9], v[8:9], v[120:121]
    v_pk_fma_f32 v[14:15], v[120:121], v[120:121], v[14:15]
    v_pk_add_f32 v[8:9], v[8:9], v[122:123]
    v_pk_fma_f32 v[14:15], v[122:123], v[122:123], v[14:15]
    v_pk_add_f32 v[8:9], v[8:9], v[124:125]
    v_pk_fma_f32 v[14:15], v[124:125], v[124:125], v[14:15]
    v_pk_add_f32 v[8:9], v[8:9], v[126:127]
    v_pk_fma_f32 v[14:15], v[126:127], v[126:127], v[14:15]
    s_waitcnt lgkmcnt(1)
    v_lshlrev_b32 v128, 16, v72
    v_and_b32 v129, 0xffff0000, v72
    v_lshlrev_b32 v130, 16, v73
    v_and_b32 v131, 0xffff0000, v73
    v_lshlrev_b32 v132, 16, v74
    v_and_b32 v133, 0xffff0000, v74
    v_lshlrev_b32 v134, 16, v75
    v_and_b32 v135, 0xffff0000, v75
    v_pk_add_f32 v[8:9], v[8:9], v[128:129]
    v_pk_fma_f32 v[14:15], v[128:129], v[128:129], v[14:15]
    v_pk_add_f32 v[8:9], v[8:9], v[130:131]
    v_pk_fma_f32 v[14:15], v[130:131], v[130:131], v[14:15]
    v_pk_add_f32 v[8:9], v[8:9], v[132:133]
    v_pk_fma_f32 v[14:15], v[132:133], v[132:133], v[14:15]
    v_pk_add_f32 v[8:9], v[8:9], v[134:135]
    v_pk_fma_f32 v[14:15], v[134:135], v[134:135], v[14:15]
    s_waitcnt lgkmcnt(0)
    v_lshlrev_b32 v136, 16, v76
    v_and_b32 v137, 0xffff0000, v76
    v_lshlrev_b32 v138, 16, v77
    v_and_b32 v139, 0xffff0000, v77
    v_lshlrev_b32 v140, 16, v78
    v_and_b32 v141, 0xffff0000, v78
    v_lshlrev_b32 v142, 16, v79
    v_and_b32 v143, 0xffff0000, v79
    v_pk_add_f32 v[8:9], v[8:9], v[136:137]
    v_pk_fma_f32 v[14:15], v[136:137], v[136:137], v[14:15]
    v_pk_add_f32 v[8:9], v[8:9], v[138:139]
    v_pk_fma_f32 v[14:15], v[138:139], v[138:139], v[14:15]
    v_pk_add_f32 v[8:9], v[8:9], v[140:141]
    v_pk_fma_f32 v[14:15], v[140:141], v[140:141], v[14:15]
    v_pk_add_f32 v[8:9], v[8:9], v[142:143]
    v_pk_fma_f32 v[14:15], v[142:143], v[142:143], v[14:15]
    v_add_f32 v8, v8, v9
    v_add_f32 v9, v14, v15
    v_mov_b32 v14, v8
    v_mov_b32 v15, v9
    s_nop 0
    v_permlane16_swap_b32 v14, v8
    v_permlane16_swap_b32 v15, v9
    s_nop 0
    v_add_f32 v8, v8, v14
    v_add_f32 v9, v9, v15
    v_mov_b32 v14, v8
    v_mov_b32 v15, v9
    s_nop 0
    v_permlane32_swap_b32 v14, v8
    v_permlane32_swap_b32 v15, v9
    s_nop 0
    v_add_f32 v8, v8, v14
    v_add_f32 v9, v9, v15
    v_lshlrev_b32 v11, 3, v3
    v_add_u32 v14, s56, v11
    ds_write_b64 v14, v[8:9]
    s_waitcnt lgkmcnt(0)
    s_barrier
    buffer_load_dwordx4 v[216:219], v2, s[36:39], s84 offen sc1
    buffer_load_dwordx4 v[232:235], v2, s[36:39], s85 offen sc1
    buffer_load_dwordx4 v[220:223], v2, s[36:39], s86 offen sc1
    buffer_load_dwordx4 v[236:239], v2, s[36:39], s87 offen sc1
    buffer_load_dwordx4 v[224:227], v2, s[36:39], s88 offen sc1
    buffer_load_dwordx4 v[240:243], v2, s[36:39], s89 offen sc1
    buffer_load_dwordx4 v[228:231], v2, s[36:39], s90 offen sc1
    buffer_load_dwordx4 v[244:247], v2, s[36:39], s91 offen sc1
    s_barrier
    ds_read_b64 v[16:17], v11 offset:0
    ds_read_b64 v[18:19], v11 offset:8192
    ds_read_b64 v[20:21], v11 offset:16384
    ds_read_b64 v[22:23], v11 offset:24576
    s_lshr_b32 s52, s54, 1
    s_lshl_b32 s52, s52, 16
    s_and_b32 s53, s54, 1
    s_lshl_b32 s60, s53, 10
    s_add_u32 s52, s52, s60
    s_lshl_b32 s60, s3, 14
    s_add_u32 s52, s52, s60
    s_lshl_b32 s60, s55, 13
    s_add_u32 s52, s52, s60
    s_add_u32 s52, s52, 0x200000
    s_add_u32 s53, s52, 4096
    s_waitcnt lgkmcnt(0)
    v_pk_add_f32 v[16:17], v[16:17], v[18:19]
    v_pk_add_f32 v[20:21], v[20:21], v[22:23]
    v_pk_add_f32 v[16:17], v[16:17], v[20:21]
    v_mul_f32 v16, 0xba800000, v16
    v_mul_f32 v17, 0x3a800000, v17
    v_fma_f32 v17, -v16, v16, v17
    v_max_f32 v17, 0, v17
    v_add_f32 v17, 0x3727c5ac, v17
    v_rsq_f32 v8, v17
    s_nop 0
    v_mul_f32 v9, v16, v8
    v_pk_fma_f32 v[80:81], v[80:81], v[8:9], v[8:9] op_sel:[0,0,1] op_sel_hi:[1,0,1]
    v_pk_fma_f32 v[82:83], v[82:83], v[8:9], v[8:9] op_sel:[0,0,1] op_sel_hi:[1,0,1]
    v_pk_fma_f32 v[84:85], v[84:85], v[8:9], v[8:9] op_sel:[0,0,1] op_sel_hi:[1,0,1]
    v_pk_fma_f32 v[86:87], v[86:87], v[8:9], v[8:9] op_sel:[0,0,1] op_sel_hi:[1,0,1]
    v_pk_fma_f32 v[88:89], v[88:89], v[8:9], v[8:9] op_sel:[0,0,1] op_sel_hi:[1,0,1]
    v_pk_fma_f32 v[90:91], v[90:91], v[8:9], v[8:9] op_sel:[0,0,1] op_sel_hi:[1,0,1]
    v_pk_fma_f32 v[92:93], v[92:93], v[8:9], v[8:9] op_sel:[0,0,1] op_sel_hi:[1,0,1]
    v_pk_fma_f32 v[94:95], v[94:95], v[8:9], v[8:9] op_sel:[0,0,1] op_sel_hi:[1,0,1]
    v_pk_fma_f32 v[96:97], v[96:97], v[8:9], v[8:9] op_sel:[0,0,1] op_sel_hi:[1,0,1]
    v_pk_fma_f32 v[98:99], v[98:99], v[8:9], v[8:9] op_sel:[0,0,1] op_sel_hi:[1,0,1]
    v_pk_fma_f32 v[100:101], v[100:101], v[8:9], v[8:9] op_sel:[0,0,1] op_sel_hi:[1,0,1]
    v_pk_fma_f32 v[102:103], v[102:103], v[8:9], v[8:9] op_sel:[0,0,1] op_sel_hi:[1,0,1]
    v_pk_fma_f32 v[104:105], v[104:105], v[8:9], v[8:9] op_sel:[0,0,1] op_sel_hi:[1,0,1]
    v_pk_fma_f32 v[106:107], v[106:107], v[8:9], v[8:9] op_sel:[0,0,1] op_sel_hi:[1,0,1]
    v_pk_fma_f32 v[108:109], v[108:109], v[8:9], v[8:9] op_sel:[0,0,1] op_sel_hi:[1,0,1]
    v_pk_fma_f32 v[110:111], v[110:111], v[8:9], v[8:9] op_sel:[0,0,1] op_sel_hi:[1,0,1]
    v_pk_fma_f32 v[112:113], v[112:113], v[8:9], v[8:9] op_sel:[0,0,1] op_sel_hi:[1,0,1]
    v_pk_fma_f32 v[114:115], v[114:115], v[8:9], v[8:9] op_sel:[0,0,1] op_sel_hi:[1,0,1]
    v_pk_fma_f32 v[116:117], v[116:117], v[8:9], v[8:9] op_sel:[0,0,1] op_sel_hi:[1,0,1]
    v_pk_fma_f32 v[118:119], v[118:119], v[8:9], v[8:9] op_sel:[0,0,1] op_sel_hi:[1,0,1]
    v_pk_fma_f32 v[120:121], v[120:121], v[8:9], v[8:9] op_sel:[0,0,1] op_sel_hi:[1,0,1]
    v_pk_fma_f32 v[122:123], v[122:123], v[8:9], v[8:9] op_sel:[0,0,1] op_sel_hi:[1,0,1]
    v_pk_fma_f32 v[124:125], v[124:125], v[8:9], v[8:9] op_sel:[0,0,1] op_sel_hi:[1,0,1]
    v_pk_fma_f32 v[126:127], v[126:127], v[8:9], v[8:9] op_sel:[0,0,1] op_sel_hi:[1,0,1]
    v_pk_fma_f32 v[128:129], v[128:129], v[8:9], v[8:9] op_sel:[0,0,1] op_sel_hi:[1,0,1]
    v_pk_fma_f32 v[130:131], v[130:131], v[8:9], v[8:9] op_sel:[0,0,1] op_sel_hi:[1,0,1]
    v_pk_fma_f32 v[132:133], v[132:133], v[8:9], v[8:9] op_sel:[0,0,1] op_sel_hi:[1,0,1]
    v_pk_fma_f32 v[134:135], v[134:135], v[8:9], v[8:9] op_sel:[0,0,1] op_sel_hi:[1,0,1]
    v_pk_fma_f32 v[136:137], v[136:137], v[8:9], v[8:9] op_sel:[0,0,1] op_sel_hi:[1,0,1]
    v_pk_fma_f32 v[138:139], v[138:139], v[8:9], v[8:9] op_sel:[0,0,1] op_sel_hi:[1,0,1]
    v_pk_fma_f32 v[140:141], v[140:141], v[8:9], v[8:9] op_sel:[0,0,1] op_sel_hi:[1,0,1]
    v_pk_fma_f32 v[142:143], v[142:143], v[8:9], v[8:9] op_sel:[0,0,1] op_sel_hi:[1,0,1]
    s_mov_b32 s61, 0x8000
    s_waitcnt vmcnt(0)
    s_branch L_mainc_ppc
L_mainc_pp:
    buffer_load_dwordx4 v[216:219], v2, s[36:39], s84 offen sc1
    buffer_load_dwordx4 v[232:235], v2, s[36:39], s85 offen sc1
    buffer_load_dwordx4 v[220:223], v2, s[36:39], s86 offen sc1
    buffer_load_dwordx4 v[236:239], v2, s[36:39], s87 offen sc1
    buffer_load_dwordx4 v[224:227], v2, s[36:39], s88 offen sc1
    buffer_load_dwordx4 v[240:243], v2, s[36:39], s89 offen sc1
    buffer_load_dwordx4 v[228:231], v2, s[36:39], s90 offen sc1
    buffer_load_dwordx4 v[244:247], v2, s[36:39], s91 offen sc1
    s_waitcnt vmcnt(0)
L_mainc_ppc:
    v_or_b32 v14, v216, v217
    v_or3_b32 v14, v14, v218, v219
    v_or3_b32 v14, v14, v220, v221
    v_or3_b32 v14, v14, v222, v223
    v_or3_b32 v14, v14, v224, v225
    v_or3_b32 v14, v14, v226, v227
    v_or3_b32 v14, v14, v228, v229
    v_or3_b32 v14, v14, v230, v231
    v_or3_b32 v14, v14, v232, v233
    v_or3_b32 v14, v14, v234, v235
    v_or3_b32 v14, v14, v236, v237
    v_or3_b32 v14, v14, v238, v239
    v_or3_b32 v14, v14, v240, v241
    v_or3_b32 v14, v14, v242, v243
    v_or3_b32 v14, v14, v244, v245
    v_or3_b32 v14, v14, v246, v247
    v_and_b32 v14, 1, v14
    v_cmp_ne_u32 vcc, 0, v14
    s_sub_u32 s61, s61, 1
    s_cbranch_scc1 L_mainc_ppx
    s_cbranch_vccnz L_mainc_pp
L_mainc_ppx:
    s_mov_b64 exec, -1
    v_pk_add_f32 v[216:217], v[216:217], v[220:221]
    v_pk_add_f32 v[218:219], v[218:219], v[222:223]
    v_pk_add_f32 v[224:225], v[224:225], v[228:229]
    v_pk_add_f32 v[226:227], v[226:227], v[230:231]
    v_pk_add_f32 v[216:217], v[216:217], v[224:225]
    v_pk_add_f32 v[218:219], v[218:219], v[226:227]
    v_cvt_pk_bf16_f32 v220, v216, v217
    v_cvt_pk_bf16_f32 v221, v218, v219
    v_lshlrev_b32 v216, 16, v220
    v_and_b32 v217, 0xffff0000, v220
    v_lshlrev_b32 v218, 16, v221
    v_and_b32 v219, 0xffff0000, v221
    v_pk_add_f32 v[232:233], v[232:233], v[236:237]
    v_pk_add_f32 v[234:235], v[234:235], v[238:239]
    v_pk_add_f32 v[240:241], v[240:241], v[244:245]
    v_pk_add_f32 v[242:243], v[242:243], v[246:247]
    v_pk_add_f32 v[232:233], v[232:233], v[240:241]
    v_pk_add_f32 v[234:235], v[234:235], v[242:243]
    v_cvt_pk_bf16_f32 v236, v232, v233
    v_cvt_pk_bf16_f32 v237, v234, v235
    v_lshlrev_b32 v232, 16, v236
    v_and_b32 v233, 0xffff0000, v236
    v_lshlrev_b32 v234, 16, v237
    v_and_b32 v235, 0xffff0000, v237
    v_pk_add_f32 v[216:217], v[216:217], 1.0 op_sel_hi:[1,0]
    v_pk_add_f32 v[218:219], v[218:219], 1.0 op_sel_hi:[1,0]
    v_cvt_pk_bf16_f32 v220, v216, v217
    v_cvt_pk_bf16_f32 v221, v218, v219
    v_lshlrev_b32 v216, 16, v220
    v_and_b32 v217, 0xffff0000, v220
    v_lshlrev_b32 v218, 16, v221
    v_and_b32 v219, 0xffff0000, v221
    ds_write_b128 v6, v[216:219]
    ds_write_b128 v6, v[232:235] offset:1024
    ds_read_b128 v[16:19], v7 offset:0
    ds_read_b128 v[20:23], v7 offset:16
    ds_read_b128 v[24:27], v7 offset:1024
    ds_read_b128 v[28:31], v7 offset:1040
    ds_read_b128 v[32:35], v7 offset:128
    ds_read_b128 v[36:39], v7 offset:144
    ds_read_b128 v[40:43], v7 offset:1152
    ds_read_b128 v[44:47], v7 offset:1168
    s_waitcnt lgkmcnt(4)
    v_pk_fma_f32 v[80:81], v[80:81], v[16:17], v[24:25]
    v_pk_fma_f32 v[82:83], v[82:83], v[18:19], v[26:27]
    v_pk_fma_f32 v[84:85], v[84:85], v[20:21], v[28:29]
    v_pk_fma_f32 v[86:87], v[86:87], v[22:23], v[30:31]
    ds_read_b128 v[16:19], v7 offset:256
    ds_read_b128 v[20:23], v7 offset:272
    ds_read_b128 v[24:27], v7 offset:1280
    ds_read_b128 v[28:31], v7 offset:1296
    v_cvt_pk_bf16_f32 v48, v80, v81
    v_cvt_pk_bf16_f32 v49, v82, v83
    v_cvt_pk_bf16_f32 v50, v84, v85
    v_cvt_pk_bf16_f32 v51, v86, v87
    buffer_store_dwordx4 v[48:51], v2, s[36:39], s52 offen offset:0 sc1
    s_waitcnt lgkmcnt(4)
    v_pk_fma_f32 v[88:89], v[88:89], v[32:33], v[40:41]
    v_pk_fma_f32 v[90:91], v[90:91], v[34:35], v[42:43]
    v_pk_fma_f32 v[92:93], v[92:93], v[36:37], v[44:45]
    v_pk_fma_f32 v[94:95], v[94:95], v[38:39], v[46:47]
    ds_read_b128 v[32:35], v7 offset:384
    ds_read_b128 v[36:39], v7 offset:400
    ds_read_b128 v[40:43], v7 offset:1408
    ds_read_b128 v[44:47], v7 offset:1424
    v_cvt_pk_bf16_f32 v52, v88, v89
    v_cvt_pk_bf16_f32 v53, v90, v91
    v_cvt_pk_bf16_f32 v54, v92, v93
    v_cvt_pk_bf16_f32 v55, v94, v95
    buffer_store_dwordx4 v[52:55], v2, s[36:39], s52 offen offset:2048 sc1
    s_waitcnt lgkmcnt(4)
    v_pk_fma_f32 v[96:97], v[96:97], v[16:17], v[24:25]
    v_pk_fma_f32 v[98:99], v[98:99], v[18:19], v[26:27]
    v_pk_fma_f32 v[100:101], v[100:101], v[20:21], v[28:29]
    v_pk_fma_f32 v[102:103], v[102:103], v[22:23], v[30:31]
    ds_read_b128 v[16:19], v7 offset:512
    ds_read_b128 v[20:23], v7 offset:528
    ds_read_b128 v[24:27], v7 offset:1536
    ds_read_b128 v[28:31], v7 offset:1552
    v_cvt_pk_bf16_f32 v56, v96, v97
    v_cvt_pk_bf16_f32 v57, v98, v99
    v_cvt_pk_bf16_f32 v58, v100, v101
    v_cvt_pk_bf16_f32 v59, v102, v103
    buffer_store_dwordx4 v[56:59], v2, s[36:39], s53 offen offset:0 sc1
    s_waitcnt lgkmcnt(4)
    v_pk_fma_f32 v[104:105], v[104:105], v[32:33], v[40:41]
    v_pk_fma_f32 v[106:107], v[106:107], v[34:35], v[42:43]
    v_pk_fma_f32 v[108:109], v[108:109], v[36:37], v[44:45]
    v_pk_fma_f32 v[110:111], v[110:111], v[38:39], v[46:47]
    ds_read_b128 v[32:35], v7 offset:640
    ds_read_b128 v[36:39], v7 offset:656
    ds_read_b128 v[40:43], v7 offset:1664
    ds_read_b128 v[44:47], v7 offset:1680
    v_cvt_pk_bf16_f32 v60, v104, v105
    v_cvt_pk_bf16_f32 v61, v106, v107
    v_cvt_pk_bf16_f32 v62, v108, v109
    v_cvt_pk_bf16_f32 v63, v110, v111
    buffer_store_dwordx4 v[60:63], v2, s[36:39], s53 offen offset:2048 sc1
    s_waitcnt lgkmcnt(4)
    v_pk_fma_f32 v[112:113], v[112:113], v[16:17], v[24:25]
    v_pk_fma_f32 v[114:115], v[114:115], v[18:19], v[26:27]
    v_pk_fma_f32 v[116:117], v[116:117], v[20:21], v[28:29]
    v_pk_fma_f32 v[118:119], v[118:119], v[22:23], v[30:31]
    ds_read_b128 v[16:19], v7 offset:768
    ds_read_b128 v[20:23], v7 offset:784
    ds_read_b128 v[24:27], v7 offset:1792
    ds_read_b128 v[28:31], v7 offset:1808
    v_cvt_pk_bf16_f32 v64, v112, v113
    v_cvt_pk_bf16_f32 v65, v114, v115
    v_cvt_pk_bf16_f32 v66, v116, v117
    v_cvt_pk_bf16_f32 v67, v118, v119
    s_waitcnt lgkmcnt(4)
    v_pk_fma_f32 v[120:121], v[120:121], v[32:33], v[40:41]
    v_pk_fma_f32 v[122:123], v[122:123], v[34:35], v[42:43]
    v_pk_fma_f32 v[124:125], v[124:125], v[36:37], v[44:45]
    v_pk_fma_f32 v[126:127], v[126:127], v[38:39], v[46:47]
    ds_read_b128 v[32:35], v7 offset:896
    ds_read_b128 v[36:39], v7 offset:912
    ds_read_b128 v[40:43], v7 offset:1920
    ds_read_b128 v[44:47], v7 offset:1936
    v_cvt_pk_bf16_f32 v68, v120, v121
    v_cvt_pk_bf16_f32 v69, v122, v123
    v_cvt_pk_bf16_f32 v70, v124, v125
    v_cvt_pk_bf16_f32 v71, v126, v127
    s_waitcnt lgkmcnt(4)
    v_pk_fma_f32 v[128:129], v[128:129], v[16:17], v[24:25]
    v_pk_fma_f32 v[130:131], v[130:131], v[18:19], v[26:27]
    v_pk_fma_f32 v[132:133], v[132:133], v[20:21], v[28:29]
    v_pk_fma_f32 v[134:135], v[134:135], v[22:23], v[30:31]
    v_cvt_pk_bf16_f32 v72, v128, v129
    v_cvt_pk_bf16_f32 v73, v130, v131
    v_cvt_pk_bf16_f32 v74, v132, v133
    v_cvt_pk_bf16_f32 v75, v134, v135
    s_waitcnt lgkmcnt(0)
    v_pk_fma_f32 v[136:137], v[136:137], v[32:33], v[40:41]
    v_pk_fma_f32 v[138:139], v[138:139], v[34:35], v[42:43]
    v_pk_fma_f32 v[140:141], v[140:141], v[36:37], v[44:45]
    v_pk_fma_f32 v[142:143], v[142:143], v[38:39], v[46:47]
    v_cvt_pk_bf16_f32 v76, v136, v137
    v_cvt_pk_bf16_f32 v77, v138, v139
    v_cvt_pk_bf16_f32 v78, v140, v141
    v_cvt_pk_bf16_f32 v79, v142, v143
    s_barrier
    s_lshl_b32 s52, s34, 2
    s_add_u32 s52, s52, s3
    s_lshl_b32 s52, s52, 7
    s_add_u32 s52, s52, 0x154000
    v_mov_b32 v7, 1
    s_waitcnt vmcnt(0)
    s_mov_b64 exec, 1
    buffer_atomic_add v7, v2, s[36:39], s52 offen sc1
    s_mov_b64 exec, -1
    s_cmp_eq_u32 s55, 0
    ds_read_b64_tr_b16 v[216:217], v12 offset:0
    ds_read_b64_tr_b16 v[218:219], v12 offset:256
    ds_read_b64_tr_b16 v[220:221], v13 offset:0
    ds_read_b64_tr_b16 v[222:223], v13 offset:256
    ds_read_b64_tr_b16 v[224:225], v12 offset:2048
    ds_read_b64_tr_b16 v[226:227], v12 offset:2304
    ds_read_b64_tr_b16 v[228:229], v13 offset:2048
    ds_read_b64_tr_b16 v[230:231], v13 offset:2304
    ds_read_b64_tr_b16 v[232:233], v12 offset:4096
    ds_read_b64_tr_b16 v[234:235], v12 offset:4352
    ds_read_b64_tr_b16 v[236:237], v13 offset:4096
    ds_read_b64_tr_b16 v[238:239], v13 offset:4352
    s_cbranch_scc0 L_mainc_pv
    s_waitcnt lgkmcnt(8)
    v_mfma_f32_16x16x32_bf16 v[16:19], v[216:219], v[48:51], 0
    v_mfma_f32_16x16x32_bf16 v[20:23], v[220:223], v[48:51], 0
    ds_read_b64_tr_b16 v[240:241], v12 offset:6144
    ds_read_b64_tr_b16 v[242:243], v12 offset:6400
    ds_read_b64_tr_b16 v[244:245], v13 offset:6144
    ds_read_b64_tr_b16 v[246:247], v13 offset:6400
    s_waitcnt lgkmcnt(8)
    v_mfma_f32_16x16x32_bf16 v[16:19], v[224:227], v[52:55], v[16:19]
    v_mfma_f32_16x16x32_bf16 v[20:23], v[228:231], v[52:55], v[20:23]
    ds_read_b64_tr_b16 v[216:217], v12 offset:8192
    ds_read_b64_tr_b16 v[218:219], v12 offset:8448
    ds_read_b64_tr_b16 v[220:221], v13 offset:8192
    ds_read_b64_tr_b16 v[222:223], v13 offset:8448
    s_waitcnt lgkmcnt(8)
    v_mfma_f32_16x16x32_bf16 v[16:19], v[232:235], v[56:59], v[16:19]
    v_mfma_f32_16x16x32_bf16 v[20:23], v[236:239], v[56:59], v[20:23]
    ds_read_b64_tr_b16 v[224:225], v12 offset:10240
    ds_read_b64_tr_b16 v[226:227], v12 offset:10496
    ds_read_b64_tr_b16 v[228:229], v13 offset:10240
    ds_read_b64_tr_b16 v[230:231], v13 offset:10496
    s_waitcnt lgkmcnt(8)
    v_mfma_f32_16x16x32_bf16 v[16:19], v[240:243], v[60:63], v[16:19]
    v_mfma_f32_16x16x32_bf16 v[20:23], v[244:247], v[60:63], v[20:23]
    ds_read_b64_tr_b16 v[232:233], v12 offset:12288
    ds_read_b64_tr_b16 v[234:235], v12 offset:12544
    ds_read_b64_tr_b16 v[236:237], v13 offset:12288
    ds_read_b64_tr_b16 v[238:239], v13 offset:12544
    s_waitcnt lgkmcnt(8)
    v_mfma_f32_16x16x32_bf16 v[16:19], v[216:219], v[64:67], v[16:19]
    v_mfma_f32_16x16x32_bf16 v[20:23], v[220:223], v[64:67], v[20:23]
    ds_read_b64_tr_b16 v[240:241], v12 offset:14336
    ds_read_b64_tr_b16 v[242:243], v12 offset:14592
    ds_read_b64_tr_b16 v[244:245], v13 offset:14336
    ds_read_b64_tr_b16 v[246:247], v13 offset:14592
    s_waitcnt lgkmcnt(8)
    v_mfma_f32_16x16x32_bf16 v[16:19], v[224:227], v[68:71], v[16:19]
    v_mfma_f32_16x16x32_bf16 v[20:23], v[228:231], v[68:71], v[20:23]
    s_waitcnt lgkmcnt(4)
    v_mfma_f32_16x16x32_bf16 v[16:19], v[232:235], v[72:75], v[16:19]
    v_mfma_f32_16x16x32_bf16 v[20:23], v[236:239], v[72:75], v[20:23]
    s_waitcnt lgkmcnt(0)
    v_mfma_f32_16x16x32_bf16 v[16:19], v[240:243], v[76:79], v[16:19]
    v_mfma_f32_16x16x32_bf16 v[20:23], v[244:247], v[76:79], v[20:23]
    s_branch L_mainc_pr
L_mainc_pv:
    s_waitcnt lgkmcnt(8)
    v_mfma_f32_16x16x32_bf16 v[16:19], v[48:51], v[216:219], 0
    v_mfma_f32_16x16x32_bf16 v[20:23], v[48:51], v[220:223], 0
    ds_read_b64_tr_b16 v[240:241], v12 offset:6144
    ds_read_b64_tr_b16 v[242:243], v12 offset:6400
    ds_read_b64_tr_b16 v[244:245], v13 offset:6144
    ds_read_b64_tr_b16 v[246:247], v13 offset:6400
    s_waitcnt lgkmcnt(8)
    v_mfma_f32_16x16x32_bf16 v[16:19], v[52:55], v[224:227], v[16:19]
    v_mfma_f32_16x16x32_bf16 v[20:23], v[52:55], v[228:231], v[20:23]
    ds_read_b64_tr_b16 v[216:217], v12 offset:8192
    ds_read_b64_tr_b16 v[218:219], v12 offset:8448
    ds_read_b64_tr_b16 v[220:221], v13 offset:8192
    ds_read_b64_tr_b16 v[222:223], v13 offset:8448
    s_waitcnt lgkmcnt(8)
    v_mfma_f32_16x16x32_bf16 v[16:19], v[56:59], v[232:235], v[16:19]
    v_mfma_f32_16x16x32_bf16 v[20:23], v[56:59], v[236:239], v[20:23]
    ds_read_b64_tr_b16 v[224:225], v12 offset:10240
    ds_read_b64_tr_b16 v[226:227], v12 offset:10496
    ds_read_b64_tr_b16 v[228:229], v13 offset:10240
    ds_read_b64_tr_b16 v[230:231], v13 offset:10496
    s_waitcnt lgkmcnt(8)
    v_mfma_f32_16x16x32_bf16 v[16:19], v[60:63], v[240:243], v[16:19]
    v_mfma_f32_16x16x32_bf16 v[20:23], v[60:63], v[244:247], v[20:23]
    ds_read_b64_tr_b16 v[232:233], v12 offset:12288
    ds_read_b64_tr_b16 v[234:235], v12 offset:12544
    ds_read_b64_tr_b16 v[236:237], v13 offset:12288
    ds_read_b64_tr_b16 v[238:239], v13 offset:12544
    s_waitcnt lgkmcnt(8)
    v_mfma_f32_16x16x32_bf16 v[16:19], v[64:67], v[216:219], v[16:19]
    v_mfma_f32_16x16x32_bf16 v[20:23], v[64:67], v[220:223], v[20:23]
    ds_read_b64_tr_b16 v[240:241], v12 offset:14336
    ds_read_b64_tr_b16 v[242:243], v12 offset:14592
    ds_read_b64_tr_b16 v[244:245], v13 offset:14336
    ds_read_b64_tr_b16 v[246:247], v13 offset:14592
    s_waitcnt lgkmcnt(8)
    v_mfma_f32_16x16x32_bf16 v[16:19], v[68:71], v[224:227], v[16:19]
    v_mfma_f32_16x16x32_bf16 v[20:23], v[68:71], v[228:231], v[20:23]
    s_waitcnt lgkmcnt(4)
    v_mfma_f32_16x16x32_bf16 v[16:19], v[72:75], v[232:235], v[16:19]
    v_mfma_f32_16x16x32_bf16 v[20:23], v[72:75], v[236:239], v[20:23]
    s_waitcnt lgkmcnt(0)
    v_mfma_f32_16x16x32_bf16 v[16:19], v[76:79], v[240:243], v[16:19]
    v_mfma_f32_16x16x32_bf16 v[20:23], v[76:79], v[244:247], v[20:23]
L_mainc_pr:
    v_add_u32 v6, s56, v2
    s_nop 6
    ds_write_b128 v6, v[16:19]
    ds_write_b128 v6, v[20:23] offset:1024
    s_waitcnt lgkmcnt(0)
    s_barrier
    s_lshl_b32 s52, s34, 2
    s_add_u32 s52, s52, s3
    s_lshl_b32 s77, s52, 16
    s_add_u32 s52, s77, 0x200000
    s_add_u32 s40, s32, s52
    s_addc_u32 s41, s33, 0
    s_mov_b32 s42, 0x10000
    s_mov_b32 s43, 0x00020000
    s_add_u32 s48, s32, 0x100000
    s_addc_u32 s49, s33, 0
    s_mov_b32 s50, 0x40000
    s_mov_b32 s51, 0x00020000
    s_mov_b32 s72, 0
    s_mov_b32 s73, 3
    s_mov_b32 s74, 0
    v_lshrrev_b32 v8, 4, v1
    v_lshlrev_b32 v8, 3, v8
    v_bfe_u32 v12, v1, 2, 2
    v_add_u32 v8, v8, v12
    v_lshlrev_b32 v8, 7, v8
    v_bfe_u32 v12, v1, 3, 2
    v_lshl_add_u32 v8, v12, 5, v8
    v_and_b32 v12, 3, v1
    v_lshl_add_u32 v8, v12, 3, v8
    v_add_u32 v8, 32768, v8
    v_xor_b32 v9, 32, v8
    v_xor_b32 v10, 64, v8
    v_xor_b32 v11, 96, v8
    v_pk_mov_b32 v[4:5], v[8:9], v[8:9] op_sel:[0,1]
    v_pk_mov_b32 v[6:7], v[10:11], v[10:11] op_sel:[0,1]
    v_pk_mov_b32 v[16:17], 0, 0
    v_pk_mov_b32 v[18:19], 0, 0
    v_pk_mov_b32 v[20:21], 0, 0
    v_pk_mov_b32 v[22:23], 0, 0
    v_pk_mov_b32 v[24:25], 0, 0
    v_pk_mov_b32 v[26:27], 0, 0
    v_pk_mov_b32 v[28:29], 0, 0
    v_pk_mov_b32 v[30:31], 0, 0
    v_pk_mov_b32 v[32:33], 0, 0
    v_pk_mov_b32 v[34:35], 0, 0
    v_pk_mov_b32 v[36:37], 0, 0
    v_pk_mov_b32 v[38:39], 0, 0
    v_pk_mov_b32 v[40:41], 0, 0
    v_pk_mov_b32 v[42:43], 0, 0
    v_pk_mov_b32 v[44:45], 0, 0
    v_pk_mov_b32 v[46:47], 0, 0
    s_lshl_b32 s60, s3, 13
    s_add_u32 s60, s60, 131072
    v_lshrrev_b32 v236, 5, v1
    v_bfe_u32 v14, v1, 2, 3
    v_lshl_add_u32 v236, v236, 4, v14
    v_lshlrev_b32 v236, 7, v236
    v_bfe_u32 v14, v1, 3, 2
    v_lshl_add_u32 v236, v14, 5, v236
    v_and_b32 v14, 3, v1
    v_lshl_add_u32 v236, v14, 3, v236
    v_add_u32 v236, 0, v236
    v_xor_b32 v237, 32, v236
    v_xor_b32 v238, 64, v236
    v_xor_b32 v239, 96, v236
    v_and_b32 v3, 15, v1
    v_lshlrev_b32 v240, 7, v3
    v_bfe_u32 v14, v1, 1, 3
    v_lshrrev_b32 v15, 5, v1
    v_xor_b32 v14, v14, v15
    v_lshl_add_u32 v240, v14, 4, v240
    v_bfe_u32 v14, v1, 4, 1
    v_lshl_add_u32 v240, v14, 3, v240
    v_add_u32 v240, s60, v240
    v_xor_b32 v241, 32, v240
    v_xor_b32 v242, 64, v240
    v_xor_b32 v243, 96, v240
    v_and_b32 v14, 48, v1
    v_add_u32 v244, 135168, v14
    v_bfe_u32 v14, v1, 4, 1
    v_lshlrev_b32 v14, 10, v14
    v_lshrrev_b32 v15, 5, v1
    v_lshl_add_u32 v14, v15, 8, v14
    v_lshl_add_u32 v245, v3, 4, v14
    s_barrier
    buffer_load_dwordx4 v[80:83], v2, s[40:43], s72 offen offset:0 sc1
    buffer_load_dwordx4 v[84:87], v2, s[40:43], s72 offen offset:1024 sc1
    buffer_load_dwordx4 v[88:91], v2, s[40:43], s72 offen offset:2048 sc1
    buffer_load_dwordx4 v[92:95], v2, s[40:43], s72 offen offset:3072 sc1
    s_add_u32 s72, s72, 4096
    ds_read_b64_tr_b16 v[48:49], v4 offset:0
    ds_read_b64_tr_b16 v[50:51], v4 offset:512
    ds_read_b64_tr_b16 v[52:53], v5 offset:0
    ds_read_b64_tr_b16 v[54:55], v5 offset:512
    ds_read_b64_tr_b16 v[56:57], v6 offset:0
    ds_read_b64_tr_b16 v[58:59], v6 offset:512
    ds_read_b64_tr_b16 v[60:61], v7 offset:0
    ds_read_b64_tr_b16 v[62:63], v7 offset:512
    ds_read_b64_tr_b16 v[64:65], v4 offset:4096
    ds_read_b64_tr_b16 v[66:67], v4 offset:4608
    ds_read_b64_tr_b16 v[68:69], v5 offset:4096
    ds_read_b64_tr_b16 v[70:71], v5 offset:4608
    ds_read_b64_tr_b16 v[72:73], v6 offset:4096
    ds_read_b64_tr_b16 v[74:75], v6 offset:4608
    buffer_load_dwordx4 v[96:99], v2, s[40:43], s72 offen offset:0 sc1
    buffer_load_dwordx4 v[100:103], v2, s[40:43], s72 offen offset:1024 sc1
    buffer_load_dwordx4 v[104:107], v2, s[40:43], s72 offen offset:2048 sc1
    buffer_load_dwordx4 v[108:111], v2, s[40:43], s72 offen offset:3072 sc1
    s_add_u32 s72, s72, 4096
    buffer_load_dwordx4 v[112:115], v2, s[40:43], s72 offen offset:0 sc1
    buffer_load_dwordx4 v[116:119], v2, s[40:43], s72 offen offset:1024 sc1
    buffer_load_dwordx4 v[120:123], v2, s[40:43], s72 offen offset:2048 sc1
    buffer_load_dwordx4 v[124:127], v2, s[40:43], s72 offen offset:3072 sc1
    s_add_u32 s72, s72, 4096
L_mainc_ql:
    s_waitcnt vmcnt(10) lgkmcnt(10)
    v_mfma_f32_16x16x32_bf16 v[16:19], v[48:51], v[80:83], v[16:19]
    buffer_load_dwordx4 v[128:131], v2, s[40:43], s72 offen offset:0 sc1
    ds_read_b64_tr_b16 v[76:77], v7 offset:4096
    v_mfma_f32_16x16x32_bf16 v[32:35], v[48:51], v[84:87], v[32:35]
    ds_read_b64_tr_b16 v[78:79], v7 offset:4608
    v_mfma_f32_16x16x32_bf16 v[20:23], v[52:55], v[80:83], v[20:23]
    ds_read_b64_tr_b16 v[48:49], v4 offset:8192
    v_mfma_f32_16x16x32_bf16 v[36:39], v[52:55], v[84:87], v[36:39]
    ds_read_b64_tr_b16 v[50:51], v4 offset:8704
    s_waitcnt lgkmcnt(10)
    v_mfma_f32_16x16x32_bf16 v[24:27], v[56:59], v[80:83], v[24:27]
    buffer_load_dwordx4 v[132:135], v2, s[40:43], s72 offen offset:1024 sc1
    ds_read_b64_tr_b16 v[52:53], v5 offset:8192
    v_mfma_f32_16x16x32_bf16 v[40:43], v[56:59], v[84:87], v[40:43]
    ds_read_b64_tr_b16 v[54:55], v5 offset:8704
    v_mfma_f32_16x16x32_bf16 v[28:31], v[60:63], v[80:83], v[28:31]
    ds_read_b64_tr_b16 v[56:57], v6 offset:8192
    v_mfma_f32_16x16x32_bf16 v[44:47], v[60:63], v[84:87], v[44:47]
    ds_read_b64_tr_b16 v[58:59], v6 offset:8704
    s_waitcnt vmcnt(10) lgkmcnt(10)
    v_mfma_f32_16x16x32_bf16 v[16:19], v[64:67], v[88:91], v[16:19]
    buffer_load_dwordx4 v[136:139], v2, s[40:43], s72 offen offset:2048 sc1
    ds_read_b64_tr_b16 v[60:61], v7 offset:8192
    v_mfma_f32_16x16x32_bf16 v[32:35], v[64:67], v[92:95], v[32:35]
    ds_read_b64_tr_b16 v[62:63], v7 offset:8704
    v_mfma_f32_16x16x32_bf16 v[20:23], v[68:71], v[88:91], v[20:23]
    ds_read_b64_tr_b16 v[64:65], v4 offset:12288
    v_mfma_f32_16x16x32_bf16 v[36:39], v[68:71], v[92:95], v[36:39]
    ds_read_b64_tr_b16 v[66:67], v4 offset:12800
    s_waitcnt lgkmcnt(10)
    v_mfma_f32_16x16x32_bf16 v[24:27], v[72:75], v[88:91], v[24:27]
    buffer_load_dwordx4 v[140:143], v2, s[40:43], s72 offen offset:3072 sc1
    ds_read_b64_tr_b16 v[68:69], v5 offset:12288
    v_mfma_f32_16x16x32_bf16 v[40:43], v[72:75], v[92:95], v[40:43]
    s_add_u32 s72, s72, 4096
    ds_read_b64_tr_b16 v[70:71], v5 offset:12800
    v_mfma_f32_16x16x32_bf16 v[28:31], v[76:79], v[88:91], v[28:31]
    ds_read_b64_tr_b16 v[72:73], v6 offset:12288
    v_mfma_f32_16x16x32_bf16 v[44:47], v[76:79], v[92:95], v[44:47]
    ds_read_b64_tr_b16 v[74:75], v6 offset:12800
    s_waitcnt vmcnt(10) lgkmcnt(10)
    v_mfma_f32_16x16x32_bf16 v[16:19], v[48:51], v[96:99], v[16:19]
    buffer_load_dwordx4 v[80:83], v2, s[40:43], s72 offen offset:0 sc1
    ds_read_b64_tr_b16 v[76:77], v7 offset:12288
    v_mfma_f32_16x16x32_bf16 v[32:35], v[48:51], v[100:103], v[32:35]
    ds_read_b64_tr_b16 v[78:79], v7 offset:12800
    v_mfma_f32_16x16x32_bf16 v[20:23], v[52:55], v[96:99], v[20:23]
    ds_read_b64_tr_b16 v[48:49], v4 offset:16384
    v_mfma_f32_16x16x32_bf16 v[36:39], v[52:55], v[100:103], v[36:39]
    ds_read_b64_tr_b16 v[50:51], v4 offset:16896
    s_waitcnt lgkmcnt(10)
    v_mfma_f32_16x16x32_bf16 v[24:27], v[56:59], v[96:99], v[24:27]
    buffer_load_dwordx4 v[84:87], v2, s[40:43], s72 offen offset:1024 sc1
    ds_read_b64_tr_b16 v[52:53], v5 offset:16384
    v_mfma_f32_16x16x32_bf16 v[40:43], v[56:59], v[100:103], v[40:43]
    ds_read_b64_tr_b16 v[54:55], v5 offset:16896
    v_mfma_f32_16x16x32_bf16 v[28:31], v[60:63], v[96:99], v[28:31]
    ds_read_b64_tr_b16 v[56:57], v6 offset:16384
    v_mfma_f32_16x16x32_bf16 v[44:47], v[60:63], v[100:103], v[44:47]
    ds_read_b64_tr_b16 v[58:59], v6 offset:16896
    s_waitcnt vmcnt(10) lgkmcnt(10)
    v_mfma_f32_16x16x32_bf16 v[16:19], v[64:67], v[104:107], v[16:19]
    buffer_load_dwordx4 v[88:91], v2, s[40:43], s72 offen offset:2048 sc1
    ds_read_b64_tr_b16 v[60:61], v7 offset:16384
    v_mfma_f32_16x16x32_bf16 v[32:35], v[64:67], v[108:111], v[32:35]
    ds_read_b64_tr_b16 v[62:63], v7 offset:16896
    v_mfma_f32_16x16x32_bf16 v[20:23], v[68:71], v[104:107], v[20:23]
    ds_read_b64_tr_b16 v[64:65], v4 offset:20480
    v_mfma_f32_16x16x32_bf16 v[36:39], v[68:71], v[108:111], v[36:39]
    ds_read_b64_tr_b16 v[66:67], v4 offset:20992
    s_waitcnt lgkmcnt(10)
    v_mfma_f32_16x16x32_bf16 v[24:27], v[72:75], v[104:107], v[24:27]
    buffer_load_dwordx4 v[92:95], v2, s[40:43], s72 offen offset:3072 sc1
    ds_read_b64_tr_b16 v[68:69], v5 offset:20480
    v_mfma_f32_16x16x32_bf16 v[40:43], v[72:75], v[108:111], v[40:43]
    s_add_u32 s72, s72, 4096
    ds_read_b64_tr_b16 v[70:71], v5 offset:20992
    v_mfma_f32_16x16x32_bf16 v[28:31], v[76:79], v[104:107], v[28:31]
    ds_read_b64_tr_b16 v[72:73], v6 offset:20480
    v_mfma_f32_16x16x32_bf16 v[44:47], v[76:79], v[108:111], v[44:47]
    ds_read_b64_tr_b16 v[74:75], v6 offset:20992
    s_waitcnt vmcnt(10) lgkmcnt(10)
    v_mfma_f32_16x16x32_bf16 v[16:19], v[48:51], v[112:115], v[16:19]
    buffer_load_dwordx4 v[96:99], v2, s[40:43], s72 offen offset:0 sc1
    ds_read_b64_tr_b16 v[76:77], v7 offset:20480
    v_mfma_f32_16x16x32_bf16 v[32:35], v[48:51], v[116:119], v[32:35]
    ds_read_b64_tr_b16 v[78:79], v7 offset:20992
    v_mfma_f32_16x16x32_bf16 v[20:23], v[52:55], v[112:115], v[20:23]
    s_add_u32 s74, s74, 0x8000
    ds_read_b64_tr_b16 v[48:49], v4 offset:24576
    v_mfma_f32_16x16x32_bf16 v[36:39], v[52:55], v[116:119], v[36:39]
    ds_read_b64_tr_b16 v[50:51], v4 offset:25088
    s_waitcnt lgkmcnt(10)
    v_mfma_f32_16x16x32_bf16 v[24:27], v[56:59], v[112:115], v[24:27]
    buffer_load_dwordx4 v[100:103], v2, s[40:43], s72 offen offset:1024 sc1
    ds_read_b64_tr_b16 v[52:53], v5 offset:24576
    v_mfma_f32_16x16x32_bf16 v[40:43], v[56:59], v[116:119], v[40:43]
    ds_read_b64_tr_b16 v[54:55], v5 offset:25088
    v_mfma_f32_16x16x32_bf16 v[28:31], v[60:63], v[112:115], v[28:31]
    s_and_b32 s74, s74, 0x1ffff
    ds_read_b64_tr_b16 v[56:57], v6 offset:24576
    v_mfma_f32_16x16x32_bf16 v[44:47], v[60:63], v[116:119], v[44:47]
    ds_read_b64_tr_b16 v[58:59], v6 offset:25088
    s_waitcnt vmcnt(10) lgkmcnt(10)
    v_mfma_f32_16x16x32_bf16 v[16:19], v[64:67], v[120:123], v[16:19]
    buffer_load_dwordx4 v[104:107], v2, s[40:43], s72 offen offset:2048 sc1
    ds_read_b64_tr_b16 v[60:61], v7 offset:24576
    v_mfma_f32_16x16x32_bf16 v[32:35], v[64:67], v[124:127], v[32:35]
    ds_read_b64_tr_b16 v[62:63], v7 offset:25088
    v_mfma_f32_16x16x32_bf16 v[20:23], v[68:71], v[120:123], v[20:23]
    ds_read_b64_tr_b16 v[64:65], v4 offset:28672
    v_mfma_f32_16x16x32_bf16 v[36:39], v[68:71], v[124:127], v[36:39]
    ds_read_b64_tr_b16 v[66:67], v4 offset:29184
    s_waitcnt lgkmcnt(10)
    v_mfma_f32_16x16x32_bf16 v[24:27], v[72:75], v[120:123], v[24:27]
    buffer_load_dwordx4 v[108:111], v2, s[40:43], s72 offen offset:3072 sc1
    ds_read_b64_tr_b16 v[68:69], v5 offset:28672
    v_mfma_f32_16x16x32_bf16 v[40:43], v[72:75], v[124:127], v[40:43]
    s_add_u32 s72, s72, 4096
    v_add_u32 v4, s74, v8
    ds_read_b64_tr_b16 v[70:71], v5 offset:29184
    v_mfma_f32_16x16x32_bf16 v[28:31], v[76:79], v[120:123], v[28:31]
    ds_read_b64_tr_b16 v[72:73], v6 offset:28672
    v_mfma_f32_16x16x32_bf16 v[44:47], v[76:79], v[124:127], v[44:47]
    ds_read_b64_tr_b16 v[74:75], v6 offset:29184
    s_waitcnt vmcnt(10) lgkmcnt(10)
    v_mfma_f32_16x16x32_bf16 v[16:19], v[48:51], v[128:131], v[16:19]
    buffer_load_dwordx4 v[112:115], v2, s[40:43], s72 offen offset:0 sc1
    ds_read_b64_tr_b16 v[76:77], v7 offset:28672
    v_mfma_f32_16x16x32_bf16 v[32:35], v[48:51], v[132:135], v[32:35]
    v_add_u32 v5, s74, v9
    ds_read_b64_tr_b16 v[78:79], v7 offset:29184
    v_mfma_f32_16x16x32_bf16 v[20:23], v[52:55], v[128:131], v[20:23]
    s_barrier
    ds_read_b64_tr_b16 v[48:49], v4 offset:0
    v_mfma_f32_16x16x32_bf16 v[36:39], v[52:55], v[132:135], v[36:39]
    ds_read_b64_tr_b16 v[50:51], v4 offset:512
    s_waitcnt lgkmcnt(10)
    v_mfma_f32_16x16x32_bf16 v[24:27], v[56:59], v[128:131], v[24:27]
    buffer_load_dwordx4 v[116:119], v2, s[40:43], s72 offen offset:1024 sc1
    ds_read_b64_tr_b16 v[52:53], v5 offset:0
    v_mfma_f32_16x16x32_bf16 v[40:43], v[56:59], v[132:135], v[40:43]
    v_add_u32 v6, s74, v10
    ds_read_b64_tr_b16 v[54:55], v5 offset:512
    v_mfma_f32_16x16x32_bf16 v[28:31], v[60:63], v[128:131], v[28:31]
    v_add_u32 v7, s74, v11
    ds_read_b64_tr_b16 v[56:57], v6 offset:0
    v_mfma_f32_16x16x32_bf16 v[44:47], v[60:63], v[132:135], v[44:47]
    ds_read_b64_tr_b16 v[58:59], v6 offset:512
    s_waitcnt vmcnt(10) lgkmcnt(10)
    v_mfma_f32_16x16x32_bf16 v[16:19], v[64:67], v[136:139], v[16:19]
    buffer_load_dwordx4 v[120:123], v2, s[40:43], s72 offen offset:2048 sc1
    ds_read_b64_tr_b16 v[60:61], v7 offset:0
    v_mfma_f32_16x16x32_bf16 v[32:35], v[64:67], v[140:143], v[32:35]
    ds_read_b64_tr_b16 v[62:63], v7 offset:512
    v_mfma_f32_16x16x32_bf16 v[20:23], v[68:71], v[136:139], v[20:23]
    s_sub_u32 s73, s73, 1
    ds_read_b64_tr_b16 v[64:65], v4 offset:4096
    v_mfma_f32_16x16x32_bf16 v[36:39], v[68:71], v[140:143], v[36:39]
    ds_read_b64_tr_b16 v[66:67], v4 offset:4608
    s_waitcnt lgkmcnt(10)
    v_mfma_f32_16x16x32_bf16 v[24:27], v[72:75], v[136:139], v[24:27]
    buffer_load_dwordx4 v[124:127], v2, s[40:43], s72 offen offset:3072 sc1
    ds_read_b64_tr_b16 v[68:69], v5 offset:4096
    v_mfma_f32_16x16x32_bf16 v[40:43], v[72:75], v[140:143], v[40:43]
    s_add_u32 s72, s72, 4096
    ds_read_b64_tr_b16 v[70:71], v5 offset:4608
    v_mfma_f32_16x16x32_bf16 v[28:31], v[76:79], v[136:139], v[28:31]
    ds_read_b64_tr_b16 v[72:73], v6 offset:4096
    v_mfma_f32_16x16x32_bf16 v[44:47], v[76:79], v[140:143], v[44:47]
    ds_read_b64_tr_b16 v[74:75], v6 offset:4608
    s_cmp_lg_u32 s73, 0
    s_cbranch_scc1 L_mainc_ql
    s_waitcnt vmcnt(10) lgkmcnt(10)
    v_mfma_f32_16x16x32_bf16 v[16:19], v[48:51], v[80:83], v[16:19]
    buffer_load_dwordx4 v[128:131], v2, s[40:43], s72 offen offset:0 sc1
    ds_read_b64_tr_b16 v[76:77], v7 offset:4096
    v_mfma_f32_16x16x32_bf16 v[32:35], v[48:51], v[84:87], v[32:35]
    ds_read_b64_tr_b16 v[78:79], v7 offset:4608
    v_mfma_f32_16x16x32_bf16 v[20:23], v[52:55], v[80:83], v[20:23]
    ds_read_b64_tr_b16 v[48:49], v4 offset:8192
    v_mfma_f32_16x16x32_bf16 v[36:39], v[52:55], v[84:87], v[36:39]
    ds_read_b64_tr_b16 v[50:51], v4 offset:8704
    s_waitcnt lgkmcnt(10)
    v_mfma_f32_16x16x32_bf16 v[24:27], v[56:59], v[80:83], v[24:27]
    buffer_load_dwordx4 v[132:135], v2, s[40:43], s72 offen offset:1024 sc1
    ds_read_b64_tr_b16 v[52:53], v5 offset:8192
    v_mfma_f32_16x16x32_bf16 v[40:43], v[56:59], v[84:87], v[40:43]
    ds_read_b64_tr_b16 v[54:55], v5 offset:8704
    v_mfma_f32_16x16x32_bf16 v[28:31], v[60:63], v[80:83], v[28:31]
    ds_read_b64_tr_b16 v[56:57], v6 offset:8192
    v_mfma_f32_16x16x32_bf16 v[44:47], v[60:63], v[84:87], v[44:47]
    ds_read_b64_tr_b16 v[58:59], v6 offset:8704
    s_waitcnt vmcnt(10) lgkmcnt(10)
    v_mfma_f32_16x16x32_bf16 v[16:19], v[64:67], v[88:91], v[16:19]
    buffer_load_dwordx4 v[136:139], v2, s[40:43], s72 offen offset:2048 sc1
    ds_read_b64_tr_b16 v[60:61], v7 offset:8192
    v_mfma_f32_16x16x32_bf16 v[32:35], v[64:67], v[92:95], v[32:35]
    ds_read_b64_tr_b16 v[62:63], v7 offset:8704
    v_mfma_f32_16x16x32_bf16 v[20:23], v[68:71], v[88:91], v[20:23]
    ds_read_b64_tr_b16 v[64:65], v4 offset:12288
    v_mfma_f32_16x16x32_bf16 v[36:39], v[68:71], v[92:95], v[36:39]
    ds_read_b64_tr_b16 v[66:67], v4 offset:12800
    s_waitcnt lgkmcnt(10)
    v_mfma_f32_16x16x32_bf16 v[24:27], v[72:75], v[88:91], v[24:27]
    buffer_load_dwordx4 v[140:143], v2, s[40:43], s72 offen offset:3072 sc1
    ds_read_b64_tr_b16 v[68:69], v5 offset:12288
    v_mfma_f32_16x16x32_bf16 v[40:43], v[72:75], v[92:95], v[40:43]
    s_add_u32 s72, s72, 4096
    ds_read_b64_tr_b16 v[70:71], v5 offset:12800
    v_mfma_f32_16x16x32_bf16 v[28:31], v[76:79], v[88:91], v[28:31]
    ds_read_b64_tr_b16 v[72:73], v6 offset:12288
    v_mfma_f32_16x16x32_bf16 v[44:47], v[76:79], v[92:95], v[44:47]
    ds_read_b64_tr_b16 v[74:75], v6 offset:12800
    s_waitcnt vmcnt(10) lgkmcnt(10)
    v_mfma_f32_16x16x32_bf16 v[16:19], v[48:51], v[96:99], v[16:19]
    ds_read_b64_tr_b16 v[76:77], v7 offset:12288
    v_mfma_f32_16x16x32_bf16 v[32:35], v[48:51], v[100:103], v[32:35]
    ds_read_b64_tr_b16 v[78:79], v7 offset:12800
    v_mfma_f32_16x16x32_bf16 v[20:23], v[52:55], v[96:99], v[20:23]
    s_mov_b32 s52, 0x156000
    buffer_load_dwordx4 v[216:219], v2, s[36:39], s52 offen sc1
    ds_read_b64_tr_b16 v[48:49], v4 offset:16384
    v_mfma_f32_16x16x32_bf16 v[36:39], v[52:55], v[100:103], v[36:39]
    ds_read_b64_tr_b16 v[50:51], v4 offset:16896
    s_waitcnt lgkmcnt(10)
    v_mfma_f32_16x16x32_bf16 v[24:27], v[56:59], v[96:99], v[24:27]
    ds_read_b64_tr_b16 v[52:53], v5 offset:16384
    v_mfma_f32_16x16x32_bf16 v[40:43], v[56:59], v[100:103], v[40:43]
    ds_read_b64_tr_b16 v[54:55], v5 offset:16896
    v_mfma_f32_16x16x32_bf16 v[28:31], v[60:63], v[96:99], v[28:31]
    s_mov_b32 s52, 253952
    buffer_load_dwordx4 v[184:187], v2, s[48:51], s52 offen sc1
    buffer_load_dwordx4 v[188:191], v2, s[48:51], s52 offen offset:1024 sc1
    ds_read_b64_tr_b16 v[56:57], v6 offset:16384
    v_mfma_f32_16x16x32_bf16 v[44:47], v[60:63], v[100:103], v[44:47]
    ds_read_b64_tr_b16 v[58:59], v6 offset:16896
    s_waitcnt vmcnt(11) lgkmcnt(10)
    v_mfma_f32_16x16x32_bf16 v[16:19], v[64:67], v[104:107], v[16:19]
    ds_read_b64_tr_b16 v[60:61], v7 offset:16384
    v_mfma_f32_16x16x32_bf16 v[32:35], v[64:67], v[108:111], v[32:35]
    ds_read_b64_tr_b16 v[62:63], v7 offset:16896
    v_mfma_f32_16x16x32_bf16 v[20:23], v[68:71], v[104:107], v[20:23]
    s_mov_b32 s52, 258048
    buffer_load_dwordx4 v[192:195], v2, s[48:51], s52 offen sc1
    buffer_load_dwordx4 v[196:199], v2, s[48:51], s52 offen offset:1024 sc1
    ds_read_b64_tr_b16 v[64:65], v4 offset:20480
    v_mfma_f32_16x16x32_bf16 v[36:39], v[68:71], v[108:111], v[36:39]
    ds_read_b64_tr_b16 v[66:67], v4 offset:20992
    s_waitcnt lgkmcnt(10)
    v_mfma_f32_16x16x32_bf16 v[24:27], v[72:75], v[104:107], v[24:27]
    ds_read_b64_tr_b16 v[68:69], v5 offset:20480
    v_mfma_f32_16x16x32_bf16 v[40:43], v[72:75], v[108:111], v[40:43]
    ds_read_b64_tr_b16 v[70:71], v5 offset:20992
    v_mfma_f32_16x16x32_bf16 v[28:31], v[76:79], v[104:107], v[28:31]
    ds_read_b64_tr_b16 v[72:73], v6 offset:20480
    v_mfma_f32_16x16x32_bf16 v[44:47], v[76:79], v[108:111], v[44:47]
    ds_read_b64_tr_b16 v[74:75], v6 offset:20992
    s_waitcnt vmcnt(11) lgkmcnt(10)
    v_mfma_f32_16x16x32_bf16 v[16:19], v[48:51], v[112:115], v[16:19]
    ds_read_b64_tr_b16 v[76:77], v7 offset:20480
    v_mfma_f32_16x16x32_bf16 v[32:35], v[48:51], v[116:119], v[32:35]
    ds_read_b64_tr_b16 v[78:79], v7 offset:20992
    v_mfma_f32_16x16x32_bf16 v[20:23], v[52:55], v[112:115], v[20:23]
    ds_read_b64_tr_b16 v[48:49], v4 offset:24576
    v_mfma_f32_16x16x32_bf16 v[36:39], v[52:55], v[116:119], v[36:39]
    ds_read_b64_tr_b16 v[50:51], v4 offset:25088
    s_waitcnt lgkmcnt(10)
    v_mfma_f32_16x16x32_bf16 v[24:27], v[56:59], v[112:115], v[24:27]
    ds_read_b64_tr_b16 v[52:53], v5 offset:24576
    v_mfma_f32_16x16x32_bf16 v[40:43], v[56:59], v[116:119], v[40:43]
    ds_read_b64_tr_b16 v[54:55], v5 offset:25088
    v_mfma_f32_16x16x32_bf16 v[28:31], v[60:63], v[112:115], v[28:31]
    ds_read_b64_tr_b16 v[56:57], v6 offset:24576
    v_mfma_f32_16x16x32_bf16 v[44:47], v[60:63], v[116:119], v[44:47]
    ds_read_b64_tr_b16 v[58:59], v6 offset:25088
    s_waitcnt vmcnt(9) lgkmcnt(10)
    v_mfma_f32_16x16x32_bf16 v[16:19], v[64:67], v[120:123], v[16:19]
    ds_read_b64_tr_b16 v[60:61], v7 offset:24576
    v_mfma_f32_16x16x32_bf16 v[32:35], v[64:67], v[124:127], v[32:35]
    ds_read_b64_tr_b16 v[62:63], v7 offset:25088
    v_mfma_f32_16x16x32_bf16 v[20:23], v[68:71], v[120:123], v[20:23]
    ds_read_b64_tr_b16 v[64:65], v4 offset:28672
    v_mfma_f32_16x16x32_bf16 v[36:39], v[68:71], v[124:127], v[36:39]
    ds_read_b64_tr_b16 v[66:67], v4 offset:29184
    s_waitcnt lgkmcnt(10)
    v_mfma_f32_16x16x32_bf16 v[24:27], v[72:75], v[120:123], v[24:27]
    ds_read_b64_tr_b16 v[68:69], v5 offset:28672
    v_mfma_f32_16x16x32_bf16 v[40:43], v[72:75], v[124:127], v[40:43]
    ds_read_b64_tr_b16 v[70:71], v5 offset:29184
    v_mfma_f32_16x16x32_bf16 v[28:31], v[76:79], v[120:123], v[28:31]
    ds_read_b64_tr_b16 v[72:73], v6 offset:28672
    v_mfma_f32_16x16x32_bf16 v[44:47], v[76:79], v[124:127], v[44:47]
    ds_read_b64_tr_b16 v[74:75], v6 offset:29184
    s_waitcnt vmcnt(7) lgkmcnt(10)
    v_mfma_f32_16x16x32_bf16 v[16:19], v[48:51], v[128:131], v[16:19]
    ds_read_b64_tr_b16 v[76:77], v7 offset:28672
    v_mfma_f32_16x16x32_bf16 v[32:35], v[48:51], v[132:135], v[32:35]
    ds_read_b64_tr_b16 v[78:79], v7 offset:29184
    v_mfma_f32_16x16x32_bf16 v[20:23], v[52:55], v[128:131], v[20:23]
    v_mfma_f32_16x16x32_bf16 v[36:39], v[52:55], v[132:135], v[36:39]
    s_waitcnt lgkmcnt(8)
    v_mfma_f32_16x16x32_bf16 v[24:27], v[56:59], v[128:131], v[24:27]
    v_mfma_f32_16x16x32_bf16 v[40:43], v[56:59], v[132:135], v[40:43]
    v_mfma_f32_16x16x32_bf16 v[28:31], v[60:63], v[128:131], v[28:31]
    v_mfma_f32_16x16x32_bf16 v[44:47], v[60:63], v[132:135], v[44:47]
    s_waitcnt vmcnt(5) lgkmcnt(4)
    v_mfma_f32_16x16x32_bf16 v[16:19], v[64:67], v[136:139], v[16:19]
    v_mfma_f32_16x16x32_bf16 v[32:35], v[64:67], v[140:143], v[32:35]
    v_mfma_f32_16x16x32_bf16 v[20:23], v[68:71], v[136:139], v[20:23]
    v_mfma_f32_16x16x32_bf16 v[36:39], v[68:71], v[140:143], v[36:39]
    s_waitcnt lgkmcnt(0)
    v_mfma_f32_16x16x32_bf16 v[24:27], v[72:75], v[136:139], v[24:27]
    v_mfma_f32_16x16x32_bf16 v[40:43], v[72:75], v[140:143], v[40:43]
    v_mfma_f32_16x16x32_bf16 v[28:31], v[76:79], v[136:139], v[28:31]
    v_mfma_f32_16x16x32_bf16 v[44:47], v[76:79], v[140:143], v[44:47]
    s_waitcnt vmcnt(4)
    v_max_f32 v216, v216, v218
    s_nop 1
    v_max_f32_dpp v216, v216, v216 quad_perm:[1,0,3,2] row_mask:0xf bank_mask:0xf
    s_nop 1
    v_max_f32_dpp v216, v216, v216 quad_perm:[2,3,0,1] row_mask:0xf bank_mask:0xf
    s_nop 1
    v_max_f32_dpp v216, v216, v216 row_half_mirror row_mask:0xf bank_mask:0xf
    s_nop 1
    v_max_f32_dpp v216, v216, v216 row_mirror row_mask:0xf bank_mask:0xf
    v_mov_b32 v217, v216
    s_nop 1
    v_permlane16_swap_b32 v217, v216
    s_nop 0
    v_max_f32 v216, v216, v217
    v_mov_b32 v217, v216
    s_nop 1
    v_permlane32_swap_b32 v217, v216
    s_nop 0
    v_max_f32 v216, v216, v217
    v_cvt_pk_bf16_f32 v48, v16, v17
    v_cvt_pk_bf16_f32 v49, v18, v19
    v_cvt_pk_bf16_f32 v50, v32, v33
    v_cvt_pk_bf16_f32 v51, v34, v35
    v_cvt_pk_bf16_f32 v52, v20, v21
    v_cvt_pk_bf16_f32 v53, v22, v23
    v_cvt_pk_bf16_f32 v54, v36, v37
    v_cvt_pk_bf16_f32 v55, v38, v39
    v_cvt_pk_bf16_f32 v56, v24, v25
    v_cvt_pk_bf16_f32 v57, v26, v27
    v_cvt_pk_bf16_f32 v58, v40, v41
    v_cvt_pk_bf16_f32 v59, v42, v43
    v_cvt_pk_bf16_f32 v60, v28, v29
    v_cvt_pk_bf16_f32 v61, v30, v31
    v_cvt_pk_bf16_f32 v62, v44, v45
    v_cvt_pk_bf16_f32 v63, v46, v47
    v_mov_b32 v12, 0
    v_mov_b32 v13, 0
    v_permlane16_swap_b32 v48, v50
    v_permlane16_swap_b32 v49, v51
    v_permlane16_swap_b32 v52, v54
    v_permlane16_swap_b32 v53, v55
    v_permlane16_swap_b32 v56, v58
    v_permlane16_swap_b32 v57, v59
    v_permlane16_swap_b32 v60, v62
    v_permlane16_swap_b32 v61, v63
    v_dot2_f32_bf16 v12, v48, v48, v12
    v_dot2_f32_bf16 v13, v56, v56, v13
    v_dot2_f32_bf16 v12, v49, v49, v12
    v_dot2_f32_bf16 v13, v57, v57, v13
    v_dot2_f32_bf16 v12, v50, v50, v12
    v_dot2_f32_bf16 v13, v58, v58, v13
    v_dot2_f32_bf16 v12, v51, v51, v12
    v_dot2_f32_bf16 v13, v59, v59, v13
    v_dot2_f32_bf16 v12, v52, v52, v12
    v_dot2_f32_bf16 v13, v60, v60, v13
    v_dot2_f32_bf16 v12, v53, v53, v12
    v_dot2_f32_bf16 v13, v61, v61, v13
    v_dot2_f32_bf16 v12, v54, v54, v12
    v_dot2_f32_bf16 v13, v62, v62, v13
    v_dot2_f32_bf16 v12, v55, v55, v12
    v_dot2_f32_bf16 v13, v63, v63, v13
    v_pk_mov_b32 v[16:17], 0, 0
    v_pk_mov_b32 v[18:19], 0, 0
    v_pk_mov_b32 v[20:21], 0, 0
    v_pk_mov_b32 v[22:23], 0, 0
    v_pk_mov_b32 v[24:25], 0, 0
    v_pk_mov_b32 v[26:27], 0, 0
    v_pk_mov_b32 v[28:29], 0, 0
    v_pk_mov_b32 v[30:31], 0, 0
    v_mov_b32 v14, v12
    v_mov_b32 v15, v13
    s_nop 0
    v_permlane32_swap_b32 v14, v12
    v_permlane32_swap_b32 v15, v13
    s_nop 0
    v_add_f32 v12, v12, v14
    v_add_f32 v13, v13, v15
    v_mul_f32 v12, v12, v216
    v_mul_f32 v13, v13, v216
    v_sqrt_f32 v12, v12
    v_sqrt_f32 v13, v13
    s_mov_b32 s72, 6
    v_sub_f32 v12, 0x42480000, v12
    v_sub_f32 v13, 0x42480000, v13
    v_pk_mov_b32 v[64:65], v[12:13], v[12:13] op_sel:[0,0]
    v_pk_mov_b32 v[66:67], v[12:13], v[12:13] op_sel:[0,0]
    v_pk_mov_b32 v[68:69], v[12:13], v[12:13] op_sel:[0,0]
    v_pk_mov_b32 v[70:71], v[12:13], v[12:13] op_sel:[0,0]
    v_pk_mov_b32 v[72:73], v[12:13], v[12:13] op_sel:[0,0]
    v_pk_mov_b32 v[74:75], v[12:13], v[12:13] op_sel:[0,0]
    v_pk_mov_b32 v[76:77], v[12:13], v[12:13] op_sel:[0,0]
    v_pk_mov_b32 v[78:79], v[12:13], v[12:13] op_sel:[0,0]
    s_waitcnt vmcnt(0)
    v_mov_b32 v4, v2
    v_mfma_f32_32x32x16_bf16 v[96:111], v[184:187], v[48:51], v[64:79]
    v_mfma_f32_32x32x16_bf16 v[96:111], v[188:191], v[52:55], v[96:111]
    v_pk_mov_b32 v[80:81], v[12:13], v[12:13] op_sel:[1,1]
    v_pk_mov_b32 v[82:83], v[12:13], v[12:13] op_sel:[1,1]
    v_pk_mov_b32 v[84:85], v[12:13], v[12:13] op_sel:[1,1]
    v_pk_mov_b32 v[86:87], v[12:13], v[12:13] op_sel:[1,1]
    v_pk_mov_b32 v[88:89], v[12:13], v[12:13] op_sel:[1,1]
    v_pk_mov_b32 v[90:91], v[12:13], v[12:13] op_sel:[1,1]
    v_pk_mov_b32 v[92:93], v[12:13], v[12:13] op_sel:[1,1]
    v_pk_mov_b32 v[94:95], v[12:13], v[12:13] op_sel:[1,1]
    s_mov_b32 s73, 0
    s_nop 1
L_mainc_al:
    s_barrier
    v_mfma_f32_32x32x16_bf16 v[112:127], v[184:187], v[56:59], v[80:95]
    v_exp_f32 v128, v96
    v_exp_f32 v129, v97
    v_exp_f32 v130, v98
    v_mfma_f32_32x32x16_bf16 v[112:127], v[188:191], v[60:63], v[112:127]
    v_exp_f32 v131, v99
    v_exp_f32 v132, v100
    v_exp_f32 v133, v101
    v_smfmac_f32_32x32x32_bf16 v[160:175], v[200:203], v[16:23], v212
    s_waitcnt lgkmcnt(0)
    v_exp_f32 v134, v102
    v_exp_f32 v135, v103
    v_exp_f32 v136, v104
    v_smfmac_f32_16x16x64_bf16 v[180:183], v[208:211], v[16:23], v212
    ds_read_b128 v[200:203], v4 offset:2048
    v_exp_f32 v137, v105
    v_exp_f32 v138, v106
    v_smfmac_f32_32x32x32_bf16 v[160:175], v[204:207], v[24:31], v212
    v_exp_f32 v139, v107
    v_exp_f32 v140, v108
    v_exp_f32 v141, v109
    v_smfmac_f32_16x16x64_bf16 v[180:183], v[208:211], v[24:31], v212
    ds_read_b128 v[204:207], v4 offset:3072
    v_exp_f32 v142, v110
    v_exp_f32 v143, v111
    v_mfma_f32_32x32x16_bf16 v[96:111], v[192:195], v[48:51], v[64:79]
    v_exp_f32 v16, v112
    v_exp_f32 v17, v113
    v_exp_f32 v18, v114
    v_mfma_f32_32x32x16_bf16 v[96:111], v[196:199], v[52:55], v[96:111]
    s_waitcnt lgkmcnt(1)
    v_exp_f32 v19, v115
    v_exp_f32 v20, v116
    v_exp_f32 v21, v117
    v_smfmac_f32_32x32x32_bf16 v[144:159], v[200:203], v[128:135], v212
    s_waitcnt lgkmcnt(0)
    v_exp_f32 v22, v118
    v_exp_f32 v23, v119
    v_exp_f32 v24, v120
    v_smfmac_f32_16x16x64_bf16 v[176:179], v[208:211], v[128:135], v212
    ds_read_b128 v[184:187], v4 offset:0
    v_exp_f32 v25, v121
    v_exp_f32 v26, v122
    v_smfmac_f32_32x32x32_bf16 v[144:159], v[204:207], v[136:143], v212
    v_exp_f32 v27, v123
    v_exp_f32 v28, v124
    v_exp_f32 v29, v125
    v_smfmac_f32_16x16x64_bf16 v[176:179], v[208:211], v[136:143], v212
    ds_read_b128 v[188:191], v4 offset:1024
    v_exp_f32 v30, v126
    v_exp_f32 v31, v127
    v_mfma_f32_32x32x16_bf16 v[112:127], v[192:195], v[56:59], v[80:95]
    v_exp_f32 v128, v96
    v_exp_f32 v129, v97
    v_exp_f32 v130, v98
    v_mfma_f32_32x32x16_bf16 v[112:127], v[196:199], v[60:63], v[112:127]
    v_exp_f32 v131, v99
    v_exp_f32 v132, v100
    v_exp_f32 v133, v101
    v_smfmac_f32_32x32x32_bf16 v[160:175], v[200:203], v[16:23], v212
    s_waitcnt lgkmcnt(0)
    v_exp_f32 v134, v102
    v_exp_f32 v135, v103
    v_exp_f32 v136, v104
    v_smfmac_f32_16x16x64_bf16 v[180:183], v[208:211], v[16:23], v212
    ds_read_b128 v[200:203], v4 offset:6144
    v_exp_f32 v137, v105
    v_exp_f32 v138, v106
    v_smfmac_f32_32x32x32_bf16 v[160:175], v[204:207], v[24:31], v212
    v_exp_f32 v139, v107
    v_exp_f32 v140, v108
    v_exp_f32 v141, v109
    v_smfmac_f32_16x16x64_bf16 v[180:183], v[208:211], v[24:31], v212
    ds_read_b128 v[204:207], v4 offset:7168
    v_exp_f32 v142, v110
    v_exp_f32 v143, v111
    v_mfma_f32_32x32x16_bf16 v[96:111], v[184:187], v[48:51], v[64:79]
    v_exp_f32 v16, v112
    v_exp_f32 v17, v113
    v_exp_f32 v18, v114
    v_mfma_f32_32x32x16_bf16 v[96:111], v[188:191], v[52:55], v[96:111]
    s_waitcnt lgkmcnt(1)
    v_exp_f32 v19, v115
    v_exp_f32 v20, v116
    v_exp_f32 v21, v117
    v_smfmac_f32_32x32x32_bf16 v[144:159], v[200:203], v[128:135], v212
    s_waitcnt lgkmcnt(0)
    v_exp_f32 v22, v118
    v_exp_f32 v23, v119
    v_exp_f32 v24, v120
    v_smfmac_f32_16x16x64_bf16 v[176:179], v[208:211], v[128:135], v212
    ds_read_b128 v[192:195], v4 offset:4096
    v_exp_f32 v25, v121
    v_exp_f32 v26, v122
    v_smfmac_f32_32x32x32_bf16 v[144:159], v[204:207], v[136:143], v212
    v_exp_f32 v27, v123
    v_exp_f32 v28, v124
    v_exp_f32 v29, v125
    v_smfmac_f32_16x16x64_bf16 v[176:179], v[208:211], v[136:143], v212
    ds_read_b128 v[196:199], v4 offset:5120
    v_exp_f32 v30, v126
    v_exp_f32 v31, v127
    v_mfma_f32_32x32x16_bf16 v[112:127], v[184:187], v[56:59], v[80:95]
    v_exp_f32 v128, v96
    v_exp_f32 v129, v97
    v_exp_f32 v130, v98
    v_mfma_f32_32x32x16_bf16 v[112:127], v[188:191], v[60:63], v[112:127]
    v_exp_f32 v131, v99
    v_exp_f32 v132, v100
    v_exp_f32 v133, v101
    v_smfmac_f32_32x32x32_bf16 v[160:175], v[200:203], v[16:23], v212
    s_waitcnt lgkmcnt(0)
    v_exp_f32 v134, v102
    v_exp_f32 v135, v103
    v_exp_f32 v136, v104
    v_smfmac_f32_16x16x64_bf16 v[180:183], v[208:211], v[16:23], v212
    ds_read_b128 v[200:203], v4 offset:10240
    v_exp_f32 v137, v105
    v_exp_f32 v138, v106
    v_smfmac_f32_32x32x32_bf16 v[160:175], v[204:207], v[24:31], v212
    v_exp_f32 v139, v107
    v_exp_f32 v140, v108
    v_exp_f32 v141, v109
    v_smfmac_f32_16x16x64_bf16 v[180:183], v[208:211], v[24:31], v212
    ds_read_b128 v[204:207], v4 offset:11264
    v_exp_f32 v142, v110
    v_exp_f32 v143, v111
    v_mfma_f32_32x32x16_bf16 v[96:111], v[192:195], v[48:51], v[64:79]
    v_exp_f32 v16, v112
    v_exp_f32 v17, v113
    v_exp_f32 v18, v114
    v_mfma_f32_32x32x16_bf16 v[96:111], v[196:199], v[52:55], v[96:111]
    s_waitcnt lgkmcnt(1)
    v_exp_f32 v19, v115
    v_exp_f32 v20, v116
    v_exp_f32 v21, v117
    v_smfmac_f32_32x32x32_bf16 v[144:159], v[200:203], v[128:135], v212
    s_waitcnt lgkmcnt(0)
    v_exp_f32 v22, v118
    v_exp_f32 v23, v119
    v_exp_f32 v24, v120
    v_smfmac_f32_16x16x64_bf16 v[176:179], v[208:211], v[128:135], v212
    ds_read_b128 v[184:187], v4 offset:8192
    v_exp_f32 v25, v121
    v_exp_f32 v26, v122
    v_smfmac_f32_32x32x32_bf16 v[144:159], v[204:207], v[136:143], v212
    v_exp_f32 v27, v123
    v_exp_f32 v28, v124
    v_exp_f32 v29, v125
    v_smfmac_f32_16x16x64_bf16 v[176:179], v[208:211], v[136:143], v212
    ds_read_b128 v[188:191], v4 offset:9216
    v_exp_f32 v30, v126
    v_exp_f32 v31, v127
    v_mfma_f32_32x32x16_bf16 v[112:127], v[192:195], v[56:59], v[80:95]
    v_exp_f32 v128, v96
    v_exp_f32 v129, v97
    v_exp_f32 v130, v98
    v_mfma_f32_32x32x16_bf16 v[112:127], v[196:199], v[60:63], v[112:127]
    v_exp_f32 v131, v99
    v_exp_f32 v132, v100
    v_exp_f32 v133, v101
    v_smfmac_f32_32x32x32_bf16 v[160:175], v[200:203], v[16:23], v212
    s_waitcnt lgkmcnt(0)
    v_exp_f32 v134, v102
    v_exp_f32 v135, v103
    v_exp_f32 v136, v104
    v_smfmac_f32_16x16x64_bf16 v[180:183], v[208:211], v[16:23], v212
    ds_read_b128 v[200:203], v4 offset:14336
    v_exp_f32 v137, v105
    v_exp_f32 v138, v106
    v_smfmac_f32_32x32x32_bf16 v[160:175], v[204:207], v[24:31], v212
    v_exp_f32 v139, v107
    v_exp_f32 v140, v108
    v_exp_f32 v141, v109
    v_smfmac_f32_16x16x64_bf16 v[180:183], v[208:211], v[24:31], v212
    ds_read_b128 v[204:207], v4 offset:15360
    v_exp_f32 v142, v110
    v_exp_f32 v143, v111
    v_mfma_f32_32x32x16_bf16 v[96:111], v[184:187], v[48:51], v[64:79]
    v_exp_f32 v16, v112
    v_exp_f32 v17, v113
    v_exp_f32 v18, v114
    v_mfma_f32_32x32x16_bf16 v[96:111], v[188:191], v[52:55], v[96:111]
    s_waitcnt lgkmcnt(1)
    v_exp_f32 v19, v115
    v_exp_f32 v20, v116
    v_exp_f32 v21, v117
    v_smfmac_f32_32x32x32_bf16 v[144:159], v[200:203], v[128:135], v212
    s_waitcnt lgkmcnt(0)
    v_exp_f32 v22, v118
    v_exp_f32 v23, v119
    v_exp_f32 v24, v120
    v_smfmac_f32_16x16x64_bf16 v[176:179], v[208:211], v[128:135], v212
    ds_read_b128 v[192:195], v4 offset:12288
    v_exp_f32 v25, v121
    v_exp_f32 v26, v122
    v_smfmac_f32_32x32x32_bf16 v[144:159], v[204:207], v[136:143], v212
    v_exp_f32 v27, v123
    v_exp_f32 v28, v124
    v_exp_f32 v29, v125
    v_smfmac_f32_16x16x64_bf16 v[176:179], v[208:211], v[136:143], v212
    ds_read_b128 v[196:199], v4 offset:13312
    v_exp_f32 v30, v126
    v_exp_f32 v31, v127
    v_mfma_f32_32x32x16_bf16 v[112:127], v[184:187], v[56:59], v[80:95]
    v_exp_f32 v128, v96
    v_exp_f32 v129, v97
    v_exp_f32 v130, v98
    v_mfma_f32_32x32x16_bf16 v[112:127], v[188:191], v[60:63], v[112:127]
    v_exp_f32 v131, v99
    v_exp_f32 v132, v100
    v_exp_f32 v133, v101
    v_smfmac_f32_32x32x32_bf16 v[160:175], v[200:203], v[16:23], v212
    s_waitcnt lgkmcnt(0)
    v_exp_f32 v134, v102
    v_exp_f32 v135, v103
    v_exp_f32 v136, v104
    v_smfmac_f32_16x16x64_bf16 v[180:183], v[208:211], v[16:23], v212
    ds_read_b128 v[200:203], v4 offset:18432
    v_exp_f32 v137, v105
    v_exp_f32 v138, v106
    v_smfmac_f32_32x32x32_bf16 v[160:175], v[204:207], v[24:31], v212
    v_exp_f32 v139, v107
    v_exp_f32 v140, v108
    v_exp_f32 v141, v109
    v_smfmac_f32_16x16x64_bf16 v[180:183], v[208:211], v[24:31], v212
    ds_read_b128 v[204:207], v4 offset:19456
    v_exp_f32 v142, v110
    v_exp_f32 v143, v111
    v_mfma_f32_32x32x16_bf16 v[96:111], v[192:195], v[48:51], v[64:79]
    v_exp_f32 v16, v112
    v_exp_f32 v17, v113
    v_exp_f32 v18, v114
    v_mfma_f32_32x32x16_bf16 v[96:111], v[196:199], v[52:55], v[96:111]
    s_waitcnt lgkmcnt(1)
    v_exp_f32 v19, v115
    v_exp_f32 v20, v116
    v_exp_f32 v21, v117
    v_smfmac_f32_32x32x32_bf16 v[144:159], v[200:203], v[128:135], v212
    s_waitcnt lgkmcnt(0)
    v_exp_f32 v22, v118
    v_exp_f32 v23, v119
    v_exp_f32 v24, v120
    v_smfmac_f32_16x16x64_bf16 v[176:179], v[208:211], v[128:135], v212
    ds_read_b128 v[184:187], v4 offset:16384
    v_exp_f32 v25, v121
    v_exp_f32 v26, v122
    v_smfmac_f32_32x32x32_bf16 v[144:159], v[204:207], v[136:143], v212
    v_exp_f32 v27, v123
    v_exp_f32 v28, v124
    v_exp_f32 v29, v125
    v_smfmac_f32_16x16x64_bf16 v[176:179], v[208:211], v[136:143], v212
    ds_read_b128 v[188:191], v4 offset:17408
    v_exp_f32 v30, v126
    v_exp_f32 v31, v127
    v_mfma_f32_32x32x16_bf16 v[112:127], v[192:195], v[56:59], v[80:95]
    v_exp_f32 v128, v96
    v_exp_f32 v129, v97
    v_exp_f32 v130, v98
    v_mfma_f32_32x32x16_bf16 v[112:127], v[196:199], v[60:63], v[112:127]
    v_exp_f32 v131, v99
    v_exp_f32 v132, v100
    v_exp_f32 v133, v101
    v_smfmac_f32_32x32x32_bf16 v[160:175], v[200:203], v[16:23], v212
    s_waitcnt lgkmcnt(0)
    v_exp_f32 v134, v102
    v_exp_f32 v135, v103
    v_exp_f32 v136, v104
    v_smfmac_f32_16x16x64_bf16 v[180:183], v[208:211], v[16:23], v212
    ds_read_b128 v[200:203], v4 offset:22528
    v_exp_f32 v137, v105
    v_exp_f32 v138, v106
    v_smfmac_f32_32x32x32_bf16 v[160:175], v[204:207], v[24:31], v212
    v_exp_f32 v139, v107
    v_exp_f32 v140, v108
    v_exp_f32 v141, v109
    v_smfmac_f32_16x16x64_bf16 v[180:183], v[208:211], v[24:31], v212
    ds_read_b128 v[204:207], v4 offset:23552
    v_exp_f32 v142, v110
    v_exp_f32 v143, v111
    v_mfma_f32_32x32x16_bf16 v[96:111], v[184:187], v[48:51], v[64:79]
    v_exp_f32 v16, v112
    v_exp_f32 v17, v113
    v_exp_f32 v18, v114
    v_mfma_f32_32x32x16_bf16 v[96:111], v[188:191], v[52:55], v[96:111]
    s_waitcnt lgkmcnt(1)
    v_exp_f32 v19, v115
    v_exp_f32 v20, v116
    v_exp_f32 v21, v117
    v_smfmac_f32_32x32x32_bf16 v[144:159], v[200:203], v[128:135], v212
    s_waitcnt lgkmcnt(0)
    v_exp_f32 v22, v118
    v_exp_f32 v23, v119
    v_exp_f32 v24, v120
    v_smfmac_f32_16x16x64_bf16 v[176:179], v[208:211], v[128:135], v212
    ds_read_b128 v[192:195], v4 offset:20480
    v_exp_f32 v25, v121
    v_exp_f32 v26, v122
    v_smfmac_f32_32x32x32_bf16 v[144:159], v[204:207], v[136:143], v212
    v_exp_f32 v27, v123
    v_exp_f32 v28, v124
    v_exp_f32 v29, v125
    v_smfmac_f32_16x16x64_bf16 v[176:179], v[208:211], v[136:143], v212
    ds_read_b128 v[196:199], v4 offset:21504
    v_exp_f32 v30, v126
    v_exp_f32 v31, v127
    v_mfma_f32_32x32x16_bf16 v[112:127], v[184:187], v[56:59], v[80:95]
    v_exp_f32 v128, v96
    v_exp_f32 v129, v97
    v_exp_f32 v130, v98
    v_mfma_f32_32x32x16_bf16 v[112:127], v[188:191], v[60:63], v[112:127]
    v_exp_f32 v131, v99
    v_exp_f32 v132, v100
    v_exp_f32 v133, v101
    v_smfmac_f32_32x32x32_bf16 v[160:175], v[200:203], v[16:23], v212
    s_waitcnt lgkmcnt(0)
    v_exp_f32 v134, v102
    v_exp_f32 v135, v103
    v_exp_f32 v136, v104
    v_smfmac_f32_16x16x64_bf16 v[180:183], v[208:211], v[16:23], v212
    ds_read_b128 v[200:203], v4 offset:26624
    v_exp_f32 v137, v105
    v_exp_f32 v138, v106
    v_smfmac_f32_32x32x32_bf16 v[160:175], v[204:207], v[24:31], v212
    v_exp_f32 v139, v107
    v_exp_f32 v140, v108
    v_exp_f32 v141, v109
    v_smfmac_f32_16x16x64_bf16 v[180:183], v[208:211], v[24:31], v212
    ds_read_b128 v[204:207], v4 offset:27648
    v_exp_f32 v142, v110
    v_exp_f32 v143, v111
    v_mfma_f32_32x32x16_bf16 v[96:111], v[192:195], v[48:51], v[64:79]
    s_add_u32 s73, s73, 0x8000
    v_exp_f32 v16, v112
    v_exp_f32 v17, v113
    v_exp_f32 v18, v114
    v_mfma_f32_32x32x16_bf16 v[96:111], v[196:199], v[52:55], v[96:111]
    s_waitcnt lgkmcnt(1)
    v_exp_f32 v19, v115
    v_exp_f32 v20, v116
    v_exp_f32 v21, v117
    v_smfmac_f32_32x32x32_bf16 v[144:159], v[200:203], v[128:135], v212
    s_waitcnt lgkmcnt(0)
    v_exp_f32 v22, v118
    v_exp_f32 v23, v119
    v_exp_f32 v24, v120
    v_smfmac_f32_16x16x64_bf16 v[176:179], v[208:211], v[128:135], v212
    ds_read_b128 v[184:187], v4 offset:24576
    v_exp_f32 v25, v121
    v_exp_f32 v26, v122
    v_smfmac_f32_32x32x32_bf16 v[144:159], v[204:207], v[136:143], v212
    s_and_b32 s73, s73, 0x1ffff
    v_exp_f32 v27, v123
    v_exp_f32 v28, v124
    v_exp_f32 v29, v125
    v_smfmac_f32_16x16x64_bf16 v[176:179], v[208:211], v[136:143], v212
    ds_read_b128 v[188:191], v4 offset:25600
    v_exp_f32 v30, v126
    v_exp_f32 v31, v127
    v_mfma_f32_32x32x16_bf16 v[112:127], v[192:195], v[56:59], v[80:95]
    v_exp_f32 v128, v96
    v_exp_f32 v129, v97
    v_exp_f32 v130, v98
    v_mfma_f32_32x32x16_bf16 v[112:127], v[196:199], v[60:63], v[112:127]
    v_exp_f32 v131, v99
    v_exp_f32 v132, v100
    v_exp_f32 v133, v101
    v_smfmac_f32_32x32x32_bf16 v[160:175], v[200:203], v[16:23], v212
    s_waitcnt lgkmcnt(0)
    v_exp_f32 v134, v102
    v_exp_f32 v135, v103
    v_exp_f32 v136, v104
    v_smfmac_f32_16x16x64_bf16 v[180:183], v[208:211], v[16:23], v212
    ds_read_b128 v[200:203], v4 offset:30720
    v_exp_f32 v137, v105
    v_exp_f32 v138, v106
    v_smfmac_f32_32x32x32_bf16 v[160:175], v[204:207], v[24:31], v212
    v_exp_f32 v139, v107
    v_exp_f32 v140, v108
    v_exp_f32 v141, v109
    v_smfmac_f32_16x16x64_bf16 v[180:183], v[208:211], v[24:31], v212
    ds_read_b128 v[204:207], v4 offset:31744
    v_exp_f32 v142, v110
    v_exp_f32 v143, v111
    v_mfma_f32_32x32x16_bf16 v[96:111], v[184:187], v[48:51], v[64:79]
    s_sub_u32 s72, s72, 1
    v_exp_f32 v16, v112
    v_exp_f32 v17, v113
    v_exp_f32 v18, v114
    v_mfma_f32_32x32x16_bf16 v[96:111], v[188:191], v[52:55], v[96:111]
    s_waitcnt lgkmcnt(1)
    v_exp_f32 v19, v115
    v_exp_f32 v20, v116
    v_exp_f32 v21, v117
    v_smfmac_f32_32x32x32_bf16 v[144:159], v[200:203], v[128:135], v212
    s_waitcnt lgkmcnt(0)
    v_exp_f32 v22, v118
    v_exp_f32 v23, v119
    v_exp_f32 v24, v120
    v_smfmac_f32_16x16x64_bf16 v[176:179], v[208:211], v[128:135], v212
    ds_read_b128 v[192:195], v4 offset:28672
    v_exp_f32 v25, v121
    v_exp_f32 v26, v122
    v_smfmac_f32_32x32x32_bf16 v[144:159], v[204:207], v[136:143], v212
    s_cmp_lg_u32 s72, 0
    v_exp_f32 v27, v123
    v_exp_f32 v28, v124
    v_exp_f32 v29, v125
    v_smfmac_f32_16x16x64_bf16 v[176:179], v[208:211], v[136:143], v212
    ds_read_b128 v[196:199], v4 offset:29696
    v_exp_f32 v30, v126
    v_exp_f32 v31, v127
    v_add_u32 v4, s73, v2
    s_cbranch_scc1 L_mainc_al
L_mainc_tail:
    s_waitcnt lgkmcnt(0)
    s_barrier
    v_mfma_f32_32x32x16_bf16 v[112:127], v[192:195], v[48:51], v[64:79]
    ds_read_b128 v[220:223], v4 offset:0
    v_exp_f32 v128, v96
    v_exp_f32 v129, v97
    v_exp_f32 v130, v98
    v_mfma_f32_32x32x16_bf16 v[112:127], v[196:199], v[52:55], v[112:127]
    ds_read_b128 v[224:227], v4 offset:1024
    s_waitcnt lgkmcnt(3)
    v_exp_f32 v131, v99
    v_exp_f32 v132, v100
    v_exp_f32 v133, v101
    v_smfmac_f32_32x32x32_bf16 v[160:175], v[200:203], v[16:23], v212
    s_waitcnt lgkmcnt(2)
    s_lshl_b32 s78, s35, 11
    v_exp_f32 v134, v102
    v_exp_f32 v135, v103
    v_exp_f32 v136, v104
    v_smfmac_f32_16x16x64_bf16 v[180:183], v[208:211], v[16:23], v212
    ds_read_b128 v[200:203], v4 offset:2048
    v_exp_f32 v137, v105
    v_exp_f32 v138, v106
    v_smfmac_f32_32x32x32_bf16 v[160:175], v[204:207], v[24:31], v212
    s_waitcnt lgkmcnt(1)
    v_exp_f32 v139, v107
    v_exp_f32 v140, v108
    v_exp_f32 v141, v109
    v_smfmac_f32_16x16x64_bf16 v[180:183], v[208:211], v[24:31], v212
    ds_read_b128 v[204:207], v4 offset:3072
    v_exp_f32 v142, v110
    v_exp_f32 v143, v111
    v_mfma_f32_32x32x16_bf16 v[96:111], v[220:223], v[48:51], v[64:79]
    ds_read_b128 v[228:231], v4 offset:4096
    v_exp_f32 v16, v112
    v_exp_f32 v17, v113
    v_exp_f32 v18, v114
    v_mfma_f32_32x32x16_bf16 v[96:111], v[224:227], v[52:55], v[96:111]
    ds_read_b128 v[232:235], v4 offset:5120
    s_waitcnt lgkmcnt(3)
    v_exp_f32 v19, v115
    v_exp_f32 v20, v116
    v_exp_f32 v21, v117
    v_smfmac_f32_32x32x32_bf16 v[144:159], v[200:203], v[128:135], v212
    s_waitcnt lgkmcnt(2)
    s_add_u32 s78, s78, s77
    v_exp_f32 v22, v118
    v_exp_f32 v23, v119
    v_exp_f32 v24, v120
    v_smfmac_f32_16x16x64_bf16 v[176:179], v[208:211], v[128:135], v212
    ds_read_b128 v[200:203], v4 offset:6144
    v_exp_f32 v25, v121
    v_exp_f32 v26, v122
    v_smfmac_f32_32x32x32_bf16 v[144:159], v[204:207], v[136:143], v212
    s_waitcnt lgkmcnt(1)
    v_exp_f32 v27, v123
    v_exp_f32 v28, v124
    v_exp_f32 v29, v125
    v_smfmac_f32_16x16x64_bf16 v[176:179], v[208:211], v[136:143], v212
    ds_read_b128 v[204:207], v4 offset:7168
    v_exp_f32 v30, v126
    v_exp_f32 v31, v127
    v_mfma_f32_32x32x16_bf16 v[112:127], v[228:231], v[48:51], v[64:79]
    ds_read_b128 v[220:223], v4 offset:8192
    v_exp_f32 v128, v96
    v_exp_f32 v129, v97
    v_exp_f32 v130, v98
    v_mfma_f32_32x32x16_bf16 v[112:127], v[232:235], v[52:55], v[112:127]
    ds_read_b128 v[224:227], v4 offset:9216
    s_waitcnt lgkmcnt(3)
    v_exp_f32 v131, v99
    v_exp_f32 v132, v100
    v_exp_f32 v133, v101
    v_smfmac_f32_32x32x32_bf16 v[144:159], v[200:203], v[16:23], v212
    s_waitcnt lgkmcnt(2)
    s_add_u32 s78, s78, 0x600000
    v_exp_f32 v134, v102
    v_exp_f32 v135, v103
    v_exp_f32 v136, v104
    v_smfmac_f32_16x16x64_bf16 v[176:179], v[208:211], v[16:23], v212
    ds_read_b128 v[200:203], v4 offset:10240
    v_exp_f32 v137, v105
    v_exp_f32 v138, v106
    v_smfmac_f32_32x32x32_bf16 v[144:159], v[204:207], v[24:31], v212
    s_waitcnt lgkmcnt(1)
    v_exp_f32 v139, v107
    v_exp_f32 v140, v108
    v_exp_f32 v141, v109
    v_smfmac_f32_16x16x64_bf16 v[176:179], v[208:211], v[24:31], v212
    ds_read_b128 v[204:207], v4 offset:11264
    v_exp_f32 v142, v110
    v_exp_f32 v143, v111
    v_mfma_f32_32x32x16_bf16 v[96:111], v[220:223], v[48:51], v[64:79]
    ds_read_b128 v[228:231], v4 offset:12288
    v_exp_f32 v16, v112
    v_exp_f32 v17, v113
    v_exp_f32 v18, v114
    v_mfma_f32_32x32x16_bf16 v[96:111], v[224:227], v[52:55], v[96:111]
    ds_read_b128 v[232:235], v4 offset:13312
    s_waitcnt lgkmcnt(3)
    v_exp_f32 v19, v115
    v_exp_f32 v20, v116
    v_exp_f32 v21, v117
    v_smfmac_f32_32x32x32_bf16 v[144:159], v[200:203], v[128:135], v212
    s_waitcnt lgkmcnt(2)
    s_add_u32 s79, s78, 0x8000
    v_exp_f32 v22, v118
    v_exp_f32 v23, v119
    v_exp_f32 v24, v120
    v_smfmac_f32_16x16x64_bf16 v[176:179], v[208:211], v[128:135], v212
    ds_read_b128 v[200:203], v4 offset:14336
    v_exp_f32 v25, v121
    v_exp_f32 v26, v122
    v_smfmac_f32_32x32x32_bf16 v[144:159], v[204:207], v[136:143], v212
    s_waitcnt lgkmcnt(1)
    v_exp_f32 v27, v123
    v_exp_f32 v28, v124
    v_exp_f32 v29, v125
    v_smfmac_f32_16x16x64_bf16 v[176:179], v[208:211], v[136:143], v212
    ds_read_b128 v[204:207], v4 offset:15360
    v_exp_f32 v30, v126
    v_exp_f32 v31, v127
    v_mfma_f32_32x32x16_bf16 v[112:127], v[228:231], v[48:51], v[64:79]
    ds_read_b128 v[220:223], v4 offset:16384
    v_exp_f32 v128, v96
    v_exp_f32 v129, v97
    v_exp_f32 v130, v98
    v_mfma_f32_32x32x16_bf16 v[112:127], v[232:235], v[52:55], v[112:127]
    ds_read_b128 v[224:227], v4 offset:17408
    s_waitcnt lgkmcnt(3)
    v_exp_f32 v131, v99
    v_exp_f32 v132, v100
    v_exp_f32 v133, v101
    v_smfmac_f32_32x32x32_bf16 v[144:159], v[200:203], v[16:23], v212
    s_waitcnt lgkmcnt(2)
    s_mov_b32 s76, 0x71800000
    v_exp_f32 v134, v102
    v_exp_f32 v135, v103
    v_exp_f32 v136, v104
    v_smfmac_f32_16x16x64_bf16 v[176:179], v[208:211], v[16:23], v212
    ds_read_b128 v[200:203], v4 offset:18432
    v_exp_f32 v137, v105
    v_exp_f32 v138, v106
    v_smfmac_f32_32x32x32_bf16 v[144:159], v[204:207], v[24:31], v212
    s_waitcnt lgkmcnt(1)
    v_exp_f32 v139, v107
    v_exp_f32 v140, v108
    v_exp_f32 v141, v109
    v_smfmac_f32_16x16x64_bf16 v[176:179], v[208:211], v[24:31], v212
    ds_read_b128 v[204:207], v4 offset:19456
    v_exp_f32 v142, v110
    v_exp_f32 v143, v111
    v_mfma_f32_32x32x16_bf16 v[96:111], v[220:223], v[48:51], v[64:79]
    ds_read_b128 v[228:231], v4 offset:20480
    v_exp_f32 v16, v112
    v_exp_f32 v17, v113
    v_exp_f32 v18, v114
    v_mfma_f32_32x32x16_bf16 v[96:111], v[224:227], v[52:55], v[96:111]
    ds_read_b128 v[232:235], v4 offset:21504
    s_waitcnt lgkmcnt(3)
    v_exp_f32 v19, v115
    v_exp_f32 v20, v116
    v_exp_f32 v21, v117
    v_smfmac_f32_32x32x32_bf16 v[144:159], v[200:203], v[128:135], v212
    s_waitcnt lgkmcnt(2)
    s_mov_b32 s75, 1
    v_exp_f32 v22, v118
    v_exp_f32 v23, v119
    v_exp_f32 v24, v120
    v_smfmac_f32_16x16x64_bf16 v[176:179], v[208:211], v[128:135], v212
    ds_read_b128 v[200:203], v4 offset:22528
    v_exp_f32 v25, v121
    v_exp_f32 v26, v122
    v_smfmac_f32_32x32x32_bf16 v[144:159], v[204:207], v[136:143], v212
    s_waitcnt lgkmcnt(1)
    v_exp_f32 v27, v123
    v_exp_f32 v28, v124
    v_exp_f32 v29, v125
    v_smfmac_f32_16x16x64_bf16 v[176:179], v[208:211], v[136:143], v212
    ds_read_b128 v[204:207], v4 offset:23552
    v_exp_f32 v30, v126
    v_exp_f32 v31, v127
    v_mfma_f32_32x32x16_bf16 v[112:127], v[228:231], v[48:51], v[64:79]
    ds_read_b128 v[220:223], v4 offset:24576
    v_exp_f32 v128, v96
    v_exp_f32 v129, v97
    v_exp_f32 v130, v98
    v_mfma_f32_32x32x16_bf16 v[112:127], v[232:235], v[52:55], v[112:127]
    ds_read_b128 v[224:227], v4 offset:25600
    s_waitcnt lgkmcnt(3)
    v_exp_f32 v131, v99
    v_exp_f32 v132, v100
    v_exp_f32 v133, v101
    v_smfmac_f32_32x32x32_bf16 v[144:159], v[200:203], v[16:23], v212
    s_waitcnt lgkmcnt(2)
    s_lshl_b32 s82, s34, 1
    v_exp_f32 v134, v102
    v_exp_f32 v135, v103
    v_exp_f32 v136, v104
    v_smfmac_f32_16x16x64_bf16 v[176:179], v[208:211], v[16:23], v212
    ds_read_b128 v[200:203], v4 offset:26624
    v_exp_f32 v137, v105
    v_exp_f32 v138, v106
    v_smfmac_f32_32x32x32_bf16 v[144:159], v[204:207], v[24:31], v212
    s_waitcnt lgkmcnt(1)
    v_exp_f32 v139, v107
    v_exp_f32 v140, v108
    v_exp_f32 v141, v109
    v_smfmac_f32_16x16x64_bf16 v[176:179], v[208:211], v[24:31], v212
    ds_read_b128 v[204:207], v4 offset:27648
    v_exp_f32 v142, v110
    v_exp_f32 v143, v111
    v_mfma_f32_32x32x16_bf16 v[96:111], v[220:223], v[48:51], v[64:79]
    ds_read_b128 v[228:231], v4 offset:28672
    v_exp_f32 v16, v112
    v_exp_f32 v17, v113
    v_exp_f32 v18, v114
    v_mfma_f32_32x32x16_bf16 v[96:111], v[224:227], v[52:55], v[96:111]
    ds_read_b128 v[232:235], v4 offset:29696
    s_waitcnt lgkmcnt(3)
    v_exp_f32 v19, v115
    v_exp_f32 v20, v116
    v_exp_f32 v21, v117
    v_smfmac_f32_32x32x32_bf16 v[144:159], v[200:203], v[128:135], v212
    s_waitcnt lgkmcnt(2)
    s_add_u32 s83, s82, 1
    v_exp_f32 v22, v118
    v_exp_f32 v23, v119
    v_exp_f32 v24, v120
    v_smfmac_f32_16x16x64_bf16 v[176:179], v[208:211], v[128:135], v212
    ds_read_b128 v[200:203], v4 offset:30720
    v_exp_f32 v25, v121
    v_exp_f32 v26, v122
    v_smfmac_f32_32x32x32_bf16 v[144:159], v[204:207], v[136:143], v212
    s_waitcnt lgkmcnt(1)
    v_exp_f32 v27, v123
    v_exp_f32 v28, v124
    v_exp_f32 v29, v125
    v_smfmac_f32_16x16x64_bf16 v[176:179], v[208:211], v[136:143], v212
    ds_read_b128 v[204:207], v4 offset:31744
    v_exp_f32 v30, v126
    v_exp_f32 v31, v127
    s_barrier
    v_mfma_f32_32x32x16_bf16 v[112:127], v[228:231], v[48:51], v[64:79]
    ds_read_b128 v[220:223], v4 offset:32768
    v_exp_f32 v128, v96
    v_exp_f32 v129, v97
    v_exp_f32 v130, v98
    v_mfma_f32_32x32x16_bf16 v[112:127], v[232:235], v[52:55], v[112:127]
    ds_read_b128 v[224:227], v4 offset:33792
    s_waitcnt lgkmcnt(3)
    v_exp_f32 v131, v99
    v_exp_f32 v132, v100
    v_exp_f32 v133, v101
    v_smfmac_f32_32x32x32_bf16 v[144:159], v[200:203], v[16:23], v212
    s_waitcnt lgkmcnt(2)
    s_add_u32 s52, s77, 0x600000
    v_exp_f32 v134, v102
    v_exp_f32 v135, v103
    v_exp_f32 v136, v104
    v_smfmac_f32_16x16x64_bf16 v[176:179], v[208:211], v[16:23], v212
    ds_read_b128 v[200:203], v4 offset:34816
    v_exp_f32 v137, v105
    v_exp_f32 v138, v106
    v_smfmac_f32_32x32x32_bf16 v[144:159], v[204:207], v[24:31], v212
    s_waitcnt lgkmcnt(1)
    v_exp_f32 v139, v107
    v_exp_f32 v140, v108
    v_exp_f32 v141, v109
    v_smfmac_f32_16x16x64_bf16 v[176:179], v[208:211], v[24:31], v212
    ds_read_b128 v[204:207], v4 offset:35840
    v_exp_f32 v142, v110
    v_exp_f32 v143, v111
    v_mfma_f32_32x32x16_bf16 v[96:111], v[220:223], v[48:51], v[64:79]
    ds_read_b128 v[228:231], v4 offset:36864
    v_exp_f32 v16, v112
    v_exp_f32 v17, v113
    v_exp_f32 v18, v114
    v_mfma_f32_32x32x16_bf16 v[96:111], v[224:227], v[52:55], v[96:111]
    ds_read_b128 v[232:235], v4 offset:37888
    s_waitcnt lgkmcnt(3)
    v_exp_f32 v19, v115
    v_exp_f32 v20, v116
    v_exp_f32 v21, v117
    v_smfmac_f32_32x32x32_bf16 v[144:159], v[200:203], v[128:135], v212
    s_waitcnt lgkmcnt(2)
    s_add_u32 s40, s32, s52
    s_addc_u32 s41, s33, 0
    v_exp_f32 v22, v118
    v_exp_f32 v23, v119
    v_exp_f32 v24, v120
    v_smfmac_f32_16x16x64_bf16 v[176:179], v[208:211], v[128:135], v212
    ds_read_b128 v[200:203], v4 offset:38912
    v_exp_f32 v25, v121
    v_exp_f32 v26, v122
    v_smfmac_f32_32x32x32_bf16 v[144:159], v[204:207], v[136:143], v212
    s_waitcnt lgkmcnt(1)
    v_exp_f32 v27, v123
    v_exp_f32 v28, v124
    v_exp_f32 v29, v125
    v_smfmac_f32_16x16x64_bf16 v[176:179], v[208:211], v[136:143], v212
    ds_read_b128 v[204:207], v4 offset:39936
    v_exp_f32 v30, v126
    v_exp_f32 v31, v127
    v_mfma_f32_32x32x16_bf16 v[112:127], v[228:231], v[48:51], v[64:79]
    ds_read_b128 v[220:223], v4 offset:40960
    v_exp_f32 v128, v96
    v_exp_f32 v129, v97
    v_exp_f32 v130, v98
    v_mfma_f32_32x32x16_bf16 v[112:127], v[232:235], v[52:55], v[112:127]
    ds_read_b128 v[224:227], v4 offset:41984
    s_waitcnt lgkmcnt(3)
    v_exp_f32 v131, v99
    v_exp_f32 v132, v100
    v_exp_f32 v133, v101
    v_smfmac_f32_32x32x32_bf16 v[144:159], v[200:203], v[16:23], v212
    s_waitcnt lgkmcnt(2)
    v_exp_f32 v134, v102
    v_exp_f32 v135, v103
    v_exp_f32 v136, v104
    v_smfmac_f32_16x16x64_bf16 v[176:179], v[208:211], v[16:23], v212
    ds_read_b128 v[200:203], v4 offset:43008
    v_exp_f32 v137, v105
    v_exp_f32 v138, v106
    v_smfmac_f32_32x32x32_bf16 v[144:159], v[204:207], v[24:31], v212
    s_waitcnt lgkmcnt(1)
    v_exp_f32 v139, v107
    v_exp_f32 v140, v108
    v_exp_f32 v141, v109
    v_smfmac_f32_16x16x64_bf16 v[176:179], v[208:211], v[24:31], v212
    ds_read_b128 v[204:207], v4 offset:44032
    v_exp_f32 v142, v110
    v_exp_f32 v143, v111
    v_mfma_f32_32x32x16_bf16 v[96:111], v[220:223], v[48:51], v[64:79]
    ds_read_b128 v[228:231], v4 offset:45056
    v_exp_f32 v16, v112
    v_exp_f32 v17, v113
    v_exp_f32 v18, v114
    v_mfma_f32_32x32x16_bf16 v[96:111], v[224:227], v[52:55], v[96:111]
    ds_read_b128 v[232:235], v4 offset:46080
    s_waitcnt lgkmcnt(3)
    v_exp_f32 v19, v115
    v_exp_f32 v20, v116
    v_exp_f32 v21, v117
    v_smfmac_f32_32x32x32_bf16 v[144:159], v[200:203], v[128:135], v212
    s_waitcnt lgkmcnt(2)
    v_exp_f32 v22, v118
    v_exp_f32 v23, v119
    v_exp_f32 v24, v120
    v_smfmac_f32_16x16x64_bf16 v[176:179], v[208:211], v[128:135], v212
    ds_read_b128 v[200:203], v4 offset:47104
    v_exp_f32 v25, v121
    v_exp_f32 v26, v122
    v_smfmac_f32_32x32x32_bf16 v[144:159], v[204:207], v[136:143], v212
    s_waitcnt lgkmcnt(1)
    v_exp_f32 v27, v123
    v_exp_f32 v28, v124
    v_exp_f32 v29, v125
    v_smfmac_f32_16x16x64_bf16 v[176:179], v[208:211], v[136:143], v212
    ds_read_b128 v[204:207], v4 offset:48128
    v_exp_f32 v30, v126
    v_exp_f32 v31, v127
    v_mfma_f32_32x32x16_bf16 v[112:127], v[228:231], v[48:51], v[64:79]
    ds_read_b128 v[220:223], v4 offset:49152
    v_exp_f32 v128, v96
    v_exp_f32 v129, v97
    v_exp_f32 v130, v98
    v_mfma_f32_32x32x16_bf16 v[112:127], v[232:235], v[52:55], v[112:127]
    ds_read_b128 v[224:227], v4 offset:50176
    s_waitcnt lgkmcnt(3)
    v_exp_f32 v131, v99
    v_exp_f32 v132, v100
    v_exp_f32 v133, v101
    v_smfmac_f32_32x32x32_bf16 v[144:159], v[200:203], v[16:23], v212
    s_waitcnt lgkmcnt(2)
    v_exp_f32 v134, v102
    v_exp_f32 v135, v103
    v_exp_f32 v136, v104
    v_smfmac_f32_16x16x64_bf16 v[176:179], v[208:211], v[16:23], v212
    ds_read_b128 v[200:203], v4 offset:51200
    v_exp_f32 v137, v105
    v_exp_f32 v138, v106
    v_smfmac_f32_32x32x32_bf16 v[144:159], v[204:207], v[24:31], v212
    s_waitcnt lgkmcnt(1)
    v_exp_f32 v139, v107
    v_exp_f32 v140, v108
    v_exp_f32 v141, v109
    v_smfmac_f32_16x16x64_bf16 v[176:179], v[208:211], v[24:31], v212
    ds_read_b128 v[204:207], v4 offset:52224
    v_exp_f32 v142, v110
    v_exp_f32 v143, v111
    v_mfma_f32_32x32x16_bf16 v[96:111], v[220:223], v[48:51], v[64:79]
    ds_read_b128 v[228:231], v4 offset:53248
    v_exp_f32 v16, v112
    v_exp_f32 v17, v113
    v_exp_f32 v18, v114
    v_mfma_f32_32x32x16_bf16 v[96:111], v[224:227], v[52:55], v[96:111]
    ds_read_b128 v[232:235], v4 offset:54272
    s_waitcnt lgkmcnt(3)
    v_exp_f32 v19, v115
    v_exp_f32 v20, v116
    v_exp_f32 v21, v117
    v_smfmac_f32_32x32x32_bf16 v[144:159], v[200:203], v[128:135], v212
    s_waitcnt lgkmcnt(2)
    v_exp_f32 v22, v118
    v_exp_f32 v23, v119
    v_exp_f32 v24, v120
    v_smfmac_f32_16x16x64_bf16 v[176:179], v[208:211], v[128:135], v212
    ds_read_b128 v[200:203], v4 offset:55296
    v_exp_f32 v25, v121
    v_exp_f32 v26, v122
    v_smfmac_f32_32x32x32_bf16 v[144:159], v[204:207], v[136:143], v212
    s_waitcnt lgkmcnt(1)
    v_exp_f32 v27, v123
    v_exp_f32 v28, v124
    v_exp_f32 v29, v125
    v_smfmac_f32_16x16x64_bf16 v[176:179], v[208:211], v[136:143], v212
    ds_read_b128 v[204:207], v4 offset:56320
    v_exp_f32 v30, v126
    v_exp_f32 v31, v127
    v_mfma_f32_32x32x16_bf16 v[112:127], v[228:231], v[48:51], v[64:79]
    v_exp_f32 v128, v96
    v_exp_f32 v129, v97
    v_exp_f32 v130, v98
    v_mfma_f32_32x32x16_bf16 v[112:127], v[232:235], v[52:55], v[112:127]
    s_waitcnt lgkmcnt(1)
    v_exp_f32 v131, v99
    v_exp_f32 v132, v100
    v_exp_f32 v133, v101
    v_smfmac_f32_32x32x32_bf16 v[144:159], v[200:203], v[16:23], v212
    s_waitcnt lgkmcnt(0)
    v_exp_f32 v134, v102
    v_exp_f32 v135, v103
    v_exp_f32 v136, v104
    v_smfmac_f32_16x16x64_bf16 v[176:179], v[208:211], v[16:23], v212
    ds_read_b128 v[200:203], v4 offset:59392
    v_exp_f32 v137, v105
    v_exp_f32 v138, v106
    v_smfmac_f32_32x32x32_bf16 v[144:159], v[204:207], v[24:31], v212
    v_exp_f32 v139, v107
    v_exp_f32 v140, v108
    v_exp_f32 v141, v109
    v_smfmac_f32_16x16x64_bf16 v[176:179], v[208:211], v[24:31], v212
    ds_read_b128 v[204:207], v4 offset:60416
    v_exp_f32 v142, v110
    v_exp_f32 v143, v111
    v_mfma_f32_32x32x16_bf16 v[96:111], v[184:187], v[56:59], v[80:95]
    v_exp_f32 v16, v112
    v_exp_f32 v17, v113
    v_exp_f32 v18, v114
    v_mfma_f32_32x32x16_bf16 v[96:111], v[188:191], v[60:63], v[96:111]
    s_waitcnt lgkmcnt(1)
    v_exp_f32 v19, v115
    v_exp_f32 v20, v116
    v_exp_f32 v21, v117
    v_smfmac_f32_32x32x32_bf16 v[144:159], v[200:203], v[128:135], v212
    s_waitcnt lgkmcnt(0)
    v_exp_f32 v22, v118
    v_exp_f32 v23, v119
    v_exp_f32 v24, v120
    v_smfmac_f32_16x16x64_bf16 v[176:179], v[208:211], v[128:135], v212
    ds_read_b128 v[200:203], v4 offset:63488
    v_exp_f32 v25, v121
    v_exp_f32 v26, v122
    v_smfmac_f32_32x32x32_bf16 v[144:159], v[204:207], v[136:143], v212
    v_exp_f32 v27, v123
    v_exp_f32 v28, v124
    v_exp_f32 v29, v125
    v_smfmac_f32_16x16x64_bf16 v[176:179], v[208:211], v[136:143], v212
    ds_read_b128 v[204:207], v4 offset:64512
    v_exp_f32 v30, v126
    v_exp_f32 v31, v127
    v_mfma_f32_32x32x16_bf16 v[112:127], v[192:195], v[56:59], v[80:95]
    ds_read_b128 v[220:223], v4 offset:0
    v_exp_f32 v128, v96
    v_exp_f32 v129, v97
    v_exp_f32 v130, v98
    v_mfma_f32_32x32x16_bf16 v[112:127], v[196:199], v[60:63], v[112:127]
    ds_read_b128 v[224:227], v4 offset:1024
    s_waitcnt lgkmcnt(3)
    v_exp_f32 v131, v99
    v_exp_f32 v132, v100
    v_exp_f32 v133, v101
    v_smfmac_f32_32x32x32_bf16 v[144:159], v[200:203], v[16:23], v212
    s_waitcnt lgkmcnt(2)
    v_exp_f32 v134, v102
    v_exp_f32 v135, v103
    v_exp_f32 v136, v104
    v_smfmac_f32_16x16x64_bf16 v[176:179], v[208:211], v[16:23], v212
    ds_read_b128 v[200:203], v4 offset:2048
    v_exp_f32 v137, v105
    v_exp_f32 v138, v106
    v_smfmac_f32_32x32x32_bf16 v[144:159], v[204:207], v[24:31], v212
    s_waitcnt lgkmcnt(1)
    v_exp_f32 v139, v107
    v_exp_f32 v140, v108
    v_exp_f32 v141, v109
    v_smfmac_f32_16x16x64_bf16 v[176:179], v[208:211], v[24:31], v212
    ds_read_b128 v[204:207], v4 offset:3072
    v_exp_f32 v142, v110
    v_exp_f32 v143, v111
    v_mfma_f32_32x32x16_bf16 v[96:111], v[220:223], v[56:59], v[80:95]
    ds_read_b128 v[228:231], v4 offset:4096
    v_exp_f32 v16, v112
    v_exp_f32 v17, v113
    v_exp_f32 v18, v114
    v_mfma_f32_32x32x16_bf16 v[96:111], v[224:227], v[60:63], v[96:111]
    ds_read_b128 v[232:235], v4 offset:5120
    s_waitcnt lgkmcnt(3)
    v_exp_f32 v19, v115
    v_exp_f32 v20, v116
    v_exp_f32 v21, v117
    v_smfmac_f32_32x32x32_bf16 v[160:175], v[200:203], v[128:135], v212
    s_waitcnt lgkmcnt(2)
    v_exp_f32 v22, v118
    v_exp_f32 v23, v119
    v_exp_f32 v24, v120
    v_smfmac_f32_16x16x64_bf16 v[180:183], v[208:211], v[128:135], v212
    ds_read_b128 v[200:203], v4 offset:6144
    v_exp_f32 v25, v121
    v_exp_f32 v26, v122
    v_smfmac_f32_32x32x32_bf16 v[160:175], v[204:207], v[136:143], v212
    s_waitcnt lgkmcnt(1)
    v_exp_f32 v27, v123
    v_exp_f32 v28, v124
    v_exp_f32 v29, v125
    v_smfmac_f32_16x16x64_bf16 v[180:183], v[208:211], v[136:143], v212
    ds_read_b128 v[204:207], v4 offset:7168
    v_exp_f32 v30, v126
    v_exp_f32 v31, v127
    v_cmp_nle_f32 vcc, 0x2b800000, v176
    v_cmp_nge_f32 s[54:55], s76, v176
    v_rcp_f32 v10, v176
    s_nop 0
    s_or_b64 vcc, vcc, s[54:55]
    s_cbranch_vccnz L_mainc_ska
    v_pk_mul_f32 v[144:145], v[144:145], v[10:11] op_sel_hi:[1,0]
    v_pk_mul_f32 v[146:147], v[146:147], v[10:11] op_sel_hi:[1,0]
    v_pk_mul_f32 v[148:149], v[148:149], v[10:11] op_sel_hi:[1,0]
    v_pk_mul_f32 v[150:151], v[150:151], v[10:11] op_sel_hi:[1,0]
    v_cvt_pk_bf16_f32 v32, v144, v145
    v_cvt_pk_bf16_f32 v33, v146, v147
    v_cvt_pk_bf16_f32 v34, v148, v149
    v_cvt_pk_bf16_f32 v35, v150, v151
    buffer_store_dwordx4 v[32:35], v245, s[36:39], s78 offen offset:0 sc1
    v_pk_mul_f32 v[152:153], v[152:153], v[10:11] op_sel_hi:[1,0]
    v_pk_mul_f32 v[154:155], v[154:155], v[10:11] op_sel_hi:[1,0]
    v_pk_mul_f32 v[156:157], v[156:157], v[10:11] op_sel_hi:[1,0]
    v_pk_mul_f32 v[158:159], v[158:159], v[10:11] op_sel_hi:[1,0]
    v_cvt_pk_bf16_f32 v36, v152, v153
    v_cvt_pk_bf16_f32 v37, v154, v155
    v_cvt_pk_bf16_f32 v38, v156, v157
    v_cvt_pk_bf16_f32 v39, v158, v159
    buffer_store_dwordx4 v[36:39], v245, s[36:39], s78 offen offset:512 sc1
    s_mov_b32 s75, 0
L_mainc_ska:
    v_mfma_f32_32x32x16_bf16 v[112:127], v[228:231], v[56:59], v[80:95]
    ds_read_b128 v[220:223], v4 offset:8192
    v_exp_f32 v128, v96
    v_exp_f32 v129, v97
    v_exp_f32 v130, v98
    v_mfma_f32_32x32x16_bf16 v[112:127], v[232:235], v[60:63], v[112:127]
    ds_read_b128 v[224:227], v4 offset:9216
    s_waitcnt lgkmcnt(3)
    v_exp_f32 v131, v99
    v_exp_f32 v132, v100
    v_exp_f32 v133, v101
    v_smfmac_f32_32x32x32_bf16 v[160:175], v[200:203], v[16:23], v212
    s_waitcnt lgkmcnt(2)
    v_exp_f32 v134, v102
    v_exp_f32 v135, v103
    v_exp_f32 v136, v104
    v_smfmac_f32_16x16x64_bf16 v[180:183], v[208:211], v[16:23], v212
    ds_read_b128 v[200:203], v4 offset:10240
    v_exp_f32 v137, v105
    v_exp_f32 v138, v106
    v_smfmac_f32_32x32x32_bf16 v[160:175], v[204:207], v[24:31], v212
    s_waitcnt lgkmcnt(1)
    v_exp_f32 v139, v107
    v_exp_f32 v140, v108
    v_exp_f32 v141, v109
    v_smfmac_f32_16x16x64_bf16 v[180:183], v[208:211], v[24:31], v212
    ds_read_b128 v[204:207], v4 offset:11264
    v_exp_f32 v142, v110
    v_exp_f32 v143, v111
    v_mfma_f32_32x32x16_bf16 v[96:111], v[220:223], v[56:59], v[80:95]
    ds_read_b128 v[228:231], v4 offset:12288
    v_exp_f32 v16, v112
    v_exp_f32 v17, v113
    v_exp_f32 v18, v114
    v_mfma_f32_32x32x16_bf16 v[96:111], v[224:227], v[60:63], v[96:111]
    ds_read_b128 v[232:235], v4 offset:13312
    s_waitcnt lgkmcnt(3)
    v_exp_f32 v19, v115
    v_exp_f32 v20, v116
    v_exp_f32 v21, v117
    v_smfmac_f32_32x32x32_bf16 v[160:175], v[200:203], v[128:135], v212
    s_waitcnt lgkmcnt(2)
    v_exp_f32 v22, v118
    v_exp_f32 v23, v119
    v_exp_f32 v24, v120
    v_smfmac_f32_16x16x64_bf16 v[180:183], v[208:211], v[128:135], v212
    ds_read_b128 v[200:203], v4 offset:14336
    v_exp_f32 v25, v121
    v_exp_f32 v26, v122
    v_smfmac_f32_32x32x32_bf16 v[160:175], v[204:207], v[136:143], v212
    s_waitcnt lgkmcnt(1)
    v_exp_f32 v27, v123
    v_exp_f32 v28, v124
    v_exp_f32 v29, v125
    v_smfmac_f32_16x16x64_bf16 v[180:183], v[208:211], v[136:143], v212
    ds_read_b128 v[204:207], v4 offset:15360
    v_exp_f32 v30, v126
    v_exp_f32 v31, v127
    v_mfma_f32_32x32x16_bf16 v[112:127], v[228:231], v[56:59], v[80:95]
    ds_read_b128 v[220:223], v4 offset:16384
    v_exp_f32 v128, v96
    v_exp_f32 v129, v97
    v_exp_f32 v130, v98
    v_mfma_f32_32x32x16_bf16 v[112:127], v[232:235], v[60:63], v[112:127]
    ds_read_b128 v[224:227], v4 offset:17408
    s_waitcnt lgkmcnt(3)
    v_exp_f32 v131, v99
    v_exp_f32 v132, v100
    v_exp_f32 v133, v101
    v_smfmac_f32_32x32x32_bf16 v[160:175], v[200:203], v[16:23], v212
    s_waitcnt lgkmcnt(2)
    v_exp_f32 v134, v102
    v_exp_f32 v135, v103
    v_exp_f32 v136, v104
    v_smfmac_f32_16x16x64_bf16 v[180:183], v[208:211], v[16:23], v212
    ds_read_b128 v[200:203], v4 offset:18432
    v_exp_f32 v137, v105
    v_exp_f32 v138, v106
    v_smfmac_f32_32x32x32_bf16 v[160:175], v[204:207], v[24:31], v212
    s_waitcnt lgkmcnt(1)
    v_exp_f32 v139, v107
    v_exp_f32 v140, v108
    v_exp_f32 v141, v109
    v_smfmac_f32_16x16x64_bf16 v[180:183], v[208:211], v[24:31], v212
    ds_read_b128 v[204:207], v4 offset:19456
    v_exp_f32 v142, v110
    v_exp_f32 v143, v111
    v_mfma_f32_32x32x16_bf16 v[96:111], v[220:223], v[56:59], v[80:95]
    ds_read_b128 v[228:231], v4 offset:20480
    v_exp_f32 v16, v112
    v_exp_f32 v17, v113
    v_exp_f32 v18, v114
    v_mfma_f32_32x32x16_bf16 v[96:111], v[224:227], v[60:63], v[96:111]
    ds_read_b128 v[232:235], v4 offset:21504
    s_waitcnt lgkmcnt(3)
    v_exp_f32 v19, v115
    v_exp_f32 v20, v116
    v_exp_f32 v21, v117
    v_smfmac_f32_32x32x32_bf16 v[160:175], v[200:203], v[128:135], v212
    s_waitcnt lgkmcnt(2)
    v_exp_f32 v22, v118
    v_exp_f32 v23, v119
    v_exp_f32 v24, v120
    v_smfmac_f32_16x16x64_bf16 v[180:183], v[208:211], v[128:135], v212
    ds_read_b128 v[200:203], v4 offset:22528
    v_exp_f32 v25, v121
    v_exp_f32 v26, v122
    v_smfmac_f32_32x32x32_bf16 v[160:175], v[204:207], v[136:143], v212
    s_waitcnt lgkmcnt(1)
    v_exp_f32 v27, v123
    v_exp_f32 v28, v124
    v_exp_f32 v29, v125
    v_smfmac_f32_16x16x64_bf16 v[180:183], v[208:211], v[136:143], v212
    ds_read_b128 v[204:207], v4 offset:23552
    v_exp_f32 v30, v126
    v_exp_f32 v31, v127
    s_cmp_lg_u32 s75, 0
    s_cbranch_scc1 L_mainc_skb
    s_lshl_b32 s81, s82, 2
    s_add_u32 s81, s81, s3
    s_lshl_b32 s81, s81, 7
    s_add_u32 s81, s81, 0x140000
    v_mov_b32 v6, 1
    s_waitcnt vmcnt(0)
    s_mov_b64 exec, 1
    buffer_atomic_add v6, v2, s[36:39], s81 offen sc1
    s_mov_b64 exec, -1
L_mainc_skb:
    v_mfma_f32_32x32x16_bf16 v[112:127], v[228:231], v[56:59], v[80:95]
    ds_read_b128 v[220:223], v4 offset:24576
    v_exp_f32 v128, v96
    v_exp_f32 v129, v97
    v_exp_f32 v130, v98
    v_mfma_f32_32x32x16_bf16 v[112:127], v[232:235], v[60:63], v[112:127]
    ds_read_b128 v[224:227], v4 offset:25600
    s_waitcnt lgkmcnt(3)
    v_exp_f32 v131, v99
    v_exp_f32 v132, v100
    v_exp_f32 v133, v101
    v_smfmac_f32_32x32x32_bf16 v[160:175], v[200:203], v[16:23], v212
    s_waitcnt lgkmcnt(2)
    v_exp_f32 v134, v102
    v_exp_f32 v135, v103
    v_exp_f32 v136, v104
    v_smfmac_f32_16x16x64_bf16 v[180:183], v[208:211], v[16:23], v212
    ds_read_b128 v[200:203], v4 offset:26624
    v_exp_f32 v137, v105
    v_exp_f32 v138, v106
    v_smfmac_f32_32x32x32_bf16 v[160:175], v[204:207], v[24:31], v212
    s_waitcnt lgkmcnt(1)
    v_exp_f32 v139, v107
    v_exp_f32 v140, v108
    v_exp_f32 v141, v109
    v_smfmac_f32_16x16x64_bf16 v[180:183], v[208:211], v[24:31], v212
    ds_read_b128 v[204:207], v4 offset:27648
    v_exp_f32 v142, v110
    v_exp_f32 v143, v111
    v_mfma_f32_32x32x16_bf16 v[96:111], v[220:223], v[56:59], v[80:95]
    ds_read_b128 v[228:231], v4 offset:28672
    v_exp_f32 v16, v112
    v_exp_f32 v17, v113
    v_exp_f32 v18, v114
    v_mfma_f32_32x32x16_bf16 v[96:111], v[224:227], v[60:63], v[96:111]
    ds_read_b128 v[232:235], v4 offset:29696
    s_waitcnt lgkmcnt(3)
    v_exp_f32 v19, v115
    v_exp_f32 v20, v116
    v_exp_f32 v21, v117
    v_smfmac_f32_32x32x32_bf16 v[160:175], v[200:203], v[128:135], v212
    s_waitcnt lgkmcnt(2)
    v_exp_f32 v22, v118
    v_exp_f32 v23, v119
    v_exp_f32 v24, v120
    v_smfmac_f32_16x16x64_bf16 v[180:183], v[208:211], v[128:135], v212
    ds_read_b128 v[200:203], v4 offset:30720
    v_exp_f32 v25, v121
    v_exp_f32 v26, v122
    v_smfmac_f32_32x32x32_bf16 v[160:175], v[204:207], v[136:143], v212
    s_waitcnt lgkmcnt(1)
    v_exp_f32 v27, v123
    v_exp_f32 v28, v124
    v_exp_f32 v29, v125
    v_smfmac_f32_16x16x64_bf16 v[180:183], v[208:211], v[136:143], v212
    ds_read_b128 v[204:207], v4 offset:31744
    v_exp_f32 v30, v126
    v_exp_f32 v31, v127
    v_mfma_f32_32x32x16_bf16 v[112:127], v[228:231], v[56:59], v[80:95]
    ds_read_b128 v[220:223], v4 offset:32768
    v_exp_f32 v128, v96
    v_exp_f32 v129, v97
    v_exp_f32 v130, v98
    v_mfma_f32_32x32x16_bf16 v[112:127], v[232:235], v[60:63], v[112:127]
    ds_read_b128 v[224:227], v4 offset:33792
    s_waitcnt lgkmcnt(3)
    v_exp_f32 v131, v99
    v_exp_f32 v132, v100
    v_exp_f32 v133, v101
    v_smfmac_f32_32x32x32_bf16 v[160:175], v[200:203], v[16:23], v212
    s_waitcnt lgkmcnt(2)
    v_exp_f32 v134, v102
    v_exp_f32 v135, v103
    v_exp_f32 v136, v104
    v_smfmac_f32_16x16x64_bf16 v[180:183], v[208:211], v[16:23], v212
    ds_read_b128 v[200:203], v4 offset:34816
    v_exp_f32 v137, v105
    v_exp_f32 v138, v106
    v_smfmac_f32_32x32x32_bf16 v[160:175], v[204:207], v[24:31], v212
    s_waitcnt lgkmcnt(1)
    v_exp_f32 v139, v107
    v_exp_f32 v140, v108
    v_exp_f32 v141, v109
    v_smfmac_f32_16x16x64_bf16 v[180:183], v[208:211], v[24:31], v212
    ds_read_b128 v[204:207], v4 offset:35840
    v_exp_f32 v142, v110
    v_exp_f32 v143, v111
    v_mfma_f32_32x32x16_bf16 v[96:111], v[220:223], v[56:59], v[80:95]
    ds_read_b128 v[228:231], v4 offset:36864
    v_exp_f32 v16, v112
    v_exp_f32 v17, v113
    v_exp_f32 v18, v114
    v_mfma_f32_32x32x16_bf16 v[96:111], v[224:227], v[60:63], v[96:111]
    ds_read_b128 v[232:235], v4 offset:37888
    s_waitcnt lgkmcnt(3)
    v_exp_f32 v19, v115
    v_exp_f32 v20, v116
    v_exp_f32 v21, v117
    v_smfmac_f32_32x32x32_bf16 v[160:175], v[200:203], v[128:135], v212
    s_waitcnt lgkmcnt(2)
    v_exp_f32 v22, v118
    v_exp_f32 v23, v119
    v_exp_f32 v24, v120
    v_smfmac_f32_16x16x64_bf16 v[180:183], v[208:211], v[128:135], v212
    ds_read_b128 v[200:203], v4 offset:38912
    v_exp_f32 v25, v121
    v_exp_f32 v26, v122
    v_smfmac_f32_32x32x32_bf16 v[160:175], v[204:207], v[136:143], v212
    s_waitcnt lgkmcnt(1)
    v_exp_f32 v27, v123
    v_exp_f32 v28, v124
    v_exp_f32 v29, v125
    v_smfmac_f32_16x16x64_bf16 v[180:183], v[208:211], v[136:143], v212
    ds_read_b128 v[204:207], v4 offset:39936
    v_exp_f32 v30, v126
    v_exp_f32 v31, v127
    v_mfma_f32_32x32x16_bf16 v[112:127], v[228:231], v[56:59], v[80:95]
    ds_read_b128 v[220:223], v4 offset:40960
    v_exp_f32 v128, v96
    v_exp_f32 v129, v97
    v_exp_f32 v130, v98
    v_mfma_f32_32x32x16_bf16 v[112:127], v[232:235], v[60:63], v[112:127]
    ds_read_b128 v[224:227], v4 offset:41984
    s_waitcnt lgkmcnt(3)
    v_exp_f32 v131, v99
    v_exp_f32 v132, v100
    v_exp_f32 v133, v101
    v_smfmac_f32_32x32x32_bf16 v[160:175], v[200:203], v[16:23], v212
    s_waitcnt lgkmcnt(2)
    v_exp_f32 v134, v102
    v_exp_f32 v135, v103
    v_exp_f32 v136, v104
    v_smfmac_f32_16x16x64_bf16 v[180:183], v[208:211], v[16:23], v212
    ds_read_b128 v[200:203], v4 offset:43008
    v_exp_f32 v137, v105
    v_exp_f32 v138, v106
    v_smfmac_f32_32x32x32_bf16 v[160:175], v[204:207], v[24:31], v212
    s_waitcnt lgkmcnt(1)
    v_exp_f32 v139, v107
    v_exp_f32 v140, v108
    v_exp_f32 v141, v109
    v_smfmac_f32_16x16x64_bf16 v[180:183], v[208:211], v[24:31], v212
    ds_read_b128 v[204:207], v4 offset:44032
    v_exp_f32 v142, v110
    v_exp_f32 v143, v111
    v_mfma_f32_32x32x16_bf16 v[96:111], v[220:223], v[56:59], v[80:95]
    ds_read_b128 v[228:231], v4 offset:45056
    v_exp_f32 v16, v112
    v_exp_f32 v17, v113
    v_exp_f32 v18, v114
    v_mfma_f32_32x32x16_bf16 v[96:111], v[224:227], v[60:63], v[96:111]
    ds_read_b128 v[232:235], v4 offset:46080
    s_waitcnt lgkmcnt(3)
    v_exp_f32 v19, v115
    v_exp_f32 v20, v116
    v_exp_f32 v21, v117
    v_smfmac_f32_32x32x32_bf16 v[160:175], v[200:203], v[128:135], v212
    s_waitcnt lgkmcnt(2)
    v_exp_f32 v22, v118
    v_exp_f32 v23, v119
    v_exp_f32 v24, v120
    v_smfmac_f32_16x16x64_bf16 v[180:183], v[208:211], v[128:135], v212
    ds_read_b128 v[200:203], v4 offset:47104
    v_exp_f32 v25, v121
    v_exp_f32 v26, v122
    v_smfmac_f32_32x32x32_bf16 v[160:175], v[204:207], v[136:143], v212
    s_waitcnt lgkmcnt(1)
    v_exp_f32 v27, v123
    v_exp_f32 v28, v124
    v_exp_f32 v29, v125
    v_smfmac_f32_16x16x64_bf16 v[180:183], v[208:211], v[136:143], v212
    ds_read_b128 v[204:207], v4 offset:48128
    v_exp_f32 v30, v126
    v_exp_f32 v31, v127
    v_mfma_f32_32x32x16_bf16 v[112:127], v[228:231], v[56:59], v[80:95]
    ds_read_b128 v[220:223], v4 offset:49152
    v_exp_f32 v128, v96
    v_exp_f32 v129, v97
    v_exp_f32 v130, v98
    v_mfma_f32_32x32x16_bf16 v[112:127], v[232:235], v[60:63], v[112:127]
    ds_read_b128 v[224:227], v4 offset:50176
    s_waitcnt lgkmcnt(3)
    v_exp_f32 v131, v99
    v_exp_f32 v132, v100
    v_exp_f32 v133, v101
    v_smfmac_f32_32x32x32_bf16 v[160:175], v[200:203], v[16:23], v212
    s_waitcnt lgkmcnt(2)
    v_exp_f32 v134, v102
    v_exp_f32 v135, v103
    v_exp_f32 v136, v104
    v_smfmac_f32_16x16x64_bf16 v[180:183], v[208:211], v[16:23], v212
    ds_read_b128 v[200:203], v4 offset:51200
    v_exp_f32 v137, v105
    v_exp_f32 v138, v106
    v_smfmac_f32_32x32x32_bf16 v[160:175], v[204:207], v[24:31], v212
    s_waitcnt lgkmcnt(1)
    v_exp_f32 v139, v107
    v_exp_f32 v140, v108
    v_exp_f32 v141, v109
    v_smfmac_f32_16x16x64_bf16 v[180:183], v[208:211], v[24:31], v212
    ds_read_b128 v[204:207], v4 offset:52224
    v_exp_f32 v142, v110
    v_exp_f32 v143, v111
    v_mfma_f32_32x32x16_bf16 v[96:111], v[220:223], v[56:59], v[80:95]
    ds_read_b128 v[228:231], v4 offset:53248
    v_exp_f32 v16, v112
    v_exp_f32 v17, v113
    v_exp_f32 v18, v114
    v_mfma_f32_32x32x16_bf16 v[96:111], v[224:227], v[60:63], v[96:111]
    ds_read_b128 v[232:235], v4 offset:54272
    s_waitcnt lgkmcnt(3)
    v_exp_f32 v19, v115
    v_exp_f32 v20, v116
    v_exp_f32 v21, v117
    v_smfmac_f32_32x32x32_bf16 v[160:175], v[200:203], v[128:135], v212
    s_waitcnt lgkmcnt(2)
    v_exp_f32 v22, v118
    v_exp_f32 v23, v119
    v_exp_f32 v24, v120
    v_smfmac_f32_16x16x64_bf16 v[180:183], v[208:211], v[128:135], v212
    ds_read_b128 v[200:203], v4 offset:55296
    v_exp_f32 v25, v121
    v_exp_f32 v26, v122
    v_smfmac_f32_32x32x32_bf16 v[160:175], v[204:207], v[136:143], v212
    s_waitcnt lgkmcnt(1)
    v_exp_f32 v27, v123
    v_exp_f32 v28, v124
    v_exp_f32 v29, v125
    v_smfmac_f32_16x16x64_bf16 v[180:183], v[208:211], v[136:143], v212
    ds_read_b128 v[204:207], v4 offset:56320
    v_exp_f32 v30, v126
    v_exp_f32 v31, v127
    s_lshl_b32 s81, s82, 2
    s_add_u32 s81, s81, s3
    s_lshl_b32 s81, s81, 7
    s_add_u32 s81, s81, 0x140000
    v_mov_b32 v7, 0
    s_mov_b64 exec, 1
    buffer_atomic_add v7, v2, s[36:39], s81 offen sc0 sc1
    s_mov_b64 exec, -1
    v_mfma_f32_32x32x16_bf16 v[112:127], v[228:231], v[56:59], v[80:95]
    v_exp_f32 v128, v96
    v_exp_f32 v129, v97
    v_exp_f32 v130, v98
    v_mfma_f32_32x32x16_bf16 v[112:127], v[232:235], v[60:63], v[112:127]
    s_waitcnt lgkmcnt(1)
    v_exp_f32 v131, v99
    v_exp_f32 v132, v100
    v_exp_f32 v133, v101
    v_smfmac_f32_32x32x32_bf16 v[160:175], v[200:203], v[16:23], v212
    s_waitcnt lgkmcnt(0)
    v_exp_f32 v134, v102
    v_exp_f32 v135, v103
    v_exp_f32 v136, v104
    v_smfmac_f32_16x16x64_bf16 v[180:183], v[208:211], v[16:23], v212
    ds_read_b128 v[200:203], v4 offset:59392
    v_exp_f32 v137, v105
    v_exp_f32 v138, v106
    v_smfmac_f32_32x32x32_bf16 v[160:175], v[204:207], v[24:31], v212
    v_exp_f32 v139, v107
    v_exp_f32 v140, v108
    v_exp_f32 v141, v109
    v_smfmac_f32_16x16x64_bf16 v[180:183], v[208:211], v[24:31], v212
    ds_read_b128 v[204:207], v4 offset:60416
    v_exp_f32 v142, v110
    v_exp_f32 v143, v111
    v_exp_f32 v16, v112
    v_exp_f32 v17, v113
    v_exp_f32 v18, v114
    s_waitcnt lgkmcnt(1)
    v_exp_f32 v19, v115
    v_exp_f32 v20, v116
    v_exp_f32 v21, v117
    v_smfmac_f32_32x32x32_bf16 v[160:175], v[200:203], v[128:135], v212
    s_waitcnt lgkmcnt(0)
    v_exp_f32 v22, v118
    v_exp_f32 v23, v119
    v_exp_f32 v24, v120
    v_smfmac_f32_16x16x64_bf16 v[180:183], v[208:211], v[128:135], v212
    ds_read_b128 v[200:203], v4 offset:63488
    v_exp_f32 v25, v121
    v_exp_f32 v26, v122
    v_smfmac_f32_32x32x32_bf16 v[160:175], v[204:207], v[136:143], v212
    v_exp_f32 v27, v123
    v_exp_f32 v28, v124
    v_exp_f32 v29, v125
    v_smfmac_f32_16x16x64_bf16 v[180:183], v[208:211], v[136:143], v212
    ds_read_b128 v[204:207], v4 offset:64512
    v_exp_f32 v30, v126
    v_exp_f32 v31, v127
    s_waitcnt lgkmcnt(0)
    v_smfmac_f32_32x32x32_bf16 v[160:175], v[200:203], v[16:23], v212
    v_smfmac_f32_16x16x64_bf16 v[180:183], v[208:211], v[16:23], v212
    v_smfmac_f32_32x32x32_bf16 v[160:175], v[204:207], v[24:31], v212
    v_smfmac_f32_16x16x64_bf16 v[180:183], v[208:211], v[24:31], v212
    s_barrier
    s_cmp_lg_u32 s75, 0
    s_cbranch_scc1 L_mainc_redo
    s_nop 4
    v_cmp_nle_f32 vcc, 0x2b800000, v180
    v_cmp_nge_f32 s[54:55], s76, v180
    v_rcp_f32 v10, v180
    s_nop 0
    s_or_b64 vcc, vcc, s[54:55]
    s_cbranch_vccnz L_mainc_redo
L_mainc_fin:
    v_pk_mul_f32 v[160:161], v[160:161], v[10:11] op_sel_hi:[1,0]
    v_pk_mul_f32 v[162:163], v[162:163], v[10:11] op_sel_hi:[1,0]
    v_pk_mul_f32 v[164:165], v[164:165], v[10:11] op_sel_hi:[1,0]
    v_pk_mul_f32 v[166:167], v[166:167], v[10:11] op_sel_hi:[1,0]
    v_cvt_pk_bf16_f32 v128, v160, v161
    v_cvt_pk_bf16_f32 v129, v162, v163
    v_cvt_pk_bf16_f32 v130, v164, v165
    v_cvt_pk_bf16_f32 v131, v166, v167
    buffer_store_dwordx4 v[128:131], v245, s[36:39], s79 offen offset:0 sc1
    v_pk_mul_f32 v[168:169], v[168:169], v[10:11] op_sel_hi:[1,0]
    v_pk_mul_f32 v[170:171], v[170:171], v[10:11] op_sel_hi:[1,0]
    v_pk_mul_f32 v[172:173], v[172:173], v[10:11] op_sel_hi:[1,0]
    v_pk_mul_f32 v[174:175], v[174:175], v[10:11] op_sel_hi:[1,0]
    v_cvt_pk_bf16_f32 v132, v168, v169
    v_cvt_pk_bf16_f32 v133, v170, v171
    v_cvt_pk_bf16_f32 v134, v172, v173
    v_cvt_pk_bf16_f32 v135, v174, v175
    buffer_store_dwordx4 v[132:135], v245, s[36:39], s79 offen offset:512 sc1
    s_mov_b64 exec, 1
    s_mov_b32 s53, 0x8000
    s_waitcnt vmcnt(2)
    s_branch L_mainc_poc
L_mainc_po:
    v_mov_b32 v7, 0
    buffer_atomic_add v7, v2, s[36:39], s81 offen sc0 sc1
    s_waitcnt vmcnt(0)
L_mainc_poc:
    v_cmp_ne_u32 vcc, 15, v7
    s_sub_u32 s53, s53, 1
    s_cbranch_scc1 L_mainc_pox
    s_cbranch_vccnz L_mainc_po
L_mainc_pox:
    s_mov_b64 exec, -1
    s_mov_b32 s72, 0
    s_mov_b32 s73, 3
    s_mov_b32 s74, 0
    buffer_load_dwordx4 v[80:83], v2, s[40:43], s72 offen offset:0 sc1
    buffer_load_dwordx4 v[84:87], v2, s[40:43], s72 offen offset:1024 sc1
    buffer_load_dwordx4 v[88:91], v2, s[40:43], s72 offen offset:2048 sc1
    buffer_load_dwordx4 v[92:95], v2, s[40:43], s72 offen offset:3072 sc1
    s_add_u32 s72, s72, 4096
    buffer_load_dwordx4 v[96:99], v2, s[40:43], s72 offen offset:0 sc1
    buffer_load_dwordx4 v[100:103], v2, s[40:43], s72 offen offset:1024 sc1
    buffer_load_dwordx4 v[104:107], v2, s[40:43], s72 offen offset:2048 sc1
    buffer_load_dwordx4 v[108:111], v2, s[40:43], s72 offen offset:3072 sc1
    s_add_u32 s72, s72, 4096
    v_pk_mov_b32 v[4:5], v[236:237], v[236:237] op_sel:[0,1]
    v_pk_mov_b32 v[6:7], v[238:239], v[238:239] op_sel:[0,1]
    v_pk_mov_b32 v[16:17], 0, 0
    v_pk_mov_b32 v[18:19], 0, 0
    v_pk_mov_b32 v[20:21], 0, 0
    v_pk_mov_b32 v[22:23], 0, 0
    v_pk_mov_b32 v[24:25], 0, 0
    v_pk_mov_b32 v[26:27], 0, 0
    v_pk_mov_b32 v[28:29], 0, 0
    v_pk_mov_b32 v[30:31], 0, 0
    v_pk_mov_b32 v[32:33], 0, 0
    v_pk_mov_b32 v[34:35], 0, 0
    v_pk_mov_b32 v[36:37], 0, 0
    v_pk_mov_b32 v[38:39], 0, 0
    v_pk_mov_b32 v[40:41], 0, 0
    v_pk_mov_b32 v[42:43], 0, 0
    v_pk_mov_b32 v[44:45], 0, 0
    v_pk_mov_b32 v[46:47], 0, 0
    s_lshr_b32 s78, s77, 16
    s_lshl_b32 s79, s35, 12
    s_add_u32 s79, s79, s77
    s_add_u32 s79, s79, 0xa00000
    s_lshl_b32 s52, s83, 2
    s_add_u32 s52, s52, s3
    s_lshl_b32 s52, s52, 7
    s_add_u32 s52, s52, 0x140000
    v_mov_b32 v15, 1
    s_waitcnt vmcnt(8)
    s_mov_b64 exec, 1
    buffer_atomic_add v15, v2, s[36:39], s52 offen sc1
    s_mov_b64 exec, -1
    ds_read_b64_tr_b16 v[48:49], v4 offset:0
    ds_read_b64_tr_b16 v[50:51], v4 offset:1024
    ds_read_b64_tr_b16 v[52:53], v5 offset:0
    ds_read_b64_tr_b16 v[54:55], v5 offset:1024
    ds_read_b64_tr_b16 v[56:57], v6 offset:0
    ds_read_b64_tr_b16 v[58:59], v6 offset:1024
    ds_read_b64_tr_b16 v[60:61], v7 offset:0
    ds_read_b64_tr_b16 v[62:63], v7 offset:1024
    ds_read_b64_tr_b16 v[64:65], v4 offset:4096
    ds_read_b64_tr_b16 v[66:67], v4 offset:5120
    ds_read_b64_tr_b16 v[68:69], v5 offset:4096
    ds_read_b64_tr_b16 v[70:71], v5 offset:5120
    ds_read_b64_tr_b16 v[72:73], v6 offset:4096
    ds_read_b64_tr_b16 v[74:75], v6 offset:5120
    buffer_load_dwordx4 v[112:115], v2, s[40:43], s72 offen offset:0 sc1
    buffer_load_dwordx4 v[116:119], v2, s[40:43], s72 offen offset:1024 sc1
    buffer_load_dwordx4 v[120:123], v2, s[40:43], s72 offen offset:2048 sc1
    buffer_load_dwordx4 v[124:127], v2, s[40:43], s72 offen offset:3072 sc1
    s_add_u32 s72, s72, 4096
L_mainc_ol:
    s_waitcnt vmcnt(10) lgkmcnt(10)
    v_mfma_f32_16x16x32_bf16 v[16:19], v[48:51], v[80:83], v[16:19]
    buffer_load_dwordx4 v[128:131], v2, s[40:43], s72 offen offset:0 sc1
    ds_read_b64_tr_b16 v[76:77], v7 offset:4096
    v_mfma_f32_16x16x32_bf16 v[32:35], v[48:51], v[84:87], v[32:35]
    ds_read_b64_tr_b16 v[78:79], v7 offset:5120
    v_mfma_f32_16x16x32_bf16 v[20:23], v[52:55], v[80:83], v[20:23]
    ds_read_b64_tr_b16 v[48:49], v4 offset:8192
    v_mfma_f32_16x16x32_bf16 v[36:39], v[52:55], v[84:87], v[36:39]
    ds_read_b64_tr_b16 v[50:51], v4 offset:9216
    s_waitcnt lgkmcnt(10)
    v_mfma_f32_16x16x32_bf16 v[24:27], v[56:59], v[80:83], v[24:27]
    buffer_load_dwordx4 v[132:135], v2, s[40:43], s72 offen offset:1024 sc1
    ds_read_b64_tr_b16 v[52:53], v5 offset:8192
    v_mfma_f32_16x16x32_bf16 v[40:43], v[56:59], v[84:87], v[40:43]
    ds_read_b64_tr_b16 v[54:55], v5 offset:9216
    v_mfma_f32_16x16x32_bf16 v[28:31], v[60:63], v[80:83], v[28:31]
    ds_read_b64_tr_b16 v[56:57], v6 offset:8192
    v_mfma_f32_16x16x32_bf16 v[44:47], v[60:63], v[84:87], v[44:47]
    ds_read_b64_tr_b16 v[58:59], v6 offset:9216
    s_waitcnt vmcnt(10) lgkmcnt(10)
    v_mfma_f32_16x16x32_bf16 v[16:19], v[64:67], v[88:91], v[16:19]
    buffer_load_dwordx4 v[136:139], v2, s[40:43], s72 offen offset:2048 sc1
    ds_read_b64_tr_b16 v[60:61], v7 offset:8192
    v_mfma_f32_16x16x32_bf16 v[32:35], v[64:67], v[92:95], v[32:35]
    ds_read_b64_tr_b16 v[62:63], v7 offset:9216
    v_mfma_f32_16x16x32_bf16 v[20:23], v[68:71], v[88:91], v[20:23]
    ds_read_b64_tr_b16 v[64:65], v4 offset:12288
    v_mfma_f32_16x16x32_bf16 v[36:39], v[68:71], v[92:95], v[36:39]
    ds_read_b64_tr_b16 v[66:67], v4 offset:13312
    s_waitcnt lgkmcnt(10)
    v_mfma_f32_16x16x32_bf16 v[24:27], v[72:75], v[88:91], v[24:27]
    buffer_load_dwordx4 v[140:143], v2, s[40:43], s72 offen offset:3072 sc1
    ds_read_b64_tr_b16 v[68:69], v5 offset:12288
    v_mfma_f32_16x16x32_bf16 v[40:43], v[72:75], v[92:95], v[40:43]
    s_add_u32 s72, s72, 4096
    ds_read_b64_tr_b16 v[70:71], v5 offset:13312
    v_mfma_f32_16x16x32_bf16 v[28:31], v[76:79], v[88:91], v[28:31]
    s_barrier
    ds_read_b64_tr_b16 v[72:73], v6 offset:12288
    v_mfma_f32_16x16x32_bf16 v[44:47], v[76:79], v[92:95], v[44:47]
    ds_read_b64_tr_b16 v[74:75], v6 offset:13312
    s_waitcnt vmcnt(10) lgkmcnt(10)
    v_mfma_f32_16x16x32_bf16 v[16:19], v[48:51], v[96:99], v[16:19]
    buffer_load_dwordx4 v[80:83], v2, s[40:43], s72 offen offset:0 sc1
    ds_read_b64_tr_b16 v[76:77], v7 offset:12288
    v_mfma_f32_16x16x32_bf16 v[32:35], v[48:51], v[100:103], v[32:35]
    ds_read_b64_tr_b16 v[78:79], v7 offset:13312
    v_mfma_f32_16x16x32_bf16 v[20:23], v[52:55], v[96:99], v[20:23]
    ds_read_b64_tr_b16 v[48:49], v4 offset:16384
    v_mfma_f32_16x16x32_bf16 v[36:39], v[52:55], v[100:103], v[36:39]
    ds_read_b64_tr_b16 v[50:51], v4 offset:17408
    s_waitcnt lgkmcnt(10)
    v_mfma_f32_16x16x32_bf16 v[24:27], v[56:59], v[96:99], v[24:27]
    buffer_load_dwordx4 v[84:87], v2, s[40:43], s72 offen offset:1024 sc1
    ds_read_b64_tr_b16 v[52:53], v5 offset:16384
    v_mfma_f32_16x16x32_bf16 v[40:43], v[56:59], v[100:103], v[40:43]
    ds_read_b64_tr_b16 v[54:55], v5 offset:17408
    v_mfma_f32_16x16x32_bf16 v[28:31], v[60:63], v[96:99], v[28:31]
    ds_read_b64_tr_b16 v[56:57], v6 offset:16384
    v_mfma_f32_16x16x32_bf16 v[44:47], v[60:63], v[100:103], v[44:47]
    ds_read_b64_tr_b16 v[58:59], v6 offset:17408
    s_waitcnt vmcnt(10) lgkmcnt(10)
    v_mfma_f32_16x16x32_bf16 v[16:19], v[64:67], v[104:107], v[16:19]
    buffer_load_dwordx4 v[88:91], v2, s[40:43], s72 offen offset:2048 sc1
    ds_read_b64_tr_b16 v[60:61], v7 offset:16384
    v_mfma_f32_16x16x32_bf16 v[32:35], v[64:67], v[108:111], v[32:35]
    ds_read_b64_tr_b16 v[62:63], v7 offset:17408
    v_mfma_f32_16x16x32_bf16 v[20:23], v[68:71], v[104:107], v[20:23]
    ds_read_b64_tr_b16 v[64:65], v4 offset:20480
    v_mfma_f32_16x16x32_bf16 v[36:39], v[68:71], v[108:111], v[36:39]
    ds_read_b64_tr_b16 v[66:67], v4 offset:21504
    s_waitcnt lgkmcnt(10)
    v_mfma_f32_16x16x32_bf16 v[24:27], v[72:75], v[104:107], v[24:27]
    buffer_load_dwordx4 v[92:95], v2, s[40:43], s72 offen offset:3072 sc1
    ds_read_b64_tr_b16 v[68:69], v5 offset:20480
    v_mfma_f32_16x16x32_bf16 v[40:43], v[72:75], v[108:111], v[40:43]
    s_add_u32 s72, s72, 4096
    ds_read_b64_tr_b16 v[70:71], v5 offset:21504
    v_mfma_f32_16x16x32_bf16 v[28:31], v[76:79], v[104:107], v[28:31]
    ds_read_b64_tr_b16 v[72:73], v6 offset:20480
    v_mfma_f32_16x16x32_bf16 v[44:47], v[76:79], v[108:111], v[44:47]
    ds_read_b64_tr_b16 v[74:75], v6 offset:21504
    s_waitcnt vmcnt(10) lgkmcnt(10)
    v_mfma_f32_16x16x32_bf16 v[16:19], v[48:51], v[112:115], v[16:19]
    buffer_load_dwordx4 v[96:99], v2, s[40:43], s72 offen offset:0 sc1
    ds_read_b64_tr_b16 v[76:77], v7 offset:20480
    v_mfma_f32_16x16x32_bf16 v[32:35], v[48:51], v[116:119], v[32:35]
    ds_read_b64_tr_b16 v[78:79], v7 offset:21504
    v_mfma_f32_16x16x32_bf16 v[20:23], v[52:55], v[112:115], v[20:23]
    s_add_u32 s74, s74, 0x8000
    ds_read_b64_tr_b16 v[48:49], v4 offset:24576
    v_mfma_f32_16x16x32_bf16 v[36:39], v[52:55], v[116:119], v[36:39]
    ds_read_b64_tr_b16 v[50:51], v4 offset:25600
    s_waitcnt lgkmcnt(10)
    v_mfma_f32_16x16x32_bf16 v[24:27], v[56:59], v[112:115], v[24:27]
    buffer_load_dwordx4 v[100:103], v2, s[40:43], s72 offen offset:1024 sc1
    ds_read_b64_tr_b16 v[52:53], v5 offset:24576
    v_mfma_f32_16x16x32_bf16 v[40:43], v[56:59], v[116:119], v[40:43]
    ds_read_b64_tr_b16 v[54:55], v5 offset:25600
    v_mfma_f32_16x16x32_bf16 v[28:31], v[60:63], v[112:115], v[28:31]
    s_and_b32 s74, s74, 0x1ffff
    ds_read_b64_tr_b16 v[56:57], v6 offset:24576
    v_mfma_f32_16x16x32_bf16 v[44:47], v[60:63], v[116:119], v[44:47]
    ds_read_b64_tr_b16 v[58:59], v6 offset:25600
    s_waitcnt vmcnt(10) lgkmcnt(10)
    v_mfma_f32_16x16x32_bf16 v[16:19], v[64:67], v[120:123], v[16:19]
    buffer_load_dwordx4 v[104:107], v2, s[40:43], s72 offen offset:2048 sc1
    ds_read_b64_tr_b16 v[60:61], v7 offset:24576
    v_mfma_f32_16x16x32_bf16 v[32:35], v[64:67], v[124:127], v[32:35]
    ds_read_b64_tr_b16 v[62:63], v7 offset:25600
    v_mfma_f32_16x16x32_bf16 v[20:23], v[68:71], v[120:123], v[20:23]
    ds_read_b64_tr_b16 v[64:65], v4 offset:28672
    v_mfma_f32_16x16x32_bf16 v[36:39], v[68:71], v[124:127], v[36:39]
    ds_read_b64_tr_b16 v[66:67], v4 offset:29696
    s_waitcnt lgkmcnt(10)
    v_mfma_f32_16x16x32_bf16 v[24:27], v[72:75], v[120:123], v[24:27]
    buffer_load_dwordx4 v[108:111], v2, s[40:43], s72 offen offset:3072 sc1
    ds_read_b64_tr_b16 v[68:69], v5 offset:28672
    v_mfma_f32_16x16x32_bf16 v[40:43], v[72:75], v[124:127], v[40:43]
    s_add_u32 s72, s72, 4096
    v_add_u32 v4, s74, v236
    ds_read_b64_tr_b16 v[70:71], v5 offset:29696
    v_mfma_f32_16x16x32_bf16 v[28:31], v[76:79], v[120:123], v[28:31]
    ds_read_b64_tr_b16 v[72:73], v6 offset:28672
    v_mfma_f32_16x16x32_bf16 v[44:47], v[76:79], v[124:127], v[44:47]
    ds_read_b64_tr_b16 v[74:75], v6 offset:29696
    s_waitcnt vmcnt(10) lgkmcnt(10)
    v_mfma_f32_16x16x32_bf16 v[16:19], v[48:51], v[128:131], v[16:19]
    buffer_load_dwordx4 v[112:115], v2, s[40:43], s72 offen offset:0 sc1
    ds_read_b64_tr_b16 v[76:77], v7 offset:28672
    v_mfma_f32_16x16x32_bf16 v[32:35], v[48:51], v[132:135], v[32:35]
    v_add_u32 v5, s74, v237
    ds_read_b64_tr_b16 v[78:79], v7 offset:29696
    v_mfma_f32_16x16x32_bf16 v[20:23], v[52:55], v[128:131], v[20:23]
    ds_read_b64_tr_b16 v[48:49], v4 offset:0
    v_mfma_f32_16x16x32_bf16 v[36:39], v[52:55], v[132:135], v[36:39]
    ds_read_b64_tr_b16 v[50:51], v4 offset:1024
    s_waitcnt lgkmcnt(10)
    v_mfma_f32_16x16x32_bf16 v[24:27], v[56:59], v[128:131], v[24:27]
    buffer_load_dwordx4 v[116:119], v2, s[40:43], s72 offen offset:1024 sc1
    ds_read_b64_tr_b16 v[52:53], v5 offset:0
    v_mfma_f32_16x16x32_bf16 v[40:43], v[56:59], v[132:135], v[40:43]
    v_add_u32 v6, s74, v238
    ds_read_b64_tr_b16 v[54:55], v5 offset:1024
    v_mfma_f32_16x16x32_bf16 v[28:31], v[60:63], v[128:131], v[28:31]
    v_add_u32 v7, s74, v239
    ds_read_b64_tr_b16 v[56:57], v6 offset:0
    v_mfma_f32_16x16x32_bf16 v[44:47], v[60:63], v[132:135], v[44:47]
    ds_read_b64_tr_b16 v[58:59], v6 offset:1024
    s_waitcnt vmcnt(10) lgkmcnt(10)
    v_mfma_f32_16x16x32_bf16 v[16:19], v[64:67], v[136:139], v[16:19]
    buffer_load_dwordx4 v[120:123], v2, s[40:43], s72 offen offset:2048 sc1
    ds_read_b64_tr_b16 v[60:61], v7 offset:0
    v_mfma_f32_16x16x32_bf16 v[32:35], v[64:67], v[140:143], v[32:35]
    ds_read_b64_tr_b16 v[62:63], v7 offset:1024
    v_mfma_f32_16x16x32_bf16 v[20:23], v[68:71], v[136:139], v[20:23]
    s_sub_u32 s73, s73, 1
    ds_read_b64_tr_b16 v[64:65], v4 offset:4096
    v_mfma_f32_16x16x32_bf16 v[36:39], v[68:71], v[140:143], v[36:39]
    ds_read_b64_tr_b16 v[66:67], v4 offset:5120
    s_waitcnt lgkmcnt(10)
    v_mfma_f32_16x16x32_bf16 v[24:27], v[72:75], v[136:139], v[24:27]
    buffer_load_dwordx4 v[124:127], v2, s[40:43], s72 offen offset:3072 sc1
    ds_read_b64_tr_b16 v[68:69], v5 offset:4096
    v_mfma_f32_16x16x32_bf16 v[40:43], v[72:75], v[140:143], v[40:43]
    s_add_u32 s72, s72, 4096
    ds_read_b64_tr_b16 v[70:71], v5 offset:5120
    v_mfma_f32_16x16x32_bf16 v[28:31], v[76:79], v[136:139], v[28:31]
    ds_read_b64_tr_b16 v[72:73], v6 offset:4096
    v_mfma_f32_16x16x32_bf16 v[44:47], v[76:79], v[140:143], v[44:47]
    ds_read_b64_tr_b16 v[74:75], v6 offset:5120
    s_cmp_lg_u32 s73, 0
    s_cbranch_scc1 L_mainc_ol
    s_waitcnt vmcnt(10) lgkmcnt(10)
    v_mfma_f32_16x16x32_bf16 v[16:19], v[48:51], v[80:83], v[16:19]
    buffer_load_dwordx4 v[128:131], v2, s[40:43], s72 offen offset:0 sc1
    ds_read_b64_tr_b16 v[76:77], v7 offset:4096
    v_mfma_f32_16x16x32_bf16 v[32:35], v[48:51], v[84:87], v[32:35]
    ds_read_b64_tr_b16 v[78:79], v7 offset:5120
    v_mfma_f32_16x16x32_bf16 v[20:23], v[52:55], v[80:83], v[20:23]
    ds_read_b64_tr_b16 v[48:49], v4 offset:8192
    v_mfma_f32_16x16x32_bf16 v[36:39], v[52:55], v[84:87], v[36:39]
    ds_read_b64_tr_b16 v[50:51], v4 offset:9216
    s_waitcnt lgkmcnt(10)
    v_mfma_f32_16x16x32_bf16 v[24:27], v[56:59], v[80:83], v[24:27]
    buffer_load_dwordx4 v[132:135], v2, s[40:43], s72 offen offset:1024 sc1
    ds_read_b64_tr_b16 v[52:53], v5 offset:8192
    v_mfma_f32_16x16x32_bf16 v[40:43], v[56:59], v[84:87], v[40:43]
    ds_read_b64_tr_b16 v[54:55], v5 offset:9216
    v_mfma_f32_16x16x32_bf16 v[28:31], v[60:63], v[80:83], v[28:31]
    ds_read_b64_tr_b16 v[56:57], v6 offset:8192
    v_mfma_f32_16x16x32_bf16 v[44:47], v[60:63], v[84:87], v[44:47]
    ds_read_b64_tr_b16 v[58:59], v6 offset:9216
    s_waitcnt vmcnt(10) lgkmcnt(10)
    v_mfma_f32_16x16x32_bf16 v[16:19], v[64:67], v[88:91], v[16:19]
    buffer_load_dwordx4 v[136:139], v2, s[40:43], s72 offen offset:2048 sc1
    ds_read_b64_tr_b16 v[60:61], v7 offset:8192
    v_mfma_f32_16x16x32_bf16 v[32:35], v[64:67], v[92:95], v[32:35]
    ds_read_b64_tr_b16 v[62:63], v7 offset:9216
    v_mfma_f32_16x16x32_bf16 v[20:23], v[68:71], v[88:91], v[20:23]
    ds_read_b64_tr_b16 v[64:65], v4 offset:12288
    v_mfma_f32_16x16x32_bf16 v[36:39], v[68:71], v[92:95], v[36:39]
    ds_read_b64_tr_b16 v[66:67], v4 offset:13312
    s_waitcnt lgkmcnt(10)
    v_mfma_f32_16x16x32_bf16 v[24:27], v[72:75], v[88:91], v[24:27]
    buffer_load_dwordx4 v[140:143], v2, s[40:43], s72 offen offset:3072 sc1
    ds_read_b64_tr_b16 v[68:69], v5 offset:12288
    v_mfma_f32_16x16x32_bf16 v[40:43], v[72:75], v[92:95], v[40:43]
    s_add_u32 s72, s72, 4096
    ds_read_b64_tr_b16 v[70:71], v5 offset:13312
    v_mfma_f32_16x16x32_bf16 v[28:31], v[76:79], v[88:91], v[28:31]
    ds_read_b64_tr_b16 v[72:73], v6 offset:12288
    v_mfma_f32_16x16x32_bf16 v[44:47], v[76:79], v[92:95], v[44:47]
    ds_read_b64_tr_b16 v[74:75], v6 offset:13312
    s_waitcnt vmcnt(10) lgkmcnt(10)
    v_mfma_f32_16x16x32_bf16 v[16:19], v[48:51], v[96:99], v[16:19]
    ds_read_b64_tr_b16 v[76:77], v7 offset:12288
    v_mfma_f32_16x16x32_bf16 v[32:35], v[48:51], v[100:103], v[32:35]
    ds_read_b64_tr_b16 v[78:79], v7 offset:13312
    v_mfma_f32_16x16x32_bf16 v[20:23], v[52:55], v[96:99], v[20:23]
    ds_read_b64 v[144:145], v240 offset:0
    ds_read_b64_tr_b16 v[48:49], v4 offset:16384
    v_mfma_f32_16x16x32_bf16 v[36:39], v[52:55], v[100:103], v[36:39]
    ds_read_b64_tr_b16 v[50:51], v4 offset:17408
    s_waitcnt lgkmcnt(10)
    v_mfma_f32_16x16x32_bf16 v[24:27], v[56:59], v[96:99], v[24:27]
    ds_read_b64_tr_b16 v[52:53], v5 offset:16384
    v_mfma_f32_16x16x32_bf16 v[40:43], v[56:59], v[100:103], v[40:43]
    ds_read_b64_tr_b16 v[54:55], v5 offset:17408
    v_mfma_f32_16x16x32_bf16 v[28:31], v[60:63], v[96:99], v[28:31]
    ds_read_b64 v[152:153], v240 offset:2048
    ds_read_b64_tr_b16 v[56:57], v6 offset:16384
    v_mfma_f32_16x16x32_bf16 v[44:47], v[60:63], v[100:103], v[44:47]
    ds_read_b64_tr_b16 v[58:59], v6 offset:17408
    s_waitcnt vmcnt(8) lgkmcnt(10)
    v_mfma_f32_16x16x32_bf16 v[16:19], v[64:67], v[104:107], v[16:19]
    ds_read_b64_tr_b16 v[60:61], v7 offset:16384
    v_mfma_f32_16x16x32_bf16 v[32:35], v[64:67], v[108:111], v[32:35]
    ds_read_b64_tr_b16 v[62:63], v7 offset:17408
    v_mfma_f32_16x16x32_bf16 v[20:23], v[68:71], v[104:107], v[20:23]
    ds_read_b64 v[146:147], v241 offset:0
    ds_read_b64_tr_b16 v[64:65], v4 offset:20480
    v_mfma_f32_16x16x32_bf16 v[36:39], v[68:71], v[108:111], v[36:39]
    ds_read_b64_tr_b16 v[66:67], v4 offset:21504
    s_waitcnt lgkmcnt(10)
    v_mfma_f32_16x16x32_bf16 v[24:27], v[72:75], v[104:107], v[24:27]
    ds_read_b64_tr_b16 v[68:69], v5 offset:20480
    v_mfma_f32_16x16x32_bf16 v[40:43], v[72:75], v[108:111], v[40:43]
    ds_read_b64_tr_b16 v[70:71], v5 offset:21504
    v_mfma_f32_16x16x32_bf16 v[28:31], v[76:79], v[104:107], v[28:31]
    ds_read_b64 v[154:155], v241 offset:2048
    ds_read_b64_tr_b16 v[72:73], v6 offset:20480
    v_mfma_f32_16x16x32_bf16 v[44:47], v[76:79], v[108:111], v[44:47]
    ds_read_b64_tr_b16 v[74:75], v6 offset:21504
    s_waitcnt vmcnt(6) lgkmcnt(10)
    v_mfma_f32_16x16x32_bf16 v[16:19], v[48:51], v[112:115], v[16:19]
    ds_read_b64_tr_b16 v[76:77], v7 offset:20480
    v_mfma_f32_16x16x32_bf16 v[32:35], v[48:51], v[116:119], v[32:35]
    ds_read_b64_tr_b16 v[78:79], v7 offset:21504
    v_mfma_f32_16x16x32_bf16 v[20:23], v[52:55], v[112:115], v[20:23]
    ds_read_b64 v[148:149], v242 offset:0
    ds_read_b64_tr_b16 v[48:49], v4 offset:24576
    v_mfma_f32_16x16x32_bf16 v[36:39], v[52:55], v[116:119], v[36:39]
    ds_read_b64_tr_b16 v[50:51], v4 offset:25600
    s_waitcnt lgkmcnt(10)
    v_mfma_f32_16x16x32_bf16 v[24:27], v[56:59], v[112:115], v[24:27]
    ds_read_b64_tr_b16 v[52:53], v5 offset:24576
    v_mfma_f32_16x16x32_bf16 v[40:43], v[56:59], v[116:119], v[40:43]
    ds_read_b64_tr_b16 v[54:55], v5 offset:25600
    v_mfma_f32_16x16x32_bf16 v[28:31], v[60:63], v[112:115], v[28:31]
    ds_read_b64 v[156:157], v242 offset:2048
    ds_read_b64_tr_b16 v[56:57], v6 offset:24576
    v_mfma_f32_16x16x32_bf16 v[44:47], v[60:63], v[116:119], v[44:47]
    ds_read_b64_tr_b16 v[58:59], v6 offset:25600
    s_waitcnt vmcnt(4) lgkmcnt(10)
    v_mfma_f32_16x16x32_bf16 v[16:19], v[64:67], v[120:123], v[16:19]
    ds_read_b64_tr_b16 v[60:61], v7 offset:24576
    v_mfma_f32_16x16x32_bf16 v[32:35], v[64:67], v[124:127], v[32:35]
    ds_read_b64_tr_b16 v[62:63], v7 offset:25600
    v_mfma_f32_16x16x32_bf16 v[20:23], v[68:71], v[120:123], v[20:23]
    ds_read_b64 v[150:151], v243 offset:0
    ds_read_b64_tr_b16 v[64:65], v4 offset:28672
    v_mfma_f32_16x16x32_bf16 v[36:39], v[68:71], v[124:127], v[36:39]
    ds_read_b64_tr_b16 v[66:67], v4 offset:29696
    s_waitcnt lgkmcnt(10)
    v_mfma_f32_16x16x32_bf16 v[24:27], v[72:75], v[120:123], v[24:27]
    ds_read_b64_tr_b16 v[68:69], v5 offset:28672
    v_mfma_f32_16x16x32_bf16 v[40:43], v[72:75], v[124:127], v[40:43]
    ds_read_b64_tr_b16 v[70:71], v5 offset:29696
    v_mfma_f32_16x16x32_bf16 v[28:31], v[76:79], v[120:123], v[28:31]
    ds_read_b64 v[158:159], v243 offset:2048
    ds_read_b64_tr_b16 v[72:73], v6 offset:28672
    v_mfma_f32_16x16x32_bf16 v[44:47], v[76:79], v[124:127], v[44:47]
    ds_read_b64_tr_b16 v[74:75], v6 offset:29696
    s_waitcnt vmcnt(2) lgkmcnt(10)
    v_mfma_f32_16x16x32_bf16 v[16:19], v[48:51], v[128:131], v[16:19]
    ds_read_b64_tr_b16 v[76:77], v7 offset:28672
    v_mfma_f32_16x16x32_bf16 v[32:35], v[48:51], v[132:135], v[32:35]
    ds_read_b64_tr_b16 v[78:79], v7 offset:29696
    v_mfma_f32_16x16x32_bf16 v[20:23], v[52:55], v[128:131], v[20:23]
    ds_read_b128 v[160:163], v244 offset:0
    v_mfma_f32_16x16x32_bf16 v[36:39], v[52:55], v[132:135], v[36:39]
    ds_read_b128 v[164:167], v244 offset:64
    s_waitcnt lgkmcnt(8)
    v_mfma_f32_16x16x32_bf16 v[24:27], v[56:59], v[128:131], v[24:27]
    ds_read_b128 v[168:171], v244 offset:128
    v_mfma_f32_16x16x32_bf16 v[40:43], v[56:59], v[132:135], v[40:43]
    ds_read_b128 v[172:175], v244 offset:192
    v_mfma_f32_16x16x32_bf16 v[28:31], v[60:63], v[128:131], v[28:31]
    ds_read_b128 v[176:179], v244 offset:16384
    v_mfma_f32_16x16x32_bf16 v[44:47], v[60:63], v[132:135], v[44:47]
    ds_read_b128 v[180:183], v244 offset:16448
    s_waitcnt vmcnt(0) lgkmcnt(4)
    v_mfma_f32_16x16x32_bf16 v[16:19], v[64:67], v[136:139], v[16:19]
    ds_read_b128 v[184:187], v244 offset:16512
    v_mfma_f32_16x16x32_bf16 v[32:35], v[64:67], v[140:143], v[32:35]
    ds_read_b128 v[188:191], v244 offset:16576
    v_mfma_f32_16x16x32_bf16 v[20:23], v[68:71], v[136:139], v[20:23]
    v_mfma_f32_16x16x32_bf16 v[36:39], v[68:71], v[140:143], v[36:39]
    s_waitcnt lgkmcnt(0)
    v_mfma_f32_16x16x32_bf16 v[24:27], v[72:75], v[136:139], v[24:27]
    v_lshlrev_b32 v192, 16, v144
    v_and_b32 v193, 0xffff0000, v144
    v_mfma_f32_16x16x32_bf16 v[40:43], v[72:75], v[140:143], v[40:43]
    v_lshlrev_b32 v194, 16, v145
    v_and_b32 v195, 0xffff0000, v145
    v_mfma_f32_16x16x32_bf16 v[28:31], v[76:79], v[136:139], v[28:31]
    v_lshlrev_b32 v196, 16, v146
    v_and_b32 v197, 0xffff0000, v146
    v_mfma_f32_16x16x32_bf16 v[44:47], v[76:79], v[140:143], v[44:47]
    v_lshlrev_b32 v198, 16, v147
    v_and_b32 v199, 0xffff0000, v147
    s_barrier
    s_nop 1
    v_pk_fma_f32 v[16:17], v[16:17], v[160:161], v[192:193]
    v_pk_fma_f32 v[18:19], v[18:19], v[162:163], v[194:195]
    v_pk_fma_f32 v[20:21], v[20:21], v[164:165], v[196:197]
    v_pk_fma_f32 v[22:23], v[22:23], v[166:167], v[198:199]
    v_pk_mul_f32 v[80:81], v[16:17], v[176:177]
    v_pk_mul_f32 v[82:83], v[18:19], v[178:179]
    v_pk_mul_f32 v[84:85], v[20:21], v[180:181]
    v_pk_mul_f32 v[86:87], v[22:23], v[182:183]
    v_cvt_pk_bf16_f32 v144, v80, v81
    v_cvt_pk_bf16_f32 v145, v82, v83
    v_cvt_pk_bf16_f32 v146, v84, v85
    v_cvt_pk_bf16_f32 v147, v86, v87
    buffer_store_dwordx4 v[144:147], v2, s[36:39], s79 offen offset:0 sc1
    v_lshlrev_b32 v208, 16, v152
    v_and_b32 v209, 0xffff0000, v152
    v_lshlrev_b32 v210, 16, v153
    v_and_b32 v211, 0xffff0000, v153
    v_lshlrev_b32 v212, 16, v154
    v_and_b32 v213, 0xffff0000, v154
    v_lshlrev_b32 v214, 16, v155
    v_and_b32 v215, 0xffff0000, v155
    v_pk_fma_f32 v[32:33], v[32:33], v[160:161], v[208:209]
    v_pk_fma_f32 v[34:35], v[34:35], v[162:163], v[210:211]
    v_pk_fma_f32 v[36:37], v[36:37], v[164:165], v[212:213]
    v_pk_fma_f32 v[38:39], v[38:39], v[166:167], v[214:215]
    v_pk_mul_f32 v[96:97], v[32:33], v[176:177]
    v_pk_mul_f32 v[98:99], v[34:35], v[178:179]
    v_pk_mul_f32 v[100:101], v[36:37], v[180:181]
    v_pk_mul_f32 v[102:103], v[38:39], v[182:183]
    v_cvt_pk_bf16_f32 v152, v96, v97
    v_cvt_pk_bf16_f32 v153, v98, v99
    v_cvt_pk_bf16_f32 v154, v100, v101
    v_cvt_pk_bf16_f32 v155, v102, v103
    buffer_store_dwordx4 v[152:155], v2, s[36:39], s79 offen offset:1024 sc1
    v_lshlrev_b32 v200, 16, v148
    v_and_b32 v201, 0xffff0000, v148
    v_lshlrev_b32 v202, 16, v149
    v_and_b32 v203, 0xffff0000, v149
    v_lshlrev_b32 v204, 16, v150
    v_and_b32 v205, 0xffff0000, v150
    v_lshlrev_b32 v206, 16, v151
    v_and_b32 v207, 0xffff0000, v151
    v_pk_fma_f32 v[24:25], v[24:25], v[168:169], v[200:201]
    v_pk_fma_f32 v[26:27], v[26:27], v[170:171], v[202:203]
    v_pk_fma_f32 v[28:29], v[28:29], v[172:173], v[204:205]
    v_pk_fma_f32 v[30:31], v[30:31], v[174:175], v[206:207]
    v_pk_mul_f32 v[88:89], v[24:25], v[184:185]
    v_pk_mul_f32 v[90:91], v[26:27], v[186:187]
    v_pk_mul_f32 v[92:93], v[28:29], v[188:189]
    v_pk_mul_f32 v[94:95], v[30:31], v[190:191]
    v_cvt_pk_bf16_f32 v148, v88, v89
    v_cvt_pk_bf16_f32 v149, v90, v91
    v_cvt_pk_bf16_f32 v150, v92, v93
    v_cvt_pk_bf16_f32 v151, v94, v95
    buffer_store_dwordx4 v[148:151], v2, s[36:39], s79 offen offset:2048 sc1
    v_lshlrev_b32 v216, 16, v156
    v_and_b32 v217, 0xffff0000, v156
    v_lshlrev_b32 v218, 16, v157
    v_and_b32 v219, 0xffff0000, v157
    v_lshlrev_b32 v220, 16, v158
    v_and_b32 v221, 0xffff0000, v158
    v_lshlrev_b32 v222, 16, v159
    v_and_b32 v223, 0xffff0000, v159
    v_pk_fma_f32 v[40:41], v[40:41], v[168:169], v[216:217]
    v_pk_fma_f32 v[42:43], v[42:43], v[170:171], v[218:219]
    v_pk_fma_f32 v[44:45], v[44:45], v[172:173], v[220:221]
    v_pk_fma_f32 v[46:47], v[46:47], v[174:175], v[222:223]
    v_pk_mul_f32 v[104:105], v[40:41], v[184:185]
    v_pk_mul_f32 v[106:107], v[42:43], v[186:187]
    v_pk_mul_f32 v[108:109], v[44:45], v[188:189]
    v_pk_mul_f32 v[110:111], v[46:47], v[190:191]
    v_cvt_pk_bf16_f32 v156, v104, v105
    v_cvt_pk_bf16_f32 v157, v106, v107
    v_cvt_pk_bf16_f32 v158, v108, v109
    v_cvt_pk_bf16_f32 v159, v110, v111
    buffer_store_dwordx4 v[156:159], v2, s[36:39], s79 offen offset:3072 sc1
    v_pk_mul_f32 v[8:9], v[16:17], v[16:17]
    v_pk_mul_f32 v[10:11], v[32:33], v[32:33]
    v_pk_add_f32 v[4:5], v[16:17], v[18:19]
    v_pk_fma_f32 v[8:9], v[18:19], v[18:19], v[8:9]
    v_pk_add_f32 v[6:7], v[32:33], v[34:35]
    v_pk_fma_f32 v[10:11], v[34:35], v[34:35], v[10:11]
    v_pk_add_f32 v[4:5], v[4:5], v[20:21]
    v_pk_fma_f32 v[8:9], v[20:21], v[20:21], v[8:9]
    v_pk_add_f32 v[6:7], v[6:7], v[36:37]
    v_pk_fma_f32 v[10:11], v[36:37], v[36:37], v[10:11]
    v_pk_add_f32 v[4:5], v[4:5], v[22:23]
    v_pk_fma_f32 v[8:9], v[22:23], v[22:23], v[8:9]
    v_pk_add_f32 v[6:7], v[6:7], v[38:39]
    v_pk_fma_f32 v[10:11], v[38:39], v[38:39], v[10:11]
    v_pk_add_f32 v[4:5], v[4:5], v[24:25]
    v_pk_fma_f32 v[8:9], v[24:25], v[24:25], v[8:9]
    v_pk_add_f32 v[6:7], v[6:7], v[40:41]
    v_pk_fma_f32 v[10:11], v[40:41], v[40:41], v[10:11]
    v_pk_add_f32 v[4:5], v[4:5], v[26:27]
    v_pk_fma_f32 v[8:9], v[26:27], v[26:27], v[8:9]
    v_pk_add_f32 v[6:7], v[6:7], v[42:43]
    v_pk_fma_f32 v[10:11], v[42:43], v[42:43], v[10:11]
    v_pk_add_f32 v[4:5], v[4:5], v[28:29]
    v_pk_fma_f32 v[8:9], v[28:29], v[28:29], v[8:9]
    v_pk_add_f32 v[6:7], v[6:7], v[44:45]
    v_pk_fma_f32 v[10:11], v[44:45], v[44:45], v[10:11]
    v_pk_add_f32 v[4:5], v[4:5], v[30:31]
    v_pk_fma_f32 v[8:9], v[30:31], v[30:31], v[8:9]
    v_pk_add_f32 v[6:7], v[6:7], v[46:47]
    v_pk_fma_f32 v[10:11], v[46:47], v[46:47], v[10:11]
    v_add_f32 v4, v4, v5
    v_add_f32 v6, v6, v7
    v_add_f32 v5, v8, v9
    v_add_f32 v7, v10, v11
    v_mov_b32 v8, v4
    v_mov_b32 v9, v5
    v_mov_b32 v10, v6
    v_mov_b32 v11, v7
    s_nop 0
    v_permlane16_swap_b32 v8, v4
    v_permlane16_swap_b32 v9, v5
    v_permlane16_swap_b32 v10, v6
    v_permlane16_swap_b32 v11, v7
    s_nop 0
    v_add_f32 v4, v4, v8
    v_add_f32 v5, v5, v9
    v_add_f32 v6, v6, v10
    v_add_f32 v7, v7, v11
    v_mov_b32 v8, v4
    v_mov_b32 v9, v5
    v_mov_b32 v10, v6
    v_mov_b32 v11, v7
    s_nop 0
    v_permlane32_swap_b32 v8, v4
    v_permlane32_swap_b32 v9, v5
    v_permlane32_swap_b32 v10, v6
    v_permlane32_swap_b32 v11, v7
    s_nop 0
    v_add_f32 v4, v4, v8
    v_add_f32 v5, v5, v9
    v_add_f32 v6, v6, v10
    v_add_f32 v7, v7, v11
    v_cvt_pk_bf16_f32 v236, v16, v17
    v_cvt_pk_bf16_f32 v237, v18, v19
    v_cvt_pk_bf16_f32 v238, v20, v21
    v_cvt_pk_bf16_f32 v239, v22, v23
    v_cvt_pk_bf16_f32 v240, v24, v25
    v_cvt_pk_bf16_f32 v241, v26, v27
    v_cvt_pk_bf16_f32 v242, v28, v29
    v_cvt_pk_bf16_f32 v243, v30, v31
    v_cvt_pk_bf16_f32 v244, v32, v33
    v_cvt_pk_bf16_f32 v245, v34, v35
    v_cvt_pk_bf16_f32 v246, v36, v37
    v_cvt_pk_bf16_f32 v247, v38, v39
    v_cvt_pk_bf16_f32 v248, v40, v41
    v_cvt_pk_bf16_f32 v249, v42, v43
    v_cvt_pk_bf16_f32 v250, v44, v45
    v_cvt_pk_bf16_f32 v251, v46, v47
    s_lshl_b32 s54, s35, 14
    s_lshl_b32 s53, s78, 8
    s_add_u32 s54, s54, s53
    s_add_u32 s54, s54, 0xc0000
    v_lshlrev_b32 v8, 3, v1
    s_mov_b32 exec_lo, 0xffff0000
    v_mov_b32 v4, v6
    v_mov_b32 v5, v7
    s_mov_b32 exec_lo, -1
    v_and_b32 v5, -2, v5
    s_lshl_b32 s52, s34, 2
    s_add_u32 s52, s52, s3
    s_lshl_b32 s52, s52, 7
    s_add_u32 s52, s52, 0x144000
    v_mov_b32 v9, 1
    s_waitcnt vmcnt(0)
    s_mov_b64 exec, 1
    buffer_atomic_add v9, v2, s[36:39], s52 offen sc1
    s_mov_b64 exec, -1
    s_mov_b32 exec_hi, 0
    buffer_store_dwordx2 v[4:5], v8, s[36:39], s54 offen sc1
    s_mov_b64 exec, -1
    s_bfe_u32 s34, s2, 0x10002
    s_lshl_b32 s34, s34, 3
    s_bfe_u32 s52, s2, 0x30003
    s_add_u32 s34, s34, s52
    s_and_b32 s35, s2, 3
    s_lshl_b32 s35, s35, 2
    s_lshr_b32 s52, s2, 6
    s_add_u32 s35, s35, s52
    s_mov_b32 s44, s20
    s_mov_b32 s45, s21
    s_mov_b32 s46, 0x1000
    s_mov_b32 s47, 0x00020000
    s_lshl_b32 s52, s34, 1
    s_and_b32 s53, s3, 1
    s_add_u32 s52, s52, s53
    s_lshl_b32 s52, s52, 7
    v_lshlrev_b32 v6, 1, v3
    buffer_load_ushort v204, v6, s[44:47], s52 offen offset:0
    buffer_load_ushort v205, v6, s[44:47], s52 offen offset:32
    buffer_load_ushort v206, v6, s[44:47], s52 offen offset:64
    buffer_load_ushort v207, v6, s[44:47], s52 offen offset:96
    s_lshr_b32 s52, s35, 1
    s_lshl_b32 s53, s52, 2
    s_mul_i32 s54, s52, 3
    s_add_u32 s54, s54, 32
    s_and_b32 s63, s35, 1
    s_cmp_eq_u32 s63, 0
    s_cselect_b32 s62, 4, 3
    s_cselect_b32 s60, s53, s54
    s_cselect_b32 s61, s54, s53
    s_sub_u32 s61, s61, s62
    s_lshl_b32 s78, s34, 2
    s_add_u32 s78, s78, s3
    s_lshl_b32 s52, s78, 16
    s_add_u32 s52, s52, 0xa00000
    s_add_u32 s40, s32, s52
    s_addc_u32 s41, s33, 0
    s_mov_b32 s42, 0x10000
    s_mov_b32 s43, 0x00020000
    s_mov_b32 s72, 0
    s_mov_b32 s73, 5
    s_mov_b32 s74, 0
    v_lshrrev_b32 v6, 2, v1
    v_mul_u32_u24 v6, 448, v6
    v_and_b32 v7, 3, v1
    v_lshl_add_u32 v6, v7, 3, v6
    v_bfe_u32 v7, v1, 4, 1
    v_lshl_add_u32 v6, v7, 5, v6
    v_xor_b32 v7, 32, v6
    v_mov_b32 v4, v6
    v_mov_b32 v5, v7
    v_and_b32 v3, 15, v1
    v_lshrrev_b32 v8, 4, v1
    v_lshlrev_b32 v8, 16, v8
    v_lshl_add_u32 v8, v3, 3, v8
    v_pk_mov_b32 v[16:17], 0, 0
    v_pk_mov_b32 v[18:19], 0, 0
    v_pk_mov_b32 v[20:21], 0, 0
    v_pk_mov_b32 v[22:23], 0, 0
    v_pk_mov_b32 v[24:25], 0, 0
    v_pk_mov_b32 v[26:27], 0, 0
    v_pk_mov_b32 v[28:29], 0, 0
    v_pk_mov_b32 v[30:31], 0, 0
    v_pk_mov_b32 v[32:33], 0, 0
    v_pk_mov_b32 v[34:35], 0, 0
    v_pk_mov_b32 v[36:37], 0, 0
    v_pk_mov_b32 v[38:39], 0, 0
    v_pk_mov_b32 v[40:41], 0, 0
    v_pk_mov_b32 v[42:43], 0, 0
    v_pk_mov_b32 v[44:45], 0, 0
    v_pk_mov_b32 v[46:47], 0, 0
    v_pk_mov_b32 v[48:49], 0, 0
    v_pk_mov_b32 v[50:51], 0, 0
    v_pk_mov_b32 v[52:53], 0, 0
    v_pk_mov_b32 v[54:55], 0, 0
    v_pk_mov_b32 v[56:57], 0, 0
    v_pk_mov_b32 v[58:59], 0, 0
    v_pk_mov_b32 v[60:61], 0, 0
    v_pk_mov_b32 v[62:63], 0, 0
    v_pk_mov_b32 v[64:65], 0, 0
    v_pk_mov_b32 v[66:67], 0, 0
    v_pk_mov_b32 v[68:69], 0, 0
    v_pk_mov_b32 v[70:71], 0, 0
    v_pk_mov_b32 v[72:73], 0, 0
    v_pk_mov_b32 v[74:75], 0, 0
    v_pk_mov_b32 v[76:77], 0, 0
    v_pk_mov_b32 v[78:79], 0, 0
    v_pk_mov_b32 v[80:81], 0, 0
    v_pk_mov_b32 v[82:83], 0, 0
    v_pk_mov_b32 v[84:85], 0, 0
    v_pk_mov_b32 v[86:87], 0, 0
    v_pk_mov_b32 v[88:89], 0, 0
    v_pk_mov_b32 v[90:91], 0, 0
    v_pk_mov_b32 v[92:93], 0, 0
    v_pk_mov_b32 v[94:95], 0, 0
    v_pk_mov_b32 v[96:97], 0, 0
    v_pk_mov_b32 v[98:99], 0, 0
    v_pk_mov_b32 v[100:101], 0, 0
    v_pk_mov_b32 v[102:103], 0, 0
    v_pk_mov_b32 v[104:105], 0, 0
    v_pk_mov_b32 v[106:107], 0, 0
    v_pk_mov_b32 v[108:109], 0, 0
    v_pk_mov_b32 v[110:111], 0, 0
    v_pk_mov_b32 v[112:113], 0, 0
    v_pk_mov_b32 v[114:115], 0, 0
    v_pk_mov_b32 v[116:117], 0, 0
    v_pk_mov_b32 v[118:119], 0, 0
    v_pk_mov_b32 v[120:121], 0, 0
    v_pk_mov_b32 v[122:123], 0, 0
    v_pk_mov_b32 v[124:125], 0, 0
    v_pk_mov_b32 v[126:127], 0, 0
    s_barrier
    s_lshl_b32 s52, s34, 2
    s_add_u32 s52, s52, s3
    s_lshl_b32 s52, s52, 7
    s_add_u32 s52, s52, 0x144000
    s_mov_b64 exec, 1
    s_mov_b32 s53, 0x8000
L_mainc_px:
    v_mov_b32 v9, 0
    buffer_atomic_add v9, v2, s[36:39], s52 offen sc0 sc1
    s_waitcnt vmcnt(0)
L_mainc_pxc:
    v_cmp_ne_u32 vcc, 15, v9
    s_sub_u32 s53, s53, 1
    s_cbranch_scc1 L_mainc_pxx
    s_cbranch_vccnz L_mainc_px
L_mainc_pxx:
    s_mov_b64 exec, -1
    buffer_load_dwordx4 v[156:159], v2, s[40:43], s72 offen offset:0 sc1
    buffer_load_dwordx4 v[160:163], v2, s[40:43], s72 offen offset:1024 sc1
    buffer_load_dwordx4 v[164:167], v2, s[40:43], s72 offen offset:2048 sc1
    buffer_load_dwordx4 v[168:171], v2, s[40:43], s72 offen offset:3072 sc1
    s_add_u32 s72, s72, 4096
    s_and_b32 s72, s72, 0xffff
    ds_read_b64_tr_b16 v[128:129], v4 offset:0
    ds_read_b64_tr_b16 v[130:131], v4 offset:7168
    ds_read_b64_tr_b16 v[132:133], v5 offset:0
    ds_read_b64_tr_b16 v[134:135], v5 offset:7168
    ds_read_b64_tr_b16 v[136:137], v4 offset:64
    ds_read_b64_tr_b16 v[138:139], v4 offset:7232
    ds_read_b64_tr_b16 v[140:141], v5 offset:64
    ds_read_b64_tr_b16 v[142:143], v5 offset:7232
    ds_read_b64_tr_b16 v[144:145], v4 offset:128
    ds_read_b64_tr_b16 v[146:147], v4 offset:7296
    ds_read_b64_tr_b16 v[148:149], v5 offset:128
    ds_read_b64_tr_b16 v[150:151], v5 offset:7296
    buffer_load_dwordx4 v[172:175], v2, s[40:43], s72 offen offset:0 sc1
    buffer_load_dwordx4 v[176:179], v2, s[40:43], s72 offen offset:1024 sc1
    buffer_load_dwordx4 v[180:183], v2, s[40:43], s72 offen offset:2048 sc1
    buffer_load_dwordx4 v[184:187], v2, s[40:43], s72 offen offset:3072 sc1
    s_add_u32 s72, s72, 4096
    s_and_b32 s72, s72, 0xffff
L_mainc_wl:
    s_waitcnt vmcnt(6) lgkmcnt(8)
    v_mfma_f32_16x16x32_bf16 v[16:19], v[128:131], v[156:159], v[16:19]
    ds_read_b64_tr_b16 v[152:153], v4 offset:192
    v_mfma_f32_16x16x32_bf16 v[20:23], v[128:131], v[160:163], v[20:23]
    ds_read_b64_tr_b16 v[154:155], v4 offset:7360
    v_mfma_f32_16x16x32_bf16 v[24:27], v[132:135], v[156:159], v[24:27]
    ds_read_b64_tr_b16 v[128:129], v5 offset:192
    v_mfma_f32_16x16x32_bf16 v[28:31], v[132:135], v[160:163], v[28:31]
    ds_read_b64_tr_b16 v[130:131], v5 offset:7360
    s_waitcnt lgkmcnt(8)
    v_mfma_f32_16x16x32_bf16 v[32:35], v[136:139], v[156:159], v[32:35]
    buffer_load_dwordx4 v[188:191], v2, s[40:43], s72 offen offset:0 sc1
    ds_read_b64_tr_b16 v[132:133], v4 offset:256
    v_mfma_f32_16x16x32_bf16 v[36:39], v[136:139], v[160:163], v[36:39]
    ds_read_b64_tr_b16 v[134:135], v4 offset:7424
    v_mfma_f32_16x16x32_bf16 v[40:43], v[140:143], v[156:159], v[40:43]
    ds_read_b64_tr_b16 v[136:137], v5 offset:256
    v_mfma_f32_16x16x32_bf16 v[44:47], v[140:143], v[160:163], v[44:47]
    ds_read_b64_tr_b16 v[138:139], v5 offset:7424
    s_waitcnt lgkmcnt(8)
    v_mfma_f32_16x16x32_bf16 v[48:51], v[144:147], v[156:159], v[48:51]
    s_add_u32 s74, s74, 28672
    ds_read_b64_tr_b16 v[140:141], v4 offset:320
    v_mfma_f32_16x16x32_bf16 v[52:55], v[144:147], v[160:163], v[52:55]
    ds_read_b64_tr_b16 v[142:143], v4 offset:7488
    v_mfma_f32_16x16x32_bf16 v[56:59], v[148:151], v[156:159], v[56:59]
    s_cmp_ge_u32 s74, 143360
    ds_read_b64_tr_b16 v[144:145], v5 offset:320
    v_mfma_f32_16x16x32_bf16 v[60:63], v[148:151], v[160:163], v[60:63]
    ds_read_b64_tr_b16 v[146:147], v5 offset:7488
    s_waitcnt lgkmcnt(8)
    v_mfma_f32_16x16x32_bf16 v[64:67], v[152:155], v[156:159], v[64:67]
    s_cselect_b32 s74, 0, s74
    ds_read_b64_tr_b16 v[148:149], v4 offset:384
    v_mfma_f32_16x16x32_bf16 v[68:71], v[152:155], v[160:163], v[68:71]
    ds_read_b64_tr_b16 v[150:151], v4 offset:7552
    v_mfma_f32_16x16x32_bf16 v[72:75], v[128:131], v[156:159], v[72:75]
    ds_read_b64_tr_b16 v[152:153], v5 offset:384
    v_mfma_f32_16x16x32_bf16 v[76:79], v[128:131], v[160:163], v[76:79]
    ds_read_b64_tr_b16 v[154:155], v5 offset:7552
    s_waitcnt lgkmcnt(8)
    v_mfma_f32_16x16x32_bf16 v[80:83], v[132:135], v[156:159], v[80:83]
    buffer_load_dwordx4 v[192:195], v2, s[40:43], s72 offen offset:1024 sc1
    ds_read_b64_tr_b16 v[128:129], v4 offset:14336
    v_mfma_f32_16x16x32_bf16 v[84:87], v[132:135], v[160:163], v[84:87]
    ds_read_b64_tr_b16 v[130:131], v4 offset:21504
    v_mfma_f32_16x16x32_bf16 v[88:91], v[136:139], v[156:159], v[88:91]
    ds_read_b64_tr_b16 v[132:133], v5 offset:14336
    v_mfma_f32_16x16x32_bf16 v[92:95], v[136:139], v[160:163], v[92:95]
    ds_read_b64_tr_b16 v[134:135], v5 offset:21504
    s_waitcnt lgkmcnt(8)
    v_mfma_f32_16x16x32_bf16 v[96:99], v[140:143], v[156:159], v[96:99]
    ds_read_b64_tr_b16 v[136:137], v4 offset:14400
    v_mfma_f32_16x16x32_bf16 v[100:103], v[140:143], v[160:163], v[100:103]
    ds_read_b64_tr_b16 v[138:139], v4 offset:21568
    v_mfma_f32_16x16x32_bf16 v[104:107], v[144:147], v[156:159], v[104:107]
    ds_read_b64_tr_b16 v[140:141], v5 offset:14400
    v_mfma_f32_16x16x32_bf16 v[108:111], v[144:147], v[160:163], v[108:111]
    ds_read_b64_tr_b16 v[142:143], v5 offset:21568
    s_waitcnt lgkmcnt(8)
    v_mfma_f32_16x16x32_bf16 v[112:115], v[148:151], v[156:159], v[112:115]
    ds_read_b64_tr_b16 v[144:145], v4 offset:14464
    v_mfma_f32_16x16x32_bf16 v[116:119], v[148:151], v[160:163], v[116:119]
    ds_read_b64_tr_b16 v[146:147], v4 offset:21632
    v_mfma_f32_16x16x32_bf16 v[120:123], v[152:155], v[156:159], v[120:123]
    ds_read_b64_tr_b16 v[148:149], v5 offset:14464
    v_mfma_f32_16x16x32_bf16 v[124:127], v[152:155], v[160:163], v[124:127]
    ds_read_b64_tr_b16 v[150:151], v5 offset:21632
    s_waitcnt vmcnt(6) lgkmcnt(8)
    v_mfma_f32_16x16x32_bf16 v[16:19], v[128:131], v[164:167], v[16:19]
    buffer_load_dwordx4 v[196:199], v2, s[40:43], s72 offen offset:2048 sc1
    ds_read_b64_tr_b16 v[152:153], v4 offset:14528
    v_mfma_f32_16x16x32_bf16 v[20:23], v[128:131], v[168:171], v[20:23]
    ds_read_b64_tr_b16 v[154:155], v4 offset:21696
    v_mfma_f32_16x16x32_bf16 v[24:27], v[132:135], v[164:167], v[24:27]
    ds_read_b64_tr_b16 v[128:129], v5 offset:14528
    v_mfma_f32_16x16x32_bf16 v[28:31], v[132:135], v[168:171], v[28:31]
    ds_read_b64_tr_b16 v[130:131], v5 offset:21696
    s_waitcnt lgkmcnt(8)
    v_mfma_f32_16x16x32_bf16 v[32:35], v[136:139], v[164:167], v[32:35]
    ds_read_b64_tr_b16 v[132:133], v4 offset:14592
    v_mfma_f32_16x16x32_bf16 v[36:39], v[136:139], v[168:171], v[36:39]
    ds_read_b64_tr_b16 v[134:135], v4 offset:21760
    v_mfma_f32_16x16x32_bf16 v[40:43], v[140:143], v[164:167], v[40:43]
    ds_read_b64_tr_b16 v[136:137], v5 offset:14592
    v_mfma_f32_16x16x32_bf16 v[44:47], v[140:143], v[168:171], v[44:47]
    ds_read_b64_tr_b16 v[138:139], v5 offset:21760
    s_waitcnt lgkmcnt(8)
    v_mfma_f32_16x16x32_bf16 v[48:51], v[144:147], v[164:167], v[48:51]
    ds_read_b64_tr_b16 v[140:141], v4 offset:14656
    v_mfma_f32_16x16x32_bf16 v[52:55], v[144:147], v[168:171], v[52:55]
    ds_read_b64_tr_b16 v[142:143], v4 offset:21824
    v_mfma_f32_16x16x32_bf16 v[56:59], v[148:151], v[164:167], v[56:59]
    ds_read_b64_tr_b16 v[144:145], v5 offset:14656
    v_mfma_f32_16x16x32_bf16 v[60:63], v[148:151], v[168:171], v[60:63]
    ds_read_b64_tr_b16 v[146:147], v5 offset:21824
    s_waitcnt lgkmcnt(8)
    v_mfma_f32_16x16x32_bf16 v[64:67], v[152:155], v[164:167], v[64:67]
    buffer_load_dwordx4 v[200:203], v2, s[40:43], s72 offen offset:3072 sc1
    ds_read_b64_tr_b16 v[148:149], v4 offset:14720
    v_mfma_f32_16x16x32_bf16 v[68:71], v[152:155], v[168:171], v[68:71]
    ds_read_b64_tr_b16 v[150:151], v4 offset:21888
    v_mfma_f32_16x16x32_bf16 v[72:75], v[128:131], v[164:167], v[72:75]
    v_add_u32 v4, s74, v6
    ds_read_b64_tr_b16 v[152:153], v5 offset:14720
    v_mfma_f32_16x16x32_bf16 v[76:79], v[128:131], v[168:171], v[76:79]
    ds_read_b64_tr_b16 v[154:155], v5 offset:21888
    s_waitcnt lgkmcnt(8)
    v_mfma_f32_16x16x32_bf16 v[80:83], v[132:135], v[164:167], v[80:83]
    s_barrier
    ds_read_b64_tr_b16 v[128:129], v4 offset:0
    v_mfma_f32_16x16x32_bf16 v[84:87], v[132:135], v[168:171], v[84:87]
    ds_read_b64_tr_b16 v[130:131], v4 offset:7168
    v_mfma_f32_16x16x32_bf16 v[88:91], v[136:139], v[164:167], v[88:91]
    v_add_u32 v5, s74, v7
    ds_read_b64_tr_b16 v[132:133], v5 offset:0
    v_mfma_f32_16x16x32_bf16 v[92:95], v[136:139], v[168:171], v[92:95]
    ds_read_b64_tr_b16 v[134:135], v5 offset:7168
    s_waitcnt lgkmcnt(8)
    v_mfma_f32_16x16x32_bf16 v[96:99], v[140:143], v[164:167], v[96:99]
    s_add_u32 s72, s72, 4096
    ds_read_b64_tr_b16 v[136:137], v4 offset:64
    v_mfma_f32_16x16x32_bf16 v[100:103], v[140:143], v[168:171], v[100:103]
    ds_read_b64_tr_b16 v[138:139], v4 offset:7232
    v_mfma_f32_16x16x32_bf16 v[104:107], v[144:147], v[164:167], v[104:107]
    s_and_b32 s72, s72, 0xffff
    ds_read_b64_tr_b16 v[140:141], v5 offset:64
    v_mfma_f32_16x16x32_bf16 v[108:111], v[144:147], v[168:171], v[108:111]
    ds_read_b64_tr_b16 v[142:143], v5 offset:7232
    s_waitcnt lgkmcnt(8)
    v_mfma_f32_16x16x32_bf16 v[112:115], v[148:151], v[164:167], v[112:115]
    ds_read_b64_tr_b16 v[144:145], v4 offset:128
    v_mfma_f32_16x16x32_bf16 v[116:119], v[148:151], v[168:171], v[116:119]
    ds_read_b64_tr_b16 v[146:147], v4 offset:7296
    v_mfma_f32_16x16x32_bf16 v[120:123], v[152:155], v[164:167], v[120:123]
    ds_read_b64_tr_b16 v[148:149], v5 offset:128
    v_mfma_f32_16x16x32_bf16 v[124:127], v[152:155], v[168:171], v[124:127]
    ds_read_b64_tr_b16 v[150:151], v5 offset:7296
    s_waitcnt vmcnt(6) lgkmcnt(8)
    v_mfma_f32_16x16x32_bf16 v[16:19], v[128:131], v[172:175], v[16:19]
    ds_read_b64_tr_b16 v[152:153], v4 offset:192
    v_mfma_f32_16x16x32_bf16 v[20:23], v[128:131], v[176:179], v[20:23]
    ds_read_b64_tr_b16 v[154:155], v4 offset:7360
    v_mfma_f32_16x16x32_bf16 v[24:27], v[132:135], v[172:175], v[24:27]
    ds_read_b64_tr_b16 v[128:129], v5 offset:192
    v_mfma_f32_16x16x32_bf16 v[28:31], v[132:135], v[176:179], v[28:31]
    ds_read_b64_tr_b16 v[130:131], v5 offset:7360
    s_waitcnt lgkmcnt(8)
    v_mfma_f32_16x16x32_bf16 v[32:35], v[136:139], v[172:175], v[32:35]
    buffer_load_dwordx4 v[156:159], v2, s[40:43], s72 offen offset:0 sc1
    ds_read_b64_tr_b16 v[132:133], v4 offset:256
    v_mfma_f32_16x16x32_bf16 v[36:39], v[136:139], v[176:179], v[36:39]
    ds_read_b64_tr_b16 v[134:135], v4 offset:7424
    v_mfma_f32_16x16x32_bf16 v[40:43], v[140:143], v[172:175], v[40:43]
    ds_read_b64_tr_b16 v[136:137], v5 offset:256
    v_mfma_f32_16x16x32_bf16 v[44:47], v[140:143], v[176:179], v[44:47]
    ds_read_b64_tr_b16 v[138:139], v5 offset:7424
    s_waitcnt lgkmcnt(8)
    v_mfma_f32_16x16x32_bf16 v[48:51], v[144:147], v[172:175], v[48:51]
    s_add_u32 s74, s74, 28672
    ds_read_b64_tr_b16 v[140:141], v4 offset:320
    v_mfma_f32_16x16x32_bf16 v[52:55], v[144:147], v[176:179], v[52:55]
    ds_read_b64_tr_b16 v[142:143], v4 offset:7488
    v_mfma_f32_16x16x32_bf16 v[56:59], v[148:151], v[172:175], v[56:59]
    s_cmp_ge_u32 s74, 143360
    ds_read_b64_tr_b16 v[144:145], v5 offset:320
    v_mfma_f32_16x16x32_bf16 v[60:63], v[148:151], v[176:179], v[60:63]
    ds_read_b64_tr_b16 v[146:147], v5 offset:7488
    s_waitcnt lgkmcnt(8)
    v_mfma_f32_16x16x32_bf16 v[64:67], v[152:155], v[172:175], v[64:67]
    s_cselect_b32 s74, 0, s74
    ds_read_b64_tr_b16 v[148:149], v4 offset:384
    v_mfma_f32_16x16x32_bf16 v[68:71], v[152:155], v[176:179], v[68:71]
    ds_read_b64_tr_b16 v[150:151], v4 offset:7552
    v_mfma_f32_16x16x32_bf16 v[72:75], v[128:131], v[172:175], v[72:75]
    ds_read_b64_tr_b16 v[152:153], v5 offset:384
    v_mfma_f32_16x16x32_bf16 v[76:79], v[128:131], v[176:179], v[76:79]
    ds_read_b64_tr_b16 v[154:155], v5 offset:7552
    s_waitcnt lgkmcnt(8)
    v_mfma_f32_16x16x32_bf16 v[80:83], v[132:135], v[172:175], v[80:83]
    buffer_load_dwordx4 v[160:163], v2, s[40:43], s72 offen offset:1024 sc1
    ds_read_b64_tr_b16 v[128:129], v4 offset:14336
    v_mfma_f32_16x16x32_bf16 v[84:87], v[132:135], v[176:179], v[84:87]
    ds_read_b64_tr_b16 v[130:131], v4 offset:21504
    v_mfma_f32_16x16x32_bf16 v[88:91], v[136:139], v[172:175], v[88:91]
    ds_read_b64_tr_b16 v[132:133], v5 offset:14336
    v_mfma_f32_16x16x32_bf16 v[92:95], v[136:139], v[176:179], v[92:95]
    ds_read_b64_tr_b16 v[134:135], v5 offset:21504
    s_waitcnt lgkmcnt(8)
    v_mfma_f32_16x16x32_bf16 v[96:99], v[140:143], v[172:175], v[96:99]
    ds_read_b64_tr_b16 v[136:137], v4 offset:14400
    v_mfma_f32_16x16x32_bf16 v[100:103], v[140:143], v[176:179], v[100:103]
    ds_read_b64_tr_b16 v[138:139], v4 offset:21568
    v_mfma_f32_16x16x32_bf16 v[104:107], v[144:147], v[172:175], v[104:107]
    ds_read_b64_tr_b16 v[140:141], v5 offset:14400
    v_mfma_f32_16x16x32_bf16 v[108:111], v[144:147], v[176:179], v[108:111]
    ds_read_b64_tr_b16 v[142:143], v5 offset:21568
    s_waitcnt lgkmcnt(8)
    v_mfma_f32_16x16x32_bf16 v[112:115], v[148:151], v[172:175], v[112:115]
    ds_read_b64_tr_b16 v[144:145], v4 offset:14464
    v_mfma_f32_16x16x32_bf16 v[116:119], v[148:151], v[176:179], v[116:119]
    ds_read_b64_tr_b16 v[146:147], v4 offset:21632
    v_mfma_f32_16x16x32_bf16 v[120:123], v[152:155], v[172:175], v[120:123]
    ds_read_b64_tr_b16 v[148:149], v5 offset:14464
    v_mfma_f32_16x16x32_bf16 v[124:127], v[152:155], v[176:179], v[124:127]
    ds_read_b64_tr_b16 v[150:151], v5 offset:21632
    s_waitcnt vmcnt(6) lgkmcnt(8)
    v_mfma_f32_16x16x32_bf16 v[16:19], v[128:131], v[180:183], v[16:19]
    buffer_load_dwordx4 v[164:167], v2, s[40:43], s72 offen offset:2048 sc1
    ds_read_b64_tr_b16 v[152:153], v4 offset:14528
    v_mfma_f32_16x16x32_bf16 v[20:23], v[128:131], v[184:187], v[20:23]
    ds_read_b64_tr_b16 v[154:155], v4 offset:21696
    v_mfma_f32_16x16x32_bf16 v[24:27], v[132:135], v[180:183], v[24:27]
    ds_read_b64_tr_b16 v[128:129], v5 offset:14528
    v_mfma_f32_16x16x32_bf16 v[28:31], v[132:135], v[184:187], v[28:31]
    ds_read_b64_tr_b16 v[130:131], v5 offset:21696
    s_waitcnt lgkmcnt(8)
    v_mfma_f32_16x16x32_bf16 v[32:35], v[136:139], v[180:183], v[32:35]
    ds_read_b64_tr_b16 v[132:133], v4 offset:14592
    v_mfma_f32_16x16x32_bf16 v[36:39], v[136:139], v[184:187], v[36:39]
    ds_read_b64_tr_b16 v[134:135], v4 offset:21760
    v_mfma_f32_16x16x32_bf16 v[40:43], v[140:143], v[180:183], v[40:43]
    ds_read_b64_tr_b16 v[136:137], v5 offset:14592
    v_mfma_f32_16x16x32_bf16 v[44:47], v[140:143], v[184:187], v[44:47]
    ds_read_b64_tr_b16 v[138:139], v5 offset:21760
    s_waitcnt lgkmcnt(8)
    v_mfma_f32_16x16x32_bf16 v[48:51], v[144:147], v[180:183], v[48:51]
    ds_read_b64_tr_b16 v[140:141], v4 offset:14656
    v_mfma_f32_16x16x32_bf16 v[52:55], v[144:147], v[184:187], v[52:55]
    ds_read_b64_tr_b16 v[142:143], v4 offset:21824
    v_mfma_f32_16x16x32_bf16 v[56:59], v[148:151], v[180:183], v[56:59]
    ds_read_b64_tr_b16 v[144:145], v5 offset:14656
    v_mfma_f32_16x16x32_bf16 v[60:63], v[148:151], v[184:187], v[60:63]
    ds_read_b64_tr_b16 v[146:147], v5 offset:21824
    s_waitcnt lgkmcnt(8)
    v_mfma_f32_16x16x32_bf16 v[64:67], v[152:155], v[180:183], v[64:67]
    buffer_load_dwordx4 v[168:171], v2, s[40:43], s72 offen offset:3072 sc1
    ds_read_b64_tr_b16 v[148:149], v4 offset:14720
    v_mfma_f32_16x16x32_bf16 v[68:71], v[152:155], v[184:187], v[68:71]
    ds_read_b64_tr_b16 v[150:151], v4 offset:21888
    v_mfma_f32_16x16x32_bf16 v[72:75], v[128:131], v[180:183], v[72:75]
    v_add_u32 v4, s74, v6
    ds_read_b64_tr_b16 v[152:153], v5 offset:14720
    v_mfma_f32_16x16x32_bf16 v[76:79], v[128:131], v[184:187], v[76:79]
    ds_read_b64_tr_b16 v[154:155], v5 offset:21888
    s_waitcnt lgkmcnt(8)
    v_mfma_f32_16x16x32_bf16 v[80:83], v[132:135], v[180:183], v[80:83]
    s_barrier
    ds_read_b64_tr_b16 v[128:129], v4 offset:0
    v_mfma_f32_16x16x32_bf16 v[84:87], v[132:135], v[184:187], v[84:87]
    ds_read_b64_tr_b16 v[130:131], v4 offset:7168
    v_mfma_f32_16x16x32_bf16 v[88:91], v[136:139], v[180:183], v[88:91]
    v_add_u32 v5, s74, v7
    ds_read_b64_tr_b16 v[132:133], v5 offset:0
    v_mfma_f32_16x16x32_bf16 v[92:95], v[136:139], v[184:187], v[92:95]
    ds_read_b64_tr_b16 v[134:135], v5 offset:7168
    s_waitcnt lgkmcnt(8)
    v_mfma_f32_16x16x32_bf16 v[96:99], v[140:143], v[180:183], v[96:99]
    s_add_u32 s72, s72, 4096
    ds_read_b64_tr_b16 v[136:137], v4 offset:64
    v_mfma_f32_16x16x32_bf16 v[100:103], v[140:143], v[184:187], v[100:103]
    ds_read_b64_tr_b16 v[138:139], v4 offset:7232
    v_mfma_f32_16x16x32_bf16 v[104:107], v[144:147], v[180:183], v[104:107]
    s_and_b32 s72, s72, 0xffff
    ds_read_b64_tr_b16 v[140:141], v5 offset:64
    v_mfma_f32_16x16x32_bf16 v[108:111], v[144:147], v[184:187], v[108:111]
    ds_read_b64_tr_b16 v[142:143], v5 offset:7232
    s_waitcnt lgkmcnt(8)
    v_mfma_f32_16x16x32_bf16 v[112:115], v[148:151], v[180:183], v[112:115]
    ds_read_b64_tr_b16 v[144:145], v4 offset:128
    v_mfma_f32_16x16x32_bf16 v[116:119], v[148:151], v[184:187], v[116:119]
    ds_read_b64_tr_b16 v[146:147], v4 offset:7296
    v_mfma_f32_16x16x32_bf16 v[120:123], v[152:155], v[180:183], v[120:123]
    ds_read_b64_tr_b16 v[148:149], v5 offset:128
    v_mfma_f32_16x16x32_bf16 v[124:127], v[152:155], v[184:187], v[124:127]
    ds_read_b64_tr_b16 v[150:151], v5 offset:7296
    s_waitcnt vmcnt(6) lgkmcnt(8)
    v_mfma_f32_16x16x32_bf16 v[16:19], v[128:131], v[188:191], v[16:19]
    ds_read_b64_tr_b16 v[152:153], v4 offset:192
    v_mfma_f32_16x16x32_bf16 v[20:23], v[128:131], v[192:195], v[20:23]
    ds_read_b64_tr_b16 v[154:155], v4 offset:7360
    v_mfma_f32_16x16x32_bf16 v[24:27], v[132:135], v[188:191], v[24:27]
    ds_read_b64_tr_b16 v[128:129], v5 offset:192
    v_mfma_f32_16x16x32_bf16 v[28:31], v[132:135], v[192:195], v[28:31]
    ds_read_b64_tr_b16 v[130:131], v5 offset:7360
    s_waitcnt lgkmcnt(8)
    v_mfma_f32_16x16x32_bf16 v[32:35], v[136:139], v[188:191], v[32:35]
    buffer_load_dwordx4 v[172:175], v2, s[40:43], s72 offen offset:0 sc1
    ds_read_b64_tr_b16 v[132:133], v4 offset:256
    v_mfma_f32_16x16x32_bf16 v[36:39], v[136:139], v[192:195], v[36:39]
    ds_read_b64_tr_b16 v[134:135], v4 offset:7424
    v_mfma_f32_16x16x32_bf16 v[40:43], v[140:143], v[188:191], v[40:43]
    ds_read_b64_tr_b16 v[136:137], v5 offset:256
    v_mfma_f32_16x16x32_bf16 v[44:47], v[140:143], v[192:195], v[44:47]
    ds_read_b64_tr_b16 v[138:139], v5 offset:7424
    s_waitcnt lgkmcnt(8)
    v_mfma_f32_16x16x32_bf16 v[48:51], v[144:147], v[188:191], v[48:51]
    s_add_u32 s74, s74, 28672
    ds_read_b64_tr_b16 v[140:141], v4 offset:320
    v_mfma_f32_16x16x32_bf16 v[52:55], v[144:147], v[192:195], v[52:55]
    ds_read_b64_tr_b16 v[142:143], v4 offset:7488
    v_mfma_f32_16x16x32_bf16 v[56:59], v[148:151], v[188:191], v[56:59]
    s_cmp_ge_u32 s74, 143360
    ds_read_b64_tr_b16 v[144:145], v5 offset:320
    v_mfma_f32_16x16x32_bf16 v[60:63], v[148:151], v[192:195], v[60:63]
    ds_read_b64_tr_b16 v[146:147], v5 offset:7488
    s_waitcnt lgkmcnt(8)
    v_mfma_f32_16x16x32_bf16 v[64:67], v[152:155], v[188:191], v[64:67]
    s_cselect_b32 s74, 0, s74
    ds_read_b64_tr_b16 v[148:149], v4 offset:384
    v_mfma_f32_16x16x32_bf16 v[68:71], v[152:155], v[192:195], v[68:71]
    ds_read_b64_tr_b16 v[150:151], v4 offset:7552
    v_mfma_f32_16x16x32_bf16 v[72:75], v[128:131], v[188:191], v[72:75]
    ds_read_b64_tr_b16 v[152:153], v5 offset:384
    v_mfma_f32_16x16x32_bf16 v[76:79], v[128:131], v[192:195], v[76:79]
    ds_read_b64_tr_b16 v[154:155], v5 offset:7552
    s_waitcnt lgkmcnt(8)
    v_mfma_f32_16x16x32_bf16 v[80:83], v[132:135], v[188:191], v[80:83]
    buffer_load_dwordx4 v[176:179], v2, s[40:43], s72 offen offset:1024 sc1
    ds_read_b64_tr_b16 v[128:129], v4 offset:14336
    v_mfma_f32_16x16x32_bf16 v[84:87], v[132:135], v[192:195], v[84:87]
    ds_read_b64_tr_b16 v[130:131], v4 offset:21504
    v_mfma_f32_16x16x32_bf16 v[88:91], v[136:139], v[188:191], v[88:91]
    ds_read_b64_tr_b16 v[132:133], v5 offset:14336
    v_mfma_f32_16x16x32_bf16 v[92:95], v[136:139], v[192:195], v[92:95]
    ds_read_b64_tr_b16 v[134:135], v5 offset:21504
    s_waitcnt lgkmcnt(8)
    v_mfma_f32_16x16x32_bf16 v[96:99], v[140:143], v[188:191], v[96:99]
    ds_read_b64_tr_b16 v[136:137], v4 offset:14400
    v_mfma_f32_16x16x32_bf16 v[100:103], v[140:143], v[192:195], v[100:103]
    ds_read_b64_tr_b16 v[138:139], v4 offset:21568
    v_mfma_f32_16x16x32_bf16 v[104:107], v[144:147], v[188:191], v[104:107]
    ds_read_b64_tr_b16 v[140:141], v5 offset:14400
    v_mfma_f32_16x16x32_bf16 v[108:111], v[144:147], v[192:195], v[108:111]
    ds_read_b64_tr_b16 v[142:143], v5 offset:21568
    s_waitcnt lgkmcnt(8)
    v_mfma_f32_16x16x32_bf16 v[112:115], v[148:151], v[188:191], v[112:115]
    ds_read_b64_tr_b16 v[144:145], v4 offset:14464
    v_mfma_f32_16x16x32_bf16 v[116:119], v[148:151], v[192:195], v[116:119]
    ds_read_b64_tr_b16 v[146:147], v4 offset:21632
    v_mfma_f32_16x16x32_bf16 v[120:123], v[152:155], v[188:191], v[120:123]
    ds_read_b64_tr_b16 v[148:149], v5 offset:14464
    v_mfma_f32_16x16x32_bf16 v[124:127], v[152:155], v[192:195], v[124:127]
    ds_read_b64_tr_b16 v[150:151], v5 offset:21632
    s_waitcnt vmcnt(6) lgkmcnt(8)
    v_mfma_f32_16x16x32_bf16 v[16:19], v[128:131], v[196:199], v[16:19]
    buffer_load_dwordx4 v[180:183], v2, s[40:43], s72 offen offset:2048 sc1
    ds_read_b64_tr_b16 v[152:153], v4 offset:14528
    v_mfma_f32_16x16x32_bf16 v[20:23], v[128:131], v[200:203], v[20:23]
    ds_read_b64_tr_b16 v[154:155], v4 offset:21696
    v_mfma_f32_16x16x32_bf16 v[24:27], v[132:135], v[196:199], v[24:27]
    ds_read_b64_tr_b16 v[128:129], v5 offset:14528
    v_mfma_f32_16x16x32_bf16 v[28:31], v[132:135], v[200:203], v[28:31]
    ds_read_b64_tr_b16 v[130:131], v5 offset:21696
    s_waitcnt lgkmcnt(8)
    v_mfma_f32_16x16x32_bf16 v[32:35], v[136:139], v[196:199], v[32:35]
    ds_read_b64_tr_b16 v[132:133], v4 offset:14592
    v_mfma_f32_16x16x32_bf16 v[36:39], v[136:139], v[200:203], v[36:39]
    ds_read_b64_tr_b16 v[134:135], v4 offset:21760
    v_mfma_f32_16x16x32_bf16 v[40:43], v[140:143], v[196:199], v[40:43]
    ds_read_b64_tr_b16 v[136:137], v5 offset:14592
    v_mfma_f32_16x16x32_bf16 v[44:47], v[140:143], v[200:203], v[44:47]
    ds_read_b64_tr_b16 v[138:139], v5 offset:21760
    s_waitcnt lgkmcnt(8)
    v_mfma_f32_16x16x32_bf16 v[48:51], v[144:147], v[196:199], v[48:51]
    ds_read_b64_tr_b16 v[140:141], v4 offset:14656
    v_mfma_f32_16x16x32_bf16 v[52:55], v[144:147], v[200:203], v[52:55]
    ds_read_b64_tr_b16 v[142:143], v4 offset:21824
    v_mfma_f32_16x16x32_bf16 v[56:59], v[148:151], v[196:199], v[56:59]
    ds_read_b64_tr_b16 v[144:145], v5 offset:14656
    v_mfma_f32_16x16x32_bf16 v[60:63], v[148:151], v[200:203], v[60:63]
    ds_read_b64_tr_b16 v[146:147], v5 offset:21824
    s_waitcnt lgkmcnt(8)
    v_mfma_f32_16x16x32_bf16 v[64:67], v[152:155], v[196:199], v[64:67]
    buffer_load_dwordx4 v[184:187], v2, s[40:43], s72 offen offset:3072 sc1
    ds_read_b64_tr_b16 v[148:149], v4 offset:14720
    v_mfma_f32_16x16x32_bf16 v[68:71], v[152:155], v[200:203], v[68:71]
    ds_read_b64_tr_b16 v[150:151], v4 offset:21888
    v_mfma_f32_16x16x32_bf16 v[72:75], v[128:131], v[196:199], v[72:75]
    v_add_u32 v4, s74, v6
    ds_read_b64_tr_b16 v[152:153], v5 offset:14720
    v_mfma_f32_16x16x32_bf16 v[76:79], v[128:131], v[200:203], v[76:79]
    ds_read_b64_tr_b16 v[154:155], v5 offset:21888
    s_waitcnt lgkmcnt(8)
    v_mfma_f32_16x16x32_bf16 v[80:83], v[132:135], v[196:199], v[80:83]
    s_barrier
    ds_read_b64_tr_b16 v[128:129], v4 offset:0
    v_mfma_f32_16x16x32_bf16 v[84:87], v[132:135], v[200:203], v[84:87]
    ds_read_b64_tr_b16 v[130:131], v4 offset:7168
    v_mfma_f32_16x16x32_bf16 v[88:91], v[136:139], v[196:199], v[88:91]
    v_add_u32 v5, s74, v7
    ds_read_b64_tr_b16 v[132:133], v5 offset:0
    v_mfma_f32_16x16x32_bf16 v[92:95], v[136:139], v[200:203], v[92:95]
    ds_read_b64_tr_b16 v[134:135], v5 offset:7168
    s_waitcnt lgkmcnt(8)
    v_mfma_f32_16x16x32_bf16 v[96:99], v[140:143], v[196:199], v[96:99]
    s_add_u32 s72, s72, 4096
    ds_read_b64_tr_b16 v[136:137], v4 offset:64
    v_mfma_f32_16x16x32_bf16 v[100:103], v[140:143], v[200:203], v[100:103]
    ds_read_b64_tr_b16 v[138:139], v4 offset:7232
    v_mfma_f32_16x16x32_bf16 v[104:107], v[144:147], v[196:199], v[104:107]
    s_and_b32 s72, s72, 0xffff
    ds_read_b64_tr_b16 v[140:141], v5 offset:64
    v_mfma_f32_16x16x32_bf16 v[108:111], v[144:147], v[200:203], v[108:111]
    ds_read_b64_tr_b16 v[142:143], v5 offset:7232
    s_waitcnt lgkmcnt(8)
    v_mfma_f32_16x16x32_bf16 v[112:115], v[148:151], v[196:199], v[112:115]
    s_sub_u32 s73, s73, 1
    ds_read_b64_tr_b16 v[144:145], v4 offset:128
    v_mfma_f32_16x16x32_bf16 v[116:119], v[148:151], v[200:203], v[116:119]
    ds_read_b64_tr_b16 v[146:147], v4 offset:7296
    v_mfma_f32_16x16x32_bf16 v[120:123], v[152:155], v[196:199], v[120:123]
    s_cmp_lg_u32 s73, 0
    ds_read_b64_tr_b16 v[148:149], v5 offset:128
    v_mfma_f32_16x16x32_bf16 v[124:127], v[152:155], v[200:203], v[124:127]
    ds_read_b64_tr_b16 v[150:151], v5 offset:7296
    s_cbranch_scc1 L_mainc_wl
    s_waitcnt vmcnt(6) lgkmcnt(8)
    v_mfma_f32_16x16x32_bf16 v[16:19], v[128:131], v[156:159], v[16:19]
    ds_read_b64_tr_b16 v[152:153], v4 offset:192
    v_mfma_f32_16x16x32_bf16 v[20:23], v[128:131], v[160:163], v[20:23]
    ds_read_b64_tr_b16 v[154:155], v4 offset:7360
    v_mfma_f32_16x16x32_bf16 v[24:27], v[132:135], v[156:159], v[24:27]
    ds_read_b64_tr_b16 v[128:129], v5 offset:192
    v_mfma_f32_16x16x32_bf16 v[28:31], v[132:135], v[160:163], v[28:31]
    ds_read_b64_tr_b16 v[130:131], v5 offset:7360
    s_waitcnt lgkmcnt(8)
    v_mfma_f32_16x16x32_bf16 v[32:35], v[136:139], v[156:159], v[32:35]
    ds_read_b64_tr_b16 v[132:133], v4 offset:256
    v_mfma_f32_16x16x32_bf16 v[36:39], v[136:139], v[160:163], v[36:39]
    ds_read_b64_tr_b16 v[134:135], v4 offset:7424
    v_mfma_f32_16x16x32_bf16 v[40:43], v[140:143], v[156:159], v[40:43]
    ds_read_b64_tr_b16 v[136:137], v5 offset:256
    v_mfma_f32_16x16x32_bf16 v[44:47], v[140:143], v[160:163], v[44:47]
    ds_read_b64_tr_b16 v[138:139], v5 offset:7424
    s_waitcnt lgkmcnt(8)
    v_mfma_f32_16x16x32_bf16 v[48:51], v[144:147], v[156:159], v[48:51]
    ds_read_b64_tr_b16 v[140:141], v4 offset:320
    v_mfma_f32_16x16x32_bf16 v[52:55], v[144:147], v[160:163], v[52:55]
    ds_read_b64_tr_b16 v[142:143], v4 offset:7488
    v_mfma_f32_16x16x32_bf16 v[56:59], v[148:151], v[156:159], v[56:59]
    ds_read_b64_tr_b16 v[144:145], v5 offset:320
    v_mfma_f32_16x16x32_bf16 v[60:63], v[148:151], v[160:163], v[60:63]
    ds_read_b64_tr_b16 v[146:147], v5 offset:7488
    s_waitcnt lgkmcnt(8)
    v_mfma_f32_16x16x32_bf16 v[64:67], v[152:155], v[156:159], v[64:67]
    ds_read_b64_tr_b16 v[148:149], v4 offset:384
    v_mfma_f32_16x16x32_bf16 v[68:71], v[152:155], v[160:163], v[68:71]
    ds_read_b64_tr_b16 v[150:151], v4 offset:7552
    v_mfma_f32_16x16x32_bf16 v[72:75], v[128:131], v[156:159], v[72:75]
    ds_read_b64_tr_b16 v[152:153], v5 offset:384
    v_mfma_f32_16x16x32_bf16 v[76:79], v[128:131], v[160:163], v[76:79]
    ds_read_b64_tr_b16 v[154:155], v5 offset:7552
    s_waitcnt lgkmcnt(8)
    v_mfma_f32_16x16x32_bf16 v[80:83], v[132:135], v[156:159], v[80:83]
    ds_read_b64_tr_b16 v[128:129], v4 offset:14336
    v_mfma_f32_16x16x32_bf16 v[84:87], v[132:135], v[160:163], v[84:87]
    ds_read_b64_tr_b16 v[130:131], v4 offset:21504
    v_mfma_f32_16x16x32_bf16 v[88:91], v[136:139], v[156:159], v[88:91]
    ds_read_b64_tr_b16 v[132:133], v5 offset:14336
    v_mfma_f32_16x16x32_bf16 v[92:95], v[136:139], v[160:163], v[92:95]
    ds_read_b64_tr_b16 v[134:135], v5 offset:21504
    s_waitcnt lgkmcnt(8)
    v_mfma_f32_16x16x32_bf16 v[96:99], v[140:143], v[156:159], v[96:99]
    ds_read_b64_tr_b16 v[136:137], v4 offset:14400
    v_mfma_f32_16x16x32_bf16 v[100:103], v[140:143], v[160:163], v[100:103]
    ds_read_b64_tr_b16 v[138:139], v4 offset:21568
    v_mfma_f32_16x16x32_bf16 v[104:107], v[144:147], v[156:159], v[104:107]
    ds_read_b64_tr_b16 v[140:141], v5 offset:14400
    v_mfma_f32_16x16x32_bf16 v[108:111], v[144:147], v[160:163], v[108:111]
    ds_read_b64_tr_b16 v[142:143], v5 offset:21568
    s_waitcnt lgkmcnt(8)
    v_mfma_f32_16x16x32_bf16 v[112:115], v[148:151], v[156:159], v[112:115]
    ds_read_b64_tr_b16 v[144:145], v4 offset:14464
    v_mfma_f32_16x16x32_bf16 v[116:119], v[148:151], v[160:163], v[116:119]
    ds_read_b64_tr_b16 v[146:147], v4 offset:21632
    v_mfma_f32_16x16x32_bf16 v[120:123], v[152:155], v[156:159], v[120:123]
    ds_read_b64_tr_b16 v[148:149], v5 offset:14464
    v_mfma_f32_16x16x32_bf16 v[124:127], v[152:155], v[160:163], v[124:127]
    ds_read_b64_tr_b16 v[150:151], v5 offset:21632
    s_waitcnt vmcnt(4) lgkmcnt(8)
    v_mfma_f32_16x16x32_bf16 v[16:19], v[128:131], v[164:167], v[16:19]
    ds_read_b64_tr_b16 v[152:153], v4 offset:14528
    v_mfma_f32_16x16x32_bf16 v[20:23], v[128:131], v[168:171], v[20:23]
    ds_read_b64_tr_b16 v[154:155], v4 offset:21696
    v_mfma_f32_16x16x32_bf16 v[24:27], v[132:135], v[164:167], v[24:27]
    ds_read_b64_tr_b16 v[128:129], v5 offset:14528
    v_mfma_f32_16x16x32_bf16 v[28:31], v[132:135], v[168:171], v[28:31]
    ds_read_b64_tr_b16 v[130:131], v5 offset:21696
    s_waitcnt lgkmcnt(8)
    v_mfma_f32_16x16x32_bf16 v[32:35], v[136:139], v[164:167], v[32:35]
    ds_read_b64_tr_b16 v[132:133], v4 offset:14592
    v_mfma_f32_16x16x32_bf16 v[36:39], v[136:139], v[168:171], v[36:39]
    ds_read_b64_tr_b16 v[134:135], v4 offset:21760
    v_mfma_f32_16x16x32_bf16 v[40:43], v[140:143], v[164:167], v[40:43]
    ds_read_b64_tr_b16 v[136:137], v5 offset:14592
    v_mfma_f32_16x16x32_bf16 v[44:47], v[140:143], v[168:171], v[44:47]
    ds_read_b64_tr_b16 v[138:139], v5 offset:21760
    s_waitcnt lgkmcnt(8)
    v_mfma_f32_16x16x32_bf16 v[48:51], v[144:147], v[164:167], v[48:51]
    ds_read_b64_tr_b16 v[140:141], v4 offset:14656
    v_mfma_f32_16x16x32_bf16 v[52:55], v[144:147], v[168:171], v[52:55]
    ds_read_b64_tr_b16 v[142:143], v4 offset:21824
    v_mfma_f32_16x16x32_bf16 v[56:59], v[148:151], v[164:167], v[56:59]
    v_lshl_or_b32 v252, v205, 16, v204
    v_lshl_or_b32 v253, v207, 16, v206
    ds_read_b64_tr_b16 v[144:145], v5 offset:14656
    v_mfma_f32_16x16x32_bf16 v[60:63], v[148:151], v[168:171], v[60:63]
    ds_read_b64_tr_b16 v[146:147], v5 offset:21824
    s_waitcnt lgkmcnt(8)
    v_mfma_f32_16x16x32_bf16 v[64:67], v[152:155], v[164:167], v[64:67]
    v_and_b32 v9, 48, v1
    v_add_u32 v9, 143360, v9
    ds_read_b64_tr_b16 v[148:149], v4 offset:14720
    v_mfma_f32_16x16x32_bf16 v[68:71], v[152:155], v[168:171], v[68:71]
    ds_read_b64_tr_b16 v[150:151], v4 offset:21888
    v_mfma_f32_16x16x32_bf16 v[72:75], v[128:131], v[164:167], v[72:75]
    s_lshl_b32 s52, s3, 8
    s_add_u32 s52, s52, 145408
    v_lshl_add_u32 v14, v3, 4, s52
    ds_read_b64_tr_b16 v[152:153], v5 offset:14720
    v_mfma_f32_16x16x32_bf16 v[76:79], v[128:131], v[168:171], v[76:79]
    ds_read_b64_tr_b16 v[154:155], v5 offset:21888
    s_waitcnt lgkmcnt(8)
    v_mfma_f32_16x16x32_bf16 v[80:83], v[132:135], v[164:167], v[80:83]
    ds_read_b128 v[10:13], v14
    v_mfma_f32_16x16x32_bf16 v[84:87], v[132:135], v[168:171], v[84:87]
    v_mfma_f32_16x16x32_bf16 v[88:91], v[136:139], v[164:167], v[88:91]
    ds_read_b128 v[204:207], v9 offset:0
    ds_read_b128 v[208:211], v9 offset:64
    ds_read_b128 v[212:215], v9 offset:1024
    ds_read_b128 v[216:219], v9 offset:1088
    v_mfma_f32_16x16x32_bf16 v[92:95], v[136:139], v[168:171], v[92:95]
    s_waitcnt lgkmcnt(4)
    v_mfma_f32_16x16x32_bf16 v[96:99], v[140:143], v[164:167], v[96:99]
    v_mfma_f32_16x16x32_bf16 v[100:103], v[140:143], v[168:171], v[100:103]
    v_mfma_f32_16x16x32_bf16 v[104:107], v[144:147], v[164:167], v[104:107]
    v_mfma_f32_16x16x32_bf16 v[108:111], v[144:147], v[168:171], v[108:111]
    s_waitcnt lgkmcnt(0)
    v_mfma_f32_16x16x32_bf16 v[112:115], v[148:151], v[164:167], v[112:115]
    v_mfma_f32_16x16x32_bf16 v[116:119], v[148:151], v[168:171], v[116:119]
    v_mfma_f32_16x16x32_bf16 v[120:123], v[152:155], v[164:167], v[120:123]
    v_mfma_f32_16x16x32_bf16 v[124:127], v[152:155], v[168:171], v[124:127]
L_mainc_wepi:
    s_waitcnt vmcnt(0)
    v_mov_b32 v4, 0xc0135761
    v_mov_b32 v5, 0xbdd2d3e8
    s_waitcnt lgkmcnt(0)
    ds_read_b128 v[220:223], v9 offset:128
    ds_read_b128 v[224:227], v9 offset:192
    ds_read_b128 v[228:231], v9 offset:1152
    ds_read_b128 v[232:235], v9 offset:1216
    v_pk_fma_f32 v[160:161], v[204:205], v[10:11], v[212:213] op_sel:[0,1,0] op_sel_hi:[1,1,1]
    v_pk_fma_f32 v[162:163], v[206:207], v[10:11], v[214:215] op_sel:[0,1,0] op_sel_hi:[1,1,1]
    v_pk_fma_f32 v[164:165], v[204:205], v[12:13], v[212:213] op_sel:[0,1,0] op_sel_hi:[1,1,1]
    v_pk_fma_f32 v[166:167], v[206:207], v[12:13], v[214:215] op_sel:[0,1,0] op_sel_hi:[1,1,1]
    v_pk_fma_f32 v[168:169], v[208:209], v[10:11], v[216:217] op_sel:[0,1,0] op_sel_hi:[1,1,1]
    v_pk_fma_f32 v[170:171], v[210:211], v[10:11], v[218:219] op_sel:[0,1,0] op_sel_hi:[1,1,1]
    v_pk_fma_f32 v[172:173], v[208:209], v[12:13], v[216:217] op_sel:[0,1,0] op_sel_hi:[1,1,1]
    v_pk_fma_f32 v[174:175], v[210:211], v[12:13], v[218:219] op_sel:[0,1,0] op_sel_hi:[1,1,1]
    v_pk_fma_f32 v[16:17], v[16:17], v[10:11], v[160:161] op_sel_hi:[1,0,1]
    v_pk_fma_f32 v[18:19], v[18:19], v[10:11], v[162:163] op_sel_hi:[1,0,1]
    v_pk_fma_f32 v[20:21], v[20:21], v[12:13], v[164:165] op_sel_hi:[1,0,1]
    v_pk_fma_f32 v[22:23], v[22:23], v[12:13], v[166:167] op_sel_hi:[1,0,1]
    v_pk_fma_f32 v[24:25], v[24:25], v[10:11], v[168:169] op_sel_hi:[1,0,1]
    v_pk_fma_f32 v[26:27], v[26:27], v[10:11], v[170:171] op_sel_hi:[1,0,1]
    v_pk_fma_f32 v[28:29], v[28:29], v[12:13], v[172:173] op_sel_hi:[1,0,1]
    v_pk_fma_f32 v[30:31], v[30:31], v[12:13], v[174:175] op_sel_hi:[1,0,1]
    v_pk_mul_f32 v[160:161], v[16:17], v[16:17]
    v_pk_mul_f32 v[162:163], v[18:19], v[18:19]
    v_pk_mul_f32 v[164:165], v[20:21], v[20:21]
    v_pk_mul_f32 v[166:167], v[22:23], v[22:23]
    v_pk_mul_f32 v[168:169], v[24:25], v[24:25]
    v_pk_mul_f32 v[170:171], v[26:27], v[26:27]
    v_pk_mul_f32 v[172:173], v[28:29], v[28:29]
    v_pk_mul_f32 v[174:175], v[30:31], v[30:31]
    v_pk_fma_f32 v[160:161], v[160:161], v[4:5], v[4:5] op_sel:[0,1,0] op_sel_hi:[1,1,0]
    v_pk_fma_f32 v[162:163], v[162:163], v[4:5], v[4:5] op_sel:[0,1,0] op_sel_hi:[1,1,0]
    v_pk_fma_f32 v[164:165], v[164:165], v[4:5], v[4:5] op_sel:[0,1,0] op_sel_hi:[1,1,0]
    v_pk_fma_f32 v[166:167], v[166:167], v[4:5], v[4:5] op_sel:[0,1,0] op_sel_hi:[1,1,0]
    v_pk_fma_f32 v[168:169], v[168:169], v[4:5], v[4:5] op_sel:[0,1,0] op_sel_hi:[1,1,0]
    v_pk_fma_f32 v[170:171], v[170:171], v[4:5], v[4:5] op_sel:[0,1,0] op_sel_hi:[1,1,0]
    v_pk_fma_f32 v[172:173], v[172:173], v[4:5], v[4:5] op_sel:[0,1,0] op_sel_hi:[1,1,0]
    v_pk_fma_f32 v[174:175], v[174:175], v[4:5], v[4:5] op_sel:[0,1,0] op_sel_hi:[1,1,0]
    v_pk_mul_f32 v[160:161], v[160:161], v[16:17]
    v_pk_mul_f32 v[162:163], v[162:163], v[18:19]
    v_pk_mul_f32 v[164:165], v[164:165], v[20:21]
    v_pk_mul_f32 v[166:167], v[166:167], v[22:23]
    v_pk_mul_f32 v[168:169], v[168:169], v[24:25]
    v_pk_mul_f32 v[170:171], v[170:171], v[26:27]
    v_pk_mul_f32 v[172:173], v[172:173], v[28:29]
    v_pk_mul_f32 v[174:175], v[174:175], v[30:31]
    v_exp_f32 v160, v160
    v_exp_f32 v161, v161
    v_exp_f32 v162, v162
    v_exp_f32 v163, v163
    v_exp_f32 v164, v164
    v_exp_f32 v165, v165
    v_exp_f32 v166, v166
    v_exp_f32 v167, v167
    v_exp_f32 v168, v168
    v_exp_f32 v169, v169
    v_exp_f32 v170, v170
    v_exp_f32 v171, v171
    v_exp_f32 v172, v172
    v_exp_f32 v173, v173
    v_exp_f32 v174, v174
    v_exp_f32 v175, v175
    v_pk_add_f32 v[160:161], v[160:161], 1.0 op_sel_hi:[1,0]
    v_pk_add_f32 v[162:163], v[162:163], 1.0 op_sel_hi:[1,0]
    v_pk_add_f32 v[164:165], v[164:165], 1.0 op_sel_hi:[1,0]
    v_pk_add_f32 v[166:167], v[166:167], 1.0 op_sel_hi:[1,0]
    v_pk_add_f32 v[168:169], v[168:169], 1.0 op_sel_hi:[1,0]
    v_pk_add_f32 v[170:171], v[170:171], 1.0 op_sel_hi:[1,0]
    v_pk_add_f32 v[172:173], v[172:173], 1.0 op_sel_hi:[1,0]
    v_pk_add_f32 v[174:175], v[174:175], 1.0 op_sel_hi:[1,0]
    v_rcp_f32 v160, v160
    v_rcp_f32 v161, v161
    v_rcp_f32 v162, v162
    v_rcp_f32 v163, v163
    v_rcp_f32 v164, v164
    v_rcp_f32 v165, v165
    v_rcp_f32 v166, v166
    v_rcp_f32 v167, v167
    v_rcp_f32 v168, v168
    v_rcp_f32 v169, v169
    v_rcp_f32 v170, v170
    v_rcp_f32 v171, v171
    v_rcp_f32 v172, v172
    v_rcp_f32 v173, v173
    v_rcp_f32 v174, v174
    v_rcp_f32 v175, v175
    v_pk_mul_f32 v[16:17], v[16:17], v[160:161]
    v_pk_mul_f32 v[18:19], v[18:19], v[162:163]
    v_pk_mul_f32 v[20:21], v[20:21], v[164:165]
    v_pk_mul_f32 v[22:23], v[22:23], v[166:167]
    v_pk_mul_f32 v[24:25], v[24:25], v[168:169]
    v_pk_mul_f32 v[26:27], v[26:27], v[170:171]
    v_pk_mul_f32 v[28:29], v[28:29], v[172:173]
    v_pk_mul_f32 v[30:31], v[30:31], v[174:175]
    s_barrier
    s_waitcnt lgkmcnt(0)
    ds_read_b128 v[204:207], v9 offset:256
    ds_read_b128 v[208:211], v9 offset:320
    ds_read_b128 v[212:215], v9 offset:1280
    ds_read_b128 v[216:219], v9 offset:1344
    v_pk_fma_f32 v[160:161], v[220:221], v[10:11], v[228:229] op_sel:[0,1,0] op_sel_hi:[1,1,1]
    v_pk_fma_f32 v[162:163], v[222:223], v[10:11], v[230:231] op_sel:[0,1,0] op_sel_hi:[1,1,1]
    v_pk_fma_f32 v[164:165], v[220:221], v[12:13], v[228:229] op_sel:[0,1,0] op_sel_hi:[1,1,1]
    v_pk_fma_f32 v[166:167], v[222:223], v[12:13], v[230:231] op_sel:[0,1,0] op_sel_hi:[1,1,1]
    v_pk_fma_f32 v[168:169], v[224:225], v[10:11], v[232:233] op_sel:[0,1,0] op_sel_hi:[1,1,1]
    v_pk_fma_f32 v[170:171], v[226:227], v[10:11], v[234:235] op_sel:[0,1,0] op_sel_hi:[1,1,1]
    v_pk_fma_f32 v[172:173], v[224:225], v[12:13], v[232:233] op_sel:[0,1,0] op_sel_hi:[1,1,1]
    v_pk_fma_f32 v[174:175], v[226:227], v[12:13], v[234:235] op_sel:[0,1,0] op_sel_hi:[1,1,1]
    v_pk_fma_f32 v[32:33], v[32:33], v[10:11], v[160:161] op_sel_hi:[1,0,1]
    v_pk_fma_f32 v[34:35], v[34:35], v[10:11], v[162:163] op_sel_hi:[1,0,1]
    v_pk_fma_f32 v[36:37], v[36:37], v[12:13], v[164:165] op_sel_hi:[1,0,1]
    v_pk_fma_f32 v[38:39], v[38:39], v[12:13], v[166:167] op_sel_hi:[1,0,1]
    v_pk_fma_f32 v[40:41], v[40:41], v[10:11], v[168:169] op_sel_hi:[1,0,1]
    v_pk_fma_f32 v[42:43], v[42:43], v[10:11], v[170:171] op_sel_hi:[1,0,1]
    v_pk_fma_f32 v[44:45], v[44:45], v[12:13], v[172:173] op_sel_hi:[1,0,1]
    v_pk_fma_f32 v[46:47], v[46:47], v[12:13], v[174:175] op_sel_hi:[1,0,1]
    v_pk_mul_f32 v[160:161], v[32:33], v[32:33]
    v_pk_mul_f32 v[162:163], v[34:35], v[34:35]
    v_pk_mul_f32 v[164:165], v[36:37], v[36:37]
    v_pk_mul_f32 v[166:167], v[38:39], v[38:39]
    v_pk_mul_f32 v[168:169], v[40:41], v[40:41]
    v_pk_mul_f32 v[170:171], v[42:43], v[42:43]
    v_pk_mul_f32 v[172:173], v[44:45], v[44:45]
    v_pk_mul_f32 v[174:175], v[46:47], v[46:47]
    v_pk_fma_f32 v[160:161], v[160:161], v[4:5], v[4:5] op_sel:[0,1,0] op_sel_hi:[1,1,0]
    v_pk_fma_f32 v[162:163], v[162:163], v[4:5], v[4:5] op_sel:[0,1,0] op_sel_hi:[1,1,0]
    v_pk_fma_f32 v[164:165], v[164:165], v[4:5], v[4:5] op_sel:[0,1,0] op_sel_hi:[1,1,0]
    v_pk_fma_f32 v[166:167], v[166:167], v[4:5], v[4:5] op_sel:[0,1,0] op_sel_hi:[1,1,0]
    v_pk_fma_f32 v[168:169], v[168:169], v[4:5], v[4:5] op_sel:[0,1,0] op_sel_hi:[1,1,0]
    v_pk_fma_f32 v[170:171], v[170:171], v[4:5], v[4:5] op_sel:[0,1,0] op_sel_hi:[1,1,0]
    v_pk_fma_f32 v[172:173], v[172:173], v[4:5], v[4:5] op_sel:[0,1,0] op_sel_hi:[1,1,0]
    v_pk_fma_f32 v[174:175], v[174:175], v[4:5], v[4:5] op_sel:[0,1,0] op_sel_hi:[1,1,0]
    v_pk_mul_f32 v[160:161], v[160:161], v[32:33]
    v_pk_mul_f32 v[162:163], v[162:163], v[34:35]
    v_pk_mul_f32 v[164:165], v[164:165], v[36:37]
    v_pk_mul_f32 v[166:167], v[166:167], v[38:39]
    v_pk_mul_f32 v[168:169], v[168:169], v[40:41]
    v_pk_mul_f32 v[170:171], v[170:171], v[42:43]
    v_pk_mul_f32 v[172:173], v[172:173], v[44:45]
    v_pk_mul_f32 v[174:175], v[174:175], v[46:47]
    v_exp_f32 v160, v160
    v_exp_f32 v161, v161
    v_exp_f32 v162, v162
    v_exp_f32 v163, v163
    v_exp_f32 v164, v164
    v_exp_f32 v165, v165
    v_exp_f32 v166, v166
    v_exp_f32 v167, v167
    v_exp_f32 v168, v168
    v_exp_f32 v169, v169
    v_exp_f32 v170, v170
    v_exp_f32 v171, v171
    v_exp_f32 v172, v172
    v_exp_f32 v173, v173
    v_exp_f32 v174, v174
    v_exp_f32 v175, v175
    v_pk_add_f32 v[160:161], v[160:161], 1.0 op_sel_hi:[1,0]
    v_pk_add_f32 v[162:163], v[162:163], 1.0 op_sel_hi:[1,0]
    v_pk_add_f32 v[164:165], v[164:165], 1.0 op_sel_hi:[1,0]
    v_pk_add_f32 v[166:167], v[166:167], 1.0 op_sel_hi:[1,0]
    v_pk_add_f32 v[168:169], v[168:169], 1.0 op_sel_hi:[1,0]
    v_pk_add_f32 v[170:171], v[170:171], 1.0 op_sel_hi:[1,0]
    v_pk_add_f32 v[172:173], v[172:173], 1.0 op_sel_hi:[1,0]
    v_pk_add_f32 v[174:175], v[174:175], 1.0 op_sel_hi:[1,0]
    v_rcp_f32 v160, v160
    v_rcp_f32 v161, v161
    v_rcp_f32 v162, v162
    v_rcp_f32 v163, v163
    v_rcp_f32 v164, v164
    v_rcp_f32 v165, v165
    v_rcp_f32 v166, v166
    v_rcp_f32 v167, v167
    v_rcp_f32 v168, v168
    v_rcp_f32 v169, v169
    v_rcp_f32 v170, v170
    v_rcp_f32 v171, v171
    v_rcp_f32 v172, v172
    v_rcp_f32 v173, v173
    v_rcp_f32 v174, v174
    v_rcp_f32 v175, v175
    v_pk_mul_f32 v[32:33], v[32:33], v[160:161]
    v_pk_mul_f32 v[34:35], v[34:35], v[162:163]
    v_pk_mul_f32 v[36:37], v[36:37], v[164:165]
    v_pk_mul_f32 v[38:39], v[38:39], v[166:167]
    v_pk_mul_f32 v[40:41], v[40:41], v[168:169]
    v_pk_mul_f32 v[42:43], v[42:43], v[170:171]
    v_pk_mul_f32 v[44:45], v[44:45], v[172:173]
    v_pk_mul_f32 v[46:47], v[46:47], v[174:175]
    s_waitcnt lgkmcnt(0)
    ds_read_b128 v[220:223], v9 offset:384
    ds_read_b128 v[224:227], v9 offset:448
    ds_read_b128 v[228:231], v9 offset:1408
    ds_read_b128 v[232:235], v9 offset:1472
    v_pk_fma_f32 v[160:161], v[204:205], v[10:11], v[212:213] op_sel:[0,1,0] op_sel_hi:[1,1,1]
    v_pk_fma_f32 v[162:163], v[206:207], v[10:11], v[214:215] op_sel:[0,1,0] op_sel_hi:[1,1,1]
    v_pk_fma_f32 v[164:165], v[204:205], v[12:13], v[212:213] op_sel:[0,1,0] op_sel_hi:[1,1,1]
    v_pk_fma_f32 v[166:167], v[206:207], v[12:13], v[214:215] op_sel:[0,1,0] op_sel_hi:[1,1,1]
    v_pk_fma_f32 v[168:169], v[208:209], v[10:11], v[216:217] op_sel:[0,1,0] op_sel_hi:[1,1,1]
    v_pk_fma_f32 v[170:171], v[210:211], v[10:11], v[218:219] op_sel:[0,1,0] op_sel_hi:[1,1,1]
    v_pk_fma_f32 v[172:173], v[208:209], v[12:13], v[216:217] op_sel:[0,1,0] op_sel_hi:[1,1,1]
    v_pk_fma_f32 v[174:175], v[210:211], v[12:13], v[218:219] op_sel:[0,1,0] op_sel_hi:[1,1,1]
    v_pk_fma_f32 v[48:49], v[48:49], v[10:11], v[160:161] op_sel_hi:[1,0,1]
    v_pk_fma_f32 v[50:51], v[50:51], v[10:11], v[162:163] op_sel_hi:[1,0,1]
    v_pk_fma_f32 v[52:53], v[52:53], v[12:13], v[164:165] op_sel_hi:[1,0,1]
    v_pk_fma_f32 v[54:55], v[54:55], v[12:13], v[166:167] op_sel_hi:[1,0,1]
    v_pk_fma_f32 v[56:57], v[56:57], v[10:11], v[168:169] op_sel_hi:[1,0,1]
    v_pk_fma_f32 v[58:59], v[58:59], v[10:11], v[170:171] op_sel_hi:[1,0,1]
    v_pk_fma_f32 v[60:61], v[60:61], v[12:13], v[172:173] op_sel_hi:[1,0,1]
    v_pk_fma_f32 v[62:63], v[62:63], v[12:13], v[174:175] op_sel_hi:[1,0,1]
    v_pk_mul_f32 v[160:161], v[48:49], v[48:49]
    v_pk_mul_f32 v[162:163], v[50:51], v[50:51]
    v_pk_mul_f32 v[164:165], v[52:53], v[52:53]
    v_pk_mul_f32 v[166:167], v[54:55], v[54:55]
    v_pk_mul_f32 v[168:169], v[56:57], v[56:57]
    v_pk_mul_f32 v[170:171], v[58:59], v[58:59]
    v_pk_mul_f32 v[172:173], v[60:61], v[60:61]
    v_pk_mul_f32 v[174:175], v[62:63], v[62:63]
    v_pk_fma_f32 v[160:161], v[160:161], v[4:5], v[4:5] op_sel:[0,1,0] op_sel_hi:[1,1,0]
    v_pk_fma_f32 v[162:163], v[162:163], v[4:5], v[4:5] op_sel:[0,1,0] op_sel_hi:[1,1,0]
    v_pk_fma_f32 v[164:165], v[164:165], v[4:5], v[4:5] op_sel:[0,1,0] op_sel_hi:[1,1,0]
    v_pk_fma_f32 v[166:167], v[166:167], v[4:5], v[4:5] op_sel:[0,1,0] op_sel_hi:[1,1,0]
    v_pk_fma_f32 v[168:169], v[168:169], v[4:5], v[4:5] op_sel:[0,1,0] op_sel_hi:[1,1,0]
    v_pk_fma_f32 v[170:171], v[170:171], v[4:5], v[4:5] op_sel:[0,1,0] op_sel_hi:[1,1,0]
    v_pk_fma_f32 v[172:173], v[172:173], v[4:5], v[4:5] op_sel:[0,1,0] op_sel_hi:[1,1,0]
    v_pk_fma_f32 v[174:175], v[174:175], v[4:5], v[4:5] op_sel:[0,1,0] op_sel_hi:[1,1,0]
    v_pk_mul_f32 v[160:161], v[160:161], v[48:49]
    v_pk_mul_f32 v[162:163], v[162:163], v[50:51]
    v_pk_mul_f32 v[164:165], v[164:165], v[52:53]
    v_pk_mul_f32 v[166:167], v[166:167], v[54:55]
    v_pk_mul_f32 v[168:169], v[168:169], v[56:57]
    v_pk_mul_f32 v[170:171], v[170:171], v[58:59]
    v_pk_mul_f32 v[172:173], v[172:173], v[60:61]
    v_pk_mul_f32 v[174:175], v[174:175], v[62:63]
    v_exp_f32 v160, v160
    v_exp_f32 v161, v161
    v_exp_f32 v162, v162
    v_exp_f32 v163, v163
    v_exp_f32 v164, v164
    v_exp_f32 v165, v165
    v_exp_f32 v166, v166
    v_exp_f32 v167, v167
    v_exp_f32 v168, v168
    v_exp_f32 v169, v169
    v_exp_f32 v170, v170
    v_exp_f32 v171, v171
    v_exp_f32 v172, v172
    v_exp_f32 v173, v173
    v_exp_f32 v174, v174
    v_exp_f32 v175, v175
    v_pk_add_f32 v[160:161], v[160:161], 1.0 op_sel_hi:[1,0]
    v_pk_add_f32 v[162:163], v[162:163], 1.0 op_sel_hi:[1,0]
    v_pk_add_f32 v[164:165], v[164:165], 1.0 op_sel_hi:[1,0]
    v_pk_add_f32 v[166:167], v[166:167], 1.0 op_sel_hi:[1,0]
    v_pk_add_f32 v[168:169], v[168:169], 1.0 op_sel_hi:[1,0]
    v_pk_add_f32 v[170:171], v[170:171], 1.0 op_sel_hi:[1,0]
    v_pk_add_f32 v[172:173], v[172:173], 1.0 op_sel_hi:[1,0]
    v_pk_add_f32 v[174:175], v[174:175], 1.0 op_sel_hi:[1,0]
    v_rcp_f32 v160, v160
    v_rcp_f32 v161, v161
    v_rcp_f32 v162, v162
    v_rcp_f32 v163, v163
    v_rcp_f32 v164, v164
    v_rcp_f32 v165, v165
    v_rcp_f32 v166, v166
    v_rcp_f32 v167, v167
    v_rcp_f32 v168, v168
    v_rcp_f32 v169, v169
    v_rcp_f32 v170, v170
    v_rcp_f32 v171, v171
    v_rcp_f32 v172, v172
    v_rcp_f32 v173, v173
    v_rcp_f32 v174, v174
    v_rcp_f32 v175, v175
    v_pk_mul_f32 v[48:49], v[48:49], v[160:161]
    v_pk_mul_f32 v[50:51], v[50:51], v[162:163]
    v_pk_mul_f32 v[52:53], v[52:53], v[164:165]
    v_pk_mul_f32 v[54:55], v[54:55], v[166:167]
    v_pk_mul_f32 v[56:57], v[56:57], v[168:169]
    v_pk_mul_f32 v[58:59], v[58:59], v[170:171]
    v_pk_mul_f32 v[60:61], v[60:61], v[172:173]
    v_pk_mul_f32 v[62:63], v[62:63], v[174:175]
    s_waitcnt lgkmcnt(0)
    ds_read_b128 v[204:207], v9 offset:512
    ds_read_b128 v[208:211], v9 offset:576
    ds_read_b128 v[212:215], v9 offset:1536
    ds_read_b128 v[216:219], v9 offset:1600
    v_pk_fma_f32 v[160:161], v[220:221], v[10:11], v[228:229] op_sel:[0,1,0] op_sel_hi:[1,1,1]
    v_pk_fma_f32 v[162:163], v[222:223], v[10:11], v[230:231] op_sel:[0,1,0] op_sel_hi:[1,1,1]
    v_pk_fma_f32 v[164:165], v[220:221], v[12:13], v[228:229] op_sel:[0,1,0] op_sel_hi:[1,1,1]
    v_pk_fma_f32 v[166:167], v[222:223], v[12:13], v[230:231] op_sel:[0,1,0] op_sel_hi:[1,1,1]
    v_pk_fma_f32 v[168:169], v[224:225], v[10:11], v[232:233] op_sel:[0,1,0] op_sel_hi:[1,1,1]
    v_pk_fma_f32 v[170:171], v[226:227], v[10:11], v[234:235] op_sel:[0,1,0] op_sel_hi:[1,1,1]
    v_pk_fma_f32 v[172:173], v[224:225], v[12:13], v[232:233] op_sel:[0,1,0] op_sel_hi:[1,1,1]
    v_pk_fma_f32 v[174:175], v[226:227], v[12:13], v[234:235] op_sel:[0,1,0] op_sel_hi:[1,1,1]
    v_pk_fma_f32 v[64:65], v[64:65], v[10:11], v[160:161] op_sel_hi:[1,0,1]
    v_pk_fma_f32 v[66:67], v[66:67], v[10:11], v[162:163] op_sel_hi:[1,0,1]
    v_pk_fma_f32 v[68:69], v[68:69], v[12:13], v[164:165] op_sel_hi:[1,0,1]
    v_pk_fma_f32 v[70:71], v[70:71], v[12:13], v[166:167] op_sel_hi:[1,0,1]
    v_pk_fma_f32 v[72:73], v[72:73], v[10:11], v[168:169] op_sel_hi:[1,0,1]
    v_pk_fma_f32 v[74:75], v[74:75], v[10:11], v[170:171] op_sel_hi:[1,0,1]
    v_pk_fma_f32 v[76:77], v[76:77], v[12:13], v[172:173] op_sel_hi:[1,0,1]
    v_pk_fma_f32 v[78:79], v[78:79], v[12:13], v[174:175] op_sel_hi:[1,0,1]
    v_pk_mul_f32 v[160:161], v[64:65], v[64:65]
    v_pk_mul_f32 v[162:163], v[66:67], v[66:67]
    v_pk_mul_f32 v[164:165], v[68:69], v[68:69]
    v_pk_mul_f32 v[166:167], v[70:71], v[70:71]
    v_pk_mul_f32 v[168:169], v[72:73], v[72:73]
    v_pk_mul_f32 v[170:171], v[74:75], v[74:75]
    v_pk_mul_f32 v[172:173], v[76:77], v[76:77]
    v_pk_mul_f32 v[174:175], v[78:79], v[78:79]
    v_pk_fma_f32 v[160:161], v[160:161], v[4:5], v[4:5] op_sel:[0,1,0] op_sel_hi:[1,1,0]
    v_pk_fma_f32 v[162:163], v[162:163], v[4:5], v[4:5] op_sel:[0,1,0] op_sel_hi:[1,1,0]
    v_pk_fma_f32 v[164:165], v[164:165], v[4:5], v[4:5] op_sel:[0,1,0] op_sel_hi:[1,1,0]
    v_pk_fma_f32 v[166:167], v[166:167], v[4:5], v[4:5] op_sel:[0,1,0] op_sel_hi:[1,1,0]
    v_pk_fma_f32 v[168:169], v[168:169], v[4:5], v[4:5] op_sel:[0,1,0] op_sel_hi:[1,1,0]
    v_pk_fma_f32 v[170:171], v[170:171], v[4:5], v[4:5] op_sel:[0,1,0] op_sel_hi:[1,1,0]
    v_pk_fma_f32 v[172:173], v[172:173], v[4:5], v[4:5] op_sel:[0,1,0] op_sel_hi:[1,1,0]
    v_pk_fma_f32 v[174:175], v[174:175], v[4:5], v[4:5] op_sel:[0,1,0] op_sel_hi:[1,1,0]
    v_pk_mul_f32 v[160:161], v[160:161], v[64:65]
    v_pk_mul_f32 v[162:163], v[162:163], v[66:67]
    v_pk_mul_f32 v[164:165], v[164:165], v[68:69]
    v_pk_mul_f32 v[166:167], v[166:167], v[70:71]
    v_pk_mul_f32 v[168:169], v[168:169], v[72:73]
    v_pk_mul_f32 v[170:171], v[170:171], v[74:75]
    v_pk_mul_f32 v[172:173], v[172:173], v[76:77]
    v_pk_mul_f32 v[174:175], v[174:175], v[78:79]
    v_exp_f32 v160, v160
    v_exp_f32 v161, v161
    v_exp_f32 v162, v162
    v_exp_f32 v163, v163
    v_exp_f32 v164, v164
    v_exp_f32 v165, v165
    v_exp_f32 v166, v166
    v_exp_f32 v167, v167
    v_exp_f32 v168, v168
    v_exp_f32 v169, v169
    v_exp_f32 v170, v170
    v_exp_f32 v171, v171
    v_exp_f32 v172, v172
    v_exp_f32 v173, v173
    v_exp_f32 v174, v174
    v_exp_f32 v175, v175
    v_pk_add_f32 v[160:161], v[160:161], 1.0 op_sel_hi:[1,0]
    v_pk_add_f32 v[162:163], v[162:163], 1.0 op_sel_hi:[1,0]
    v_pk_add_f32 v[164:165], v[164:165], 1.0 op_sel_hi:[1,0]
    v_pk_add_f32 v[166:167], v[166:167], 1.0 op_sel_hi:[1,0]
    v_pk_add_f32 v[168:169], v[168:169], 1.0 op_sel_hi:[1,0]
    v_pk_add_f32 v[170:171], v[170:171], 1.0 op_sel_hi:[1,0]
    v_pk_add_f32 v[172:173], v[172:173], 1.0 op_sel_hi:[1,0]
    v_pk_add_f32 v[174:175], v[174:175], 1.0 op_sel_hi:[1,0]
    v_rcp_f32 v160, v160
    v_rcp_f32 v161, v161
    v_rcp_f32 v162, v162
    v_rcp_f32 v163, v163
    v_rcp_f32 v164, v164
    v_rcp_f32 v165, v165
    v_rcp_f32 v166, v166
    v_rcp_f32 v167, v167
    v_rcp_f32 v168, v168
    v_rcp_f32 v169, v169
    v_rcp_f32 v170, v170
    v_rcp_f32 v171, v171
    v_rcp_f32 v172, v172
    v_rcp_f32 v173, v173
    v_rcp_f32 v174, v174
    v_rcp_f32 v175, v175
    v_pk_mul_f32 v[64:65], v[64:65], v[160:161]
    v_pk_mul_f32 v[66:67], v[66:67], v[162:163]
    v_pk_mul_f32 v[68:69], v[68:69], v[164:165]
    v_pk_mul_f32 v[70:71], v[70:71], v[166:167]
    v_pk_mul_f32 v[72:73], v[72:73], v[168:169]
    v_pk_mul_f32 v[74:75], v[74:75], v[170:171]
    v_pk_mul_f32 v[76:77], v[76:77], v[172:173]
    v_pk_mul_f32 v[78:79], v[78:79], v[174:175]
    v_pk_mul_f32 v[194:195], v[16:17], v[16:17]
    v_pk_add_f32 v[192:193], v[16:17], v[18:19]
    v_pk_fma_f32 v[194:195], v[18:19], v[18:19], v[194:195]
    v_pk_mul_f32 v[198:199], v[20:21], v[20:21]
    v_pk_add_f32 v[196:197], v[20:21], v[22:23]
    v_pk_fma_f32 v[198:199], v[22:23], v[22:23], v[198:199]
    v_pk_add_f32 v[192:193], v[192:193], v[24:25]
    v_pk_fma_f32 v[194:195], v[24:25], v[24:25], v[194:195]
    v_pk_add_f32 v[192:193], v[192:193], v[26:27]
    v_pk_fma_f32 v[194:195], v[26:27], v[26:27], v[194:195]
    v_pk_add_f32 v[196:197], v[196:197], v[28:29]
    v_pk_fma_f32 v[198:199], v[28:29], v[28:29], v[198:199]
    v_pk_add_f32 v[196:197], v[196:197], v[30:31]
    v_pk_fma_f32 v[198:199], v[30:31], v[30:31], v[198:199]
    v_pk_add_f32 v[192:193], v[192:193], v[32:33]
    v_pk_fma_f32 v[194:195], v[32:33], v[32:33], v[194:195]
    v_pk_add_f32 v[192:193], v[192:193], v[34:35]
    v_pk_fma_f32 v[194:195], v[34:35], v[34:35], v[194:195]
    v_pk_add_f32 v[196:197], v[196:197], v[36:37]
    v_pk_fma_f32 v[198:199], v[36:37], v[36:37], v[198:199]
    v_pk_add_f32 v[196:197], v[196:197], v[38:39]
    v_pk_fma_f32 v[198:199], v[38:39], v[38:39], v[198:199]
    v_pk_add_f32 v[192:193], v[192:193], v[40:41]
    v_pk_fma_f32 v[194:195], v[40:41], v[40:41], v[194:195]
    v_pk_add_f32 v[192:193], v[192:193], v[42:43]
    v_pk_fma_f32 v[194:195], v[42:43], v[42:43], v[194:195]
    v_pk_add_f32 v[196:197], v[196:197], v[44:45]
    v_pk_fma_f32 v[198:199], v[44:45], v[44:45], v[198:199]
    v_pk_add_f32 v[196:197], v[196:197], v[46:47]
    v_pk_fma_f32 v[198:199], v[46:47], v[46:47], v[198:199]
    v_pk_add_f32 v[192:193], v[192:193], v[48:49]
    v_pk_fma_f32 v[194:195], v[48:49], v[48:49], v[194:195]
    v_pk_add_f32 v[192:193], v[192:193], v[50:51]
    v_pk_fma_f32 v[194:195], v[50:51], v[50:51], v[194:195]
    v_pk_add_f32 v[196:197], v[196:197], v[52:53]
    v_pk_fma_f32 v[198:199], v[52:53], v[52:53], v[198:199]
    v_pk_add_f32 v[196:197], v[196:197], v[54:55]
    v_pk_fma_f32 v[198:199], v[54:55], v[54:55], v[198:199]
    v_pk_add_f32 v[192:193], v[192:193], v[56:57]
    v_pk_fma_f32 v[194:195], v[56:57], v[56:57], v[194:195]
    v_pk_add_f32 v[192:193], v[192:193], v[58:59]
    v_pk_fma_f32 v[194:195], v[58:59], v[58:59], v[194:195]
    v_pk_add_f32 v[196:197], v[196:197], v[60:61]
    v_pk_fma_f32 v[198:199], v[60:61], v[60:61], v[198:199]
    v_pk_add_f32 v[196:197], v[196:197], v[62:63]
    v_pk_fma_f32 v[198:199], v[62:63], v[62:63], v[198:199]
    s_cmp_eq_u32 s63, 0
    s_cbranch_scc0 L_mainc_s1
    v_pk_add_f32 v[192:193], v[192:193], v[64:65]
    v_pk_fma_f32 v[194:195], v[64:65], v[64:65], v[194:195]
    v_pk_add_f32 v[192:193], v[192:193], v[66:67]
    v_pk_fma_f32 v[194:195], v[66:67], v[66:67], v[194:195]
    v_pk_add_f32 v[196:197], v[196:197], v[68:69]
    v_pk_fma_f32 v[198:199], v[68:69], v[68:69], v[198:199]
    v_pk_add_f32 v[196:197], v[196:197], v[70:71]
    v_pk_fma_f32 v[198:199], v[70:71], v[70:71], v[198:199]
    v_pk_add_f32 v[192:193], v[192:193], v[72:73]
    v_pk_fma_f32 v[194:195], v[72:73], v[72:73], v[194:195]
    v_pk_add_f32 v[192:193], v[192:193], v[74:75]
    v_pk_fma_f32 v[194:195], v[74:75], v[74:75], v[194:195]
    v_pk_add_f32 v[196:197], v[196:197], v[76:77]
    v_pk_fma_f32 v[198:199], v[76:77], v[76:77], v[198:199]
    v_pk_add_f32 v[196:197], v[196:197], v[78:79]
    v_pk_fma_f32 v[198:199], v[78:79], v[78:79], v[198:199]
L_mainc_s1:
    v_add_f32 v200, v192, v193
    v_add_f32 v201, v194, v195
    v_add_f32 v202, v196, v197
    v_add_f32 v203, v198, v199
    v_mov_b32 v192, v200
    v_mov_b32 v193, v201
    v_mov_b32 v194, v202
    v_mov_b32 v195, v203
    s_nop 0
    v_permlane16_swap_b32 v192, v200
    v_permlane16_swap_b32 v193, v201
    v_permlane16_swap_b32 v194, v202
    v_permlane16_swap_b32 v195, v203
    s_nop 0
    v_add_f32 v200, v200, v192
    v_add_f32 v201, v201, v193
    v_add_f32 v202, v202, v194
    v_add_f32 v203, v203, v195
    v_mov_b32 v192, v200
    v_mov_b32 v193, v201
    v_mov_b32 v194, v202
    v_mov_b32 v195, v203
    s_nop 0
    v_permlane32_swap_b32 v192, v200
    v_permlane32_swap_b32 v193, v201
    v_permlane32_swap_b32 v194, v202
    v_permlane32_swap_b32 v195, v203
    s_nop 0
    v_add_f32 v200, v200, v192
    v_add_f32 v201, v201, v193
    v_add_f32 v202, v202, v194
    v_add_f32 v203, v203, v195
    s_lshl_b32 s52, s78, 8
    s_add_u32 s58, s52, 0x80000
    s_lshl_b32 s53, s35, 14
    s_add_u32 s52, s58, s53
    v_lshlrev_b32 v6, 3, v1
    v_mov_b32 v14, v200
    v_and_b32 v15, -2, v201
    s_mov_b32 exec_lo, 0xffff0000
    s_mov_b32 exec_hi, 0
    v_mov_b32 v14, v202
    v_and_b32 v15, -2, v203
    s_mov_b32 exec_lo, -1
    buffer_store_dwordx2 v[14:15], v6, s[36:39], s52 offen sc1
    s_mov_b64 exec, -1
    v_lshrrev_b32 v6, 4, v1
    v_lshlrev_b32 v6, 2, v6
    v_sub_u32 v6, s35, v6
    v_bfrev_b32 v7, 2
    v_cmp_eq_u32 vcc, 0, v6
    s_add_u32 s54, s58, 0
    s_nop 0
    v_cndmask_b32 v148, v8, v7, vcc
    v_cmp_eq_u32 vcc, 1, v6
    s_add_u32 s55, s58, 16384
    s_nop 0
    v_cndmask_b32 v149, v8, v7, vcc
    v_cmp_eq_u32 vcc, 2, v6
    s_add_u32 s56, s58, 32768
    s_nop 0
    v_cndmask_b32 v150, v8, v7, vcc
    v_cmp_eq_u32 vcc, 3, v6
    s_add_u32 s57, s58, 49152
    s_nop 0
    v_cndmask_b32 v151, v8, v7, vcc
    s_lshl_b32 s64, s34, 2
    s_add_u32 s64, s64, s3
    s_lshl_b32 s64, s64, 7
    s_add_u32 s64, s64, 0x150000
    v_mov_b32 v152, 1
    s_mov_b64 exec, 1
    buffer_atomic_add v152, v2, s[36:39], s64 offen sc0 sc1
    s_mov_b64 exec, -1
    s_waitcnt lgkmcnt(0)
    ds_read_b128 v[220:223], v9 offset:640
    ds_read_b128 v[224:227], v9 offset:704
    ds_read_b128 v[228:231], v9 offset:1664
    ds_read_b128 v[232:235], v9 offset:1728
    v_pk_fma_f32 v[160:161], v[204:205], v[10:11], v[212:213] op_sel:[0,1,0] op_sel_hi:[1,1,1]
    v_pk_fma_f32 v[162:163], v[206:207], v[10:11], v[214:215] op_sel:[0,1,0] op_sel_hi:[1,1,1]
    v_pk_fma_f32 v[164:165], v[204:205], v[12:13], v[212:213] op_sel:[0,1,0] op_sel_hi:[1,1,1]
    v_pk_fma_f32 v[166:167], v[206:207], v[12:13], v[214:215] op_sel:[0,1,0] op_sel_hi:[1,1,1]
    v_pk_fma_f32 v[168:169], v[208:209], v[10:11], v[216:217] op_sel:[0,1,0] op_sel_hi:[1,1,1]
    v_pk_fma_f32 v[170:171], v[210:211], v[10:11], v[218:219] op_sel:[0,1,0] op_sel_hi:[1,1,1]
    v_pk_fma_f32 v[172:173], v[208:209], v[12:13], v[216:217] op_sel:[0,1,0] op_sel_hi:[1,1,1]
    v_pk_fma_f32 v[174:175], v[210:211], v[12:13], v[218:219] op_sel:[0,1,0] op_sel_hi:[1,1,1]
    v_pk_fma_f32 v[80:81], v[80:81], v[10:11], v[160:161] op_sel_hi:[1,0,1]
    v_pk_fma_f32 v[82:83], v[82:83], v[10:11], v[162:163] op_sel_hi:[1,0,1]
    v_pk_fma_f32 v[84:85], v[84:85], v[12:13], v[164:165] op_sel_hi:[1,0,1]
    v_pk_fma_f32 v[86:87], v[86:87], v[12:13], v[166:167] op_sel_hi:[1,0,1]
    v_pk_fma_f32 v[88:89], v[88:89], v[10:11], v[168:169] op_sel_hi:[1,0,1]
    v_pk_fma_f32 v[90:91], v[90:91], v[10:11], v[170:171] op_sel_hi:[1,0,1]
    v_pk_fma_f32 v[92:93], v[92:93], v[12:13], v[172:173] op_sel_hi:[1,0,1]
    v_pk_fma_f32 v[94:95], v[94:95], v[12:13], v[174:175] op_sel_hi:[1,0,1]
    v_pk_mul_f32 v[160:161], v[80:81], v[80:81]
    v_pk_mul_f32 v[162:163], v[82:83], v[82:83]
    v_pk_mul_f32 v[164:165], v[84:85], v[84:85]
    v_pk_mul_f32 v[166:167], v[86:87], v[86:87]
    v_pk_mul_f32 v[168:169], v[88:89], v[88:89]
    v_pk_mul_f32 v[170:171], v[90:91], v[90:91]
    v_pk_mul_f32 v[172:173], v[92:93], v[92:93]
    v_pk_mul_f32 v[174:175], v[94:95], v[94:95]
    v_pk_fma_f32 v[160:161], v[160:161], v[4:5], v[4:5] op_sel:[0,1,0] op_sel_hi:[1,1,0]
    v_pk_fma_f32 v[162:163], v[162:163], v[4:5], v[4:5] op_sel:[0,1,0] op_sel_hi:[1,1,0]
    v_pk_fma_f32 v[164:165], v[164:165], v[4:5], v[4:5] op_sel:[0,1,0] op_sel_hi:[1,1,0]
    v_pk_fma_f32 v[166:167], v[166:167], v[4:5], v[4:5] op_sel:[0,1,0] op_sel_hi:[1,1,0]
    v_pk_fma_f32 v[168:169], v[168:169], v[4:5], v[4:5] op_sel:[0,1,0] op_sel_hi:[1,1,0]
    v_pk_fma_f32 v[170:171], v[170:171], v[4:5], v[4:5] op_sel:[0,1,0] op_sel_hi:[1,1,0]
    v_pk_fma_f32 v[172:173], v[172:173], v[4:5], v[4:5] op_sel:[0,1,0] op_sel_hi:[1,1,0]
    v_pk_fma_f32 v[174:175], v[174:175], v[4:5], v[4:5] op_sel:[0,1,0] op_sel_hi:[1,1,0]
    v_pk_mul_f32 v[160:161], v[160:161], v[80:81]
    v_pk_mul_f32 v[162:163], v[162:163], v[82:83]
    v_pk_mul_f32 v[164:165], v[164:165], v[84:85]
    v_pk_mul_f32 v[166:167], v[166:167], v[86:87]
    v_pk_mul_f32 v[168:169], v[168:169], v[88:89]
    v_pk_mul_f32 v[170:171], v[170:171], v[90:91]
    v_pk_mul_f32 v[172:173], v[172:173], v[92:93]
    v_pk_mul_f32 v[174:175], v[174:175], v[94:95]
    v_exp_f32 v160, v160
    v_exp_f32 v161, v161
    v_exp_f32 v162, v162
    v_exp_f32 v163, v163
    v_exp_f32 v164, v164
    v_exp_f32 v165, v165
    v_exp_f32 v166, v166
    v_exp_f32 v167, v167
    v_exp_f32 v168, v168
    v_exp_f32 v169, v169
    v_exp_f32 v170, v170
    v_exp_f32 v171, v171
    v_exp_f32 v172, v172
    v_exp_f32 v173, v173
    v_exp_f32 v174, v174
    v_exp_f32 v175, v175
    v_pk_add_f32 v[160:161], v[160:161], 1.0 op_sel_hi:[1,0]
    v_pk_add_f32 v[162:163], v[162:163], 1.0 op_sel_hi:[1,0]
    v_pk_add_f32 v[164:165], v[164:165], 1.0 op_sel_hi:[1,0]
    v_pk_add_f32 v[166:167], v[166:167], 1.0 op_sel_hi:[1,0]
    v_pk_add_f32 v[168:169], v[168:169], 1.0 op_sel_hi:[1,0]
    v_pk_add_f32 v[170:171], v[170:171], 1.0 op_sel_hi:[1,0]
    v_pk_add_f32 v[172:173], v[172:173], 1.0 op_sel_hi:[1,0]
    v_pk_add_f32 v[174:175], v[174:175], 1.0 op_sel_hi:[1,0]
    v_rcp_f32 v160, v160
    v_rcp_f32 v161, v161
    v_rcp_f32 v162, v162
    v_rcp_f32 v163, v163
    v_rcp_f32 v164, v164
    v_rcp_f32 v165, v165
    v_rcp_f32 v166, v166
    v_rcp_f32 v167, v167
    v_rcp_f32 v168, v168
    v_rcp_f32 v169, v169
    v_rcp_f32 v170, v170
    v_rcp_f32 v171, v171
    v_rcp_f32 v172, v172
    v_rcp_f32 v173, v173
    v_rcp_f32 v174, v174
    v_rcp_f32 v175, v175
    v_pk_mul_f32 v[80:81], v[80:81], v[160:161]
    v_pk_mul_f32 v[82:83], v[82:83], v[162:163]
    v_pk_mul_f32 v[84:85], v[84:85], v[164:165]
    v_pk_mul_f32 v[86:87], v[86:87], v[166:167]
    v_pk_mul_f32 v[88:89], v[88:89], v[168:169]
    v_pk_mul_f32 v[90:91], v[90:91], v[170:171]
    v_pk_mul_f32 v[92:93], v[92:93], v[172:173]
    v_pk_mul_f32 v[94:95], v[94:95], v[174:175]
    s_waitcnt vmcnt(0)
    v_readfirstlane_b32 s65, v152
    s_cmp_eq_u32 s65, 14
    s_cbranch_scc1 L_mainc_h1
    v_mov_b32 v152, 0
    s_mov_b64 exec, 1
    buffer_atomic_add v152, v2, s[36:39], s64 offen sc0 sc1
    s_mov_b64 exec, -1
    s_branch L_mainc_h2
L_mainc_h1:
    buffer_load_dwordx2 v[128:129], v148, s[36:39], s54 offen sc1
    buffer_load_dwordx2 v[136:137], v148, s[36:39], s54 offen offset:128 sc1
    buffer_load_dwordx2 v[130:131], v149, s[36:39], s55 offen sc1
    buffer_load_dwordx2 v[138:139], v149, s[36:39], s55 offen offset:128 sc1
    buffer_load_dwordx2 v[132:133], v150, s[36:39], s56 offen sc1
    buffer_load_dwordx2 v[140:141], v150, s[36:39], s56 offen offset:128 sc1
    buffer_load_dwordx2 v[134:135], v151, s[36:39], s57 offen sc1
    buffer_load_dwordx2 v[142:143], v151, s[36:39], s57 offen offset:128 sc1
L_mainc_h2:
    s_waitcnt lgkmcnt(0)
    ds_read_b128 v[204:207], v9 offset:768
    ds_read_b128 v[208:211], v9 offset:832
    ds_read_b128 v[212:215], v9 offset:1792
    ds_read_b128 v[216:219], v9 offset:1856
    v_pk_fma_f32 v[160:161], v[220:221], v[10:11], v[228:229] op_sel:[0,1,0] op_sel_hi:[1,1,1]
    v_pk_fma_f32 v[162:163], v[222:223], v[10:11], v[230:231] op_sel:[0,1,0] op_sel_hi:[1,1,1]
    v_pk_fma_f32 v[164:165], v[220:221], v[12:13], v[228:229] op_sel:[0,1,0] op_sel_hi:[1,1,1]
    v_pk_fma_f32 v[166:167], v[222:223], v[12:13], v[230:231] op_sel:[0,1,0] op_sel_hi:[1,1,1]
    v_pk_fma_f32 v[168:169], v[224:225], v[10:11], v[232:233] op_sel:[0,1,0] op_sel_hi:[1,1,1]
    v_pk_fma_f32 v[170:171], v[226:227], v[10:11], v[234:235] op_sel:[0,1,0] op_sel_hi:[1,1,1]
    v_pk_fma_f32 v[172:173], v[224:225], v[12:13], v[232:233] op_sel:[0,1,0] op_sel_hi:[1,1,1]
    v_pk_fma_f32 v[174:175], v[226:227], v[12:13], v[234:235] op_sel:[0,1,0] op_sel_hi:[1,1,1]
    v_pk_fma_f32 v[96:97], v[96:97], v[10:11], v[160:161] op_sel_hi:[1,0,1]
    v_pk_fma_f32 v[98:99], v[98:99], v[10:11], v[162:163] op_sel_hi:[1,0,1]
    v_pk_fma_f32 v[100:101], v[100:101], v[12:13], v[164:165] op_sel_hi:[1,0,1]
    v_pk_fma_f32 v[102:103], v[102:103], v[12:13], v[166:167] op_sel_hi:[1,0,1]
    v_pk_fma_f32 v[104:105], v[104:105], v[10:11], v[168:169] op_sel_hi:[1,0,1]
    v_pk_fma_f32 v[106:107], v[106:107], v[10:11], v[170:171] op_sel_hi:[1,0,1]
    v_pk_fma_f32 v[108:109], v[108:109], v[12:13], v[172:173] op_sel_hi:[1,0,1]
    v_pk_fma_f32 v[110:111], v[110:111], v[12:13], v[174:175] op_sel_hi:[1,0,1]
    v_pk_mul_f32 v[160:161], v[96:97], v[96:97]
    v_pk_mul_f32 v[162:163], v[98:99], v[98:99]
    v_pk_mul_f32 v[164:165], v[100:101], v[100:101]
    v_pk_mul_f32 v[166:167], v[102:103], v[102:103]
    v_pk_mul_f32 v[168:169], v[104:105], v[104:105]
    v_pk_mul_f32 v[170:171], v[106:107], v[106:107]
    v_pk_mul_f32 v[172:173], v[108:109], v[108:109]
    v_pk_mul_f32 v[174:175], v[110:111], v[110:111]
    v_pk_fma_f32 v[160:161], v[160:161], v[4:5], v[4:5] op_sel:[0,1,0] op_sel_hi:[1,1,0]
    v_pk_fma_f32 v[162:163], v[162:163], v[4:5], v[4:5] op_sel:[0,1,0] op_sel_hi:[1,1,0]
    v_pk_fma_f32 v[164:165], v[164:165], v[4:5], v[4:5] op_sel:[0,1,0] op_sel_hi:[1,1,0]
    v_pk_fma_f32 v[166:167], v[166:167], v[4:5], v[4:5] op_sel:[0,1,0] op_sel_hi:[1,1,0]
    v_pk_fma_f32 v[168:169], v[168:169], v[4:5], v[4:5] op_sel:[0,1,0] op_sel_hi:[1,1,0]
    v_pk_fma_f32 v[170:171], v[170:171], v[4:5], v[4:5] op_sel:[0,1,0] op_sel_hi:[1,1,0]
    v_pk_fma_f32 v[172:173], v[172:173], v[4:5], v[4:5] op_sel:[0,1,0] op_sel_hi:[1,1,0]
    v_pk_fma_f32 v[174:175], v[174:175], v[4:5], v[4:5] op_sel:[0,1,0] op_sel_hi:[1,1,0]
    v_pk_mul_f32 v[160:161], v[160:161], v[96:97]
    v_pk_mul_f32 v[162:163], v[162:163], v[98:99]
    v_pk_mul_f32 v[164:165], v[164:165], v[100:101]
    v_pk_mul_f32 v[166:167], v[166:167], v[102:103]
    v_pk_mul_f32 v[168:169], v[168:169], v[104:105]
    v_pk_mul_f32 v[170:171], v[170:171], v[106:107]
    v_pk_mul_f32 v[172:173], v[172:173], v[108:109]
    v_pk_mul_f32 v[174:175], v[174:175], v[110:111]
    v_exp_f32 v160, v160
    v_exp_f32 v161, v161
    v_exp_f32 v162, v162
    v_exp_f32 v163, v163
    v_exp_f32 v164, v164
    v_exp_f32 v165, v165
    v_exp_f32 v166, v166
    v_exp_f32 v167, v167
    v_exp_f32 v168, v168
    v_exp_f32 v169, v169
    v_exp_f32 v170, v170
    v_exp_f32 v171, v171
    v_exp_f32 v172, v172
    v_exp_f32 v173, v173
    v_exp_f32 v174, v174
    v_exp_f32 v175, v175
    v_pk_add_f32 v[160:161], v[160:161], 1.0 op_sel_hi:[1,0]
    v_pk_add_f32 v[162:163], v[162:163], 1.0 op_sel_hi:[1,0]
    v_pk_add_f32 v[164:165], v[164:165], 1.0 op_sel_hi:[1,0]
    v_pk_add_f32 v[166:167], v[166:167], 1.0 op_sel_hi:[1,0]
    v_pk_add_f32 v[168:169], v[168:169], 1.0 op_sel_hi:[1,0]
    v_pk_add_f32 v[170:171], v[170:171], 1.0 op_sel_hi:[1,0]
    v_pk_add_f32 v[172:173], v[172:173], 1.0 op_sel_hi:[1,0]
    v_pk_add_f32 v[174:175], v[174:175], 1.0 op_sel_hi:[1,0]
    v_rcp_f32 v160, v160
    v_rcp_f32 v161, v161
    v_rcp_f32 v162, v162
    v_rcp_f32 v163, v163
    v_rcp_f32 v164, v164
    v_rcp_f32 v165, v165
    v_rcp_f32 v166, v166
    v_rcp_f32 v167, v167
    v_rcp_f32 v168, v168
    v_rcp_f32 v169, v169
    v_rcp_f32 v170, v170
    v_rcp_f32 v171, v171
    v_rcp_f32 v172, v172
    v_rcp_f32 v173, v173
    v_rcp_f32 v174, v174
    v_rcp_f32 v175, v175
    v_pk_mul_f32 v[96:97], v[96:97], v[160:161]
    v_pk_mul_f32 v[98:99], v[98:99], v[162:163]
    v_pk_mul_f32 v[100:101], v[100:101], v[164:165]
    v_pk_mul_f32 v[102:103], v[102:103], v[166:167]
    v_pk_mul_f32 v[104:105], v[104:105], v[168:169]
    v_pk_mul_f32 v[106:107], v[106:107], v[170:171]
    v_pk_mul_f32 v[108:109], v[108:109], v[172:173]
    v_pk_mul_f32 v[110:111], v[110:111], v[174:175]
    s_cmp_eq_u32 s65, 14
    s_cbranch_scc1 L_mainc_h4
    s_mov_b32 s53, 0x8000
L_mainc_h3:
    s_waitcnt vmcnt(0)
    v_readfirstlane_b32 s65, v152
    s_sub_u32 s53, s53, 1
    s_cbranch_scc1 L_mainc_h5
    s_cmp_eq_u32 s65, 15
    s_cbranch_scc1 L_mainc_h5
    v_mov_b32 v152, 0
    s_mov_b64 exec, 1
    buffer_atomic_add v152, v2, s[36:39], s64 offen sc0 sc1
    s_mov_b64 exec, -1
    s_branch L_mainc_h3
L_mainc_h5:
    buffer_load_dwordx2 v[128:129], v148, s[36:39], s54 offen sc1
    buffer_load_dwordx2 v[136:137], v148, s[36:39], s54 offen offset:128 sc1
    buffer_load_dwordx2 v[130:131], v149, s[36:39], s55 offen sc1
    buffer_load_dwordx2 v[138:139], v149, s[36:39], s55 offen offset:128 sc1
    buffer_load_dwordx2 v[132:133], v150, s[36:39], s56 offen sc1
    buffer_load_dwordx2 v[140:141], v150, s[36:39], s56 offen offset:128 sc1
    buffer_load_dwordx2 v[134:135], v151, s[36:39], s57 offen sc1
    buffer_load_dwordx2 v[142:143], v151, s[36:39], s57 offen offset:128 sc1
L_mainc_h4:
    v_bfe_u32 v7, v1, 2, 2
    v_lshlrev_b32 v7, 8, v7
    v_lshrrev_b32 v6, 4, v1
    v_lshl_add_u32 v7, v6, 6, v7
    v_and_b32 v6, 3, v1
    v_lshl_add_u32 v7, v6, 4, v7
    s_mul_i32 s52, s78, 114688
    s_lshl_b32 s53, s60, 11
    s_add_u32 s59, s52, s53
    s_add_u32 s59, s59, 0x1500000
    s_mov_b32 s53, 0x8000
    s_waitcnt vmcnt(0)
    s_branch L_mainc_psc
L_mainc_ps:
    buffer_load_dwordx2 v[128:129], v148, s[36:39], s54 offen sc1
    buffer_load_dwordx2 v[136:137], v148, s[36:39], s54 offen offset:128 sc1
    buffer_load_dwordx2 v[130:131], v149, s[36:39], s55 offen sc1
    buffer_load_dwordx2 v[138:139], v149, s[36:39], s55 offen offset:128 sc1
    buffer_load_dwordx2 v[132:133], v150, s[36:39], s56 offen sc1
    buffer_load_dwordx2 v[140:141], v150, s[36:39], s56 offen offset:128 sc1
    buffer_load_dwordx2 v[134:135], v151, s[36:39], s57 offen sc1
    buffer_load_dwordx2 v[142:143], v151, s[36:39], s57 offen offset:128 sc1
    s_waitcnt vmcnt(0)
L_mainc_psc:
    v_or_b32 v6, v129, v131
    v_or3_b32 v6, v6, v133, v135
    v_or3_b32 v6, v6, v137, v139
    v_or3_b32 v6, v6, v141, v143
    v_and_b32 v6, 1, v6
    v_cmp_ne_u32 vcc, 0, v6
    s_sub_u32 s53, s53, 1
    s_cbranch_scc1 L_mainc_psx
    s_cbranch_vccnz L_mainc_ps
L_mainc_psx:
    s_mov_b64 exec, -1
    v_pk_add_f32 v[128:129], v[128:129], v[130:131]
    v_pk_add_f32 v[136:137], v[136:137], v[138:139]
    v_pk_add_f32 v[132:133], v[132:133], v[134:135]
    v_pk_add_f32 v[140:141], v[140:141], v[142:143]
    v_pk_add_f32 v[128:129], v[128:129], v[132:133]
    v_pk_add_f32 v[136:137], v[136:137], v[140:141]
    v_mov_b32 v192, v128
    v_mov_b32 v193, v129
    v_mov_b32 v194, v136
    v_mov_b32 v195, v137
    s_nop 0
    v_permlane16_swap_b32 v192, v128
    v_permlane16_swap_b32 v193, v129
    v_permlane16_swap_b32 v194, v136
    v_permlane16_swap_b32 v195, v137
    s_nop 0
    v_add_f32 v128, v128, v192
    v_add_f32 v129, v129, v193
    v_add_f32 v136, v136, v194
    v_add_f32 v137, v137, v195
    v_mov_b32 v192, v128
    v_mov_b32 v193, v129
    v_mov_b32 v194, v136
    v_mov_b32 v195, v137
    s_nop 0
    v_permlane32_swap_b32 v192, v128
    v_permlane32_swap_b32 v193, v129
    v_permlane32_swap_b32 v194, v136
    v_permlane32_swap_b32 v195, v137
    s_nop 0
    v_add_f32 v128, v128, v192
    v_add_f32 v129, v129, v193
    v_add_f32 v136, v136, v194
    v_add_f32 v137, v137, v195
    v_pk_add_f32 v[128:129], v[128:129], v[200:201]
    v_pk_add_f32 v[136:137], v[136:137], v[202:203]
    v_mul_f32 v128, 0xba124925, v128
    v_mul_f32 v129, 0x3a124925, v129
    v_mul_f32 v136, 0xba124925, v136
    v_mul_f32 v137, 0x3a124925, v137
    v_fma_f32 v129, -v128, v128, v129
    v_max_f32 v129, 0, v129
    v_add_f32 v129, 0x3727c5ac, v129
    v_fma_f32 v137, -v136, v136, v137
    v_max_f32 v137, 0, v137
    v_add_f32 v137, 0x3727c5ac, v137
    v_rsq_f32 v144, v129
    v_rsq_f32 v146, v137
    s_nop 0
    v_mul_f32 v145, v128, v144
    v_mul_f32 v147, v136, v146
    v_pk_fma_f32 v[16:17], v[16:17], v[144:145], v[144:145] op_sel:[0,0,1] op_sel_hi:[1,0,1]
    v_pk_fma_f32 v[18:19], v[18:19], v[144:145], v[144:145] op_sel:[0,0,1] op_sel_hi:[1,0,1]
    v_pk_fma_f32 v[20:21], v[20:21], v[146:147], v[146:147] op_sel:[0,0,1] op_sel_hi:[1,0,1]
    v_pk_fma_f32 v[22:23], v[22:23], v[146:147], v[146:147] op_sel:[0,0,1] op_sel_hi:[1,0,1]
    v_cvt_pk_bf16_f32 v176, v16, v17
    v_cvt_pk_bf16_f32 v177, v18, v19
    v_cvt_pk_bf16_f32 v178, v20, v21
    v_cvt_pk_bf16_f32 v179, v22, v23
    buffer_store_dwordx4 v[176:179], v7, s[36:39], s59 offen offset:0 sc1
    v_pk_fma_f32 v[24:25], v[24:25], v[144:145], v[144:145] op_sel:[0,0,1] op_sel_hi:[1,0,1]
    v_pk_fma_f32 v[26:27], v[26:27], v[144:145], v[144:145] op_sel:[0,0,1] op_sel_hi:[1,0,1]
    v_pk_fma_f32 v[28:29], v[28:29], v[146:147], v[146:147] op_sel:[0,0,1] op_sel_hi:[1,0,1]
    v_pk_fma_f32 v[30:31], v[30:31], v[146:147], v[146:147] op_sel:[0,0,1] op_sel_hi:[1,0,1]
    v_cvt_pk_bf16_f32 v180, v24, v25
    v_cvt_pk_bf16_f32 v181, v26, v27
    v_cvt_pk_bf16_f32 v182, v28, v29
    v_cvt_pk_bf16_f32 v183, v30, v31
    buffer_store_dwordx4 v[180:183], v7, s[36:39], s59 offen offset:1024 sc1
    s_add_u32 s59, s59, 2048
    v_pk_fma_f32 v[32:33], v[32:33], v[144:145], v[144:145] op_sel:[0,0,1] op_sel_hi:[1,0,1]
    v_pk_fma_f32 v[34:35], v[34:35], v[144:145], v[144:145] op_sel:[0,0,1] op_sel_hi:[1,0,1]
    v_pk_fma_f32 v[36:37], v[36:37], v[146:147], v[146:147] op_sel:[0,0,1] op_sel_hi:[1,0,1]
    v_pk_fma_f32 v[38:39], v[38:39], v[146:147], v[146:147] op_sel:[0,0,1] op_sel_hi:[1,0,1]
    v_cvt_pk_bf16_f32 v184, v32, v33
    v_cvt_pk_bf16_f32 v185, v34, v35
    v_cvt_pk_bf16_f32 v186, v36, v37
    v_cvt_pk_bf16_f32 v187, v38, v39
    buffer_store_dwordx4 v[184:187], v7, s[36:39], s59 offen offset:0 sc1
    v_pk_fma_f32 v[40:41], v[40:41], v[144:145], v[144:145] op_sel:[0,0,1] op_sel_hi:[1,0,1]
    v_pk_fma_f32 v[42:43], v[42:43], v[144:145], v[144:145] op_sel:[0,0,1] op_sel_hi:[1,0,1]
    v_pk_fma_f32 v[44:45], v[44:45], v[146:147], v[146:147] op_sel:[0,0,1] op_sel_hi:[1,0,1]
    v_pk_fma_f32 v[46:47], v[46:47], v[146:147], v[146:147] op_sel:[0,0,1] op_sel_hi:[1,0,1]
    v_cvt_pk_bf16_f32 v188, v40, v41
    v_cvt_pk_bf16_f32 v189, v42, v43
    v_cvt_pk_bf16_f32 v190, v44, v45
    v_cvt_pk_bf16_f32 v191, v46, v47
    buffer_store_dwordx4 v[188:191], v7, s[36:39], s59 offen offset:1024 sc1
    s_add_u32 s59, s59, 2048
    v_pk_fma_f32 v[48:49], v[48:49], v[144:145], v[144:145] op_sel:[0,0,1] op_sel_hi:[1,0,1]
    v_pk_fma_f32 v[50:51], v[50:51], v[144:145], v[144:145] op_sel:[0,0,1] op_sel_hi:[1,0,1]
    v_pk_fma_f32 v[52:53], v[52:53], v[146:147], v[146:147] op_sel:[0,0,1] op_sel_hi:[1,0,1]
    v_pk_fma_f32 v[54:55], v[54:55], v[146:147], v[146:147] op_sel:[0,0,1] op_sel_hi:[1,0,1]
    v_cvt_pk_bf16_f32 v176, v48, v49
    v_cvt_pk_bf16_f32 v177, v50, v51
    v_cvt_pk_bf16_f32 v178, v52, v53
    v_cvt_pk_bf16_f32 v179, v54, v55
    buffer_store_dwordx4 v[176:179], v7, s[36:39], s59 offen offset:0 sc1
    v_pk_fma_f32 v[56:57], v[56:57], v[144:145], v[144:145] op_sel:[0,0,1] op_sel_hi:[1,0,1]
    v_pk_fma_f32 v[58:59], v[58:59], v[144:145], v[144:145] op_sel:[0,0,1] op_sel_hi:[1,0,1]
    v_pk_fma_f32 v[60:61], v[60:61], v[146:147], v[146:147] op_sel:[0,0,1] op_sel_hi:[1,0,1]
    v_pk_fma_f32 v[62:63], v[62:63], v[146:147], v[146:147] op_sel:[0,0,1] op_sel_hi:[1,0,1]
    v_cvt_pk_bf16_f32 v180, v56, v57
    v_cvt_pk_bf16_f32 v181, v58, v59
    v_cvt_pk_bf16_f32 v182, v60, v61
    v_cvt_pk_bf16_f32 v183, v62, v63
    buffer_store_dwordx4 v[180:183], v7, s[36:39], s59 offen offset:1024 sc1
    s_add_u32 s59, s59, 2048
    s_cmp_eq_u32 s63, 0
    s_cbranch_scc0 L_mainc_s4
    v_pk_fma_f32 v[64:65], v[64:65], v[144:145], v[144:145] op_sel:[0,0,1] op_sel_hi:[1,0,1]
    v_pk_fma_f32 v[66:67], v[66:67], v[144:145], v[144:145] op_sel:[0,0,1] op_sel_hi:[1,0,1]
    v_pk_fma_f32 v[68:69], v[68:69], v[146:147], v[146:147] op_sel:[0,0,1] op_sel_hi:[1,0,1]
    v_pk_fma_f32 v[70:71], v[70:71], v[146:147], v[146:147] op_sel:[0,0,1] op_sel_hi:[1,0,1]
    v_cvt_pk_bf16_f32 v184, v64, v65
    v_cvt_pk_bf16_f32 v185, v66, v67
    v_cvt_pk_bf16_f32 v186, v68, v69
    v_cvt_pk_bf16_f32 v187, v70, v71
    buffer_store_dwordx4 v[184:187], v7, s[36:39], s59 offen offset:0 sc1
    v_pk_fma_f32 v[72:73], v[72:73], v[144:145], v[144:145] op_sel:[0,0,1] op_sel_hi:[1,0,1]
    v_pk_fma_f32 v[74:75], v[74:75], v[144:145], v[144:145] op_sel:[0,0,1] op_sel_hi:[1,0,1]
    v_pk_fma_f32 v[76:77], v[76:77], v[146:147], v[146:147] op_sel:[0,0,1] op_sel_hi:[1,0,1]
    v_pk_fma_f32 v[78:79], v[78:79], v[146:147], v[146:147] op_sel:[0,0,1] op_sel_hi:[1,0,1]
    v_cvt_pk_bf16_f32 v188, v72, v73
    v_cvt_pk_bf16_f32 v189, v74, v75
    v_cvt_pk_bf16_f32 v190, v76, v77
    v_cvt_pk_bf16_f32 v191, v78, v79
    buffer_store_dwordx4 v[188:191], v7, s[36:39], s59 offen offset:1024 sc1
    s_add_u32 s59, s59, 2048
L_mainc_s4:
    s_waitcnt lgkmcnt(0)
    v_pk_fma_f32 v[160:161], v[204:205], v[10:11], v[212:213] op_sel:[0,1,0] op_sel_hi:[1,1,1]
    v_pk_fma_f32 v[162:163], v[206:207], v[10:11], v[214:215] op_sel:[0,1,0] op_sel_hi:[1,1,1]
    v_pk_fma_f32 v[164:165], v[204:205], v[12:13], v[212:213] op_sel:[0,1,0] op_sel_hi:[1,1,1]
    v_pk_fma_f32 v[166:167], v[206:207], v[12:13], v[214:215] op_sel:[0,1,0] op_sel_hi:[1,1,1]
    v_pk_fma_f32 v[168:169], v[208:209], v[10:11], v[216:217] op_sel:[0,1,0] op_sel_hi:[1,1,1]
    v_pk_fma_f32 v[170:171], v[210:211], v[10:11], v[218:219] op_sel:[0,1,0] op_sel_hi:[1,1,1]
    v_pk_fma_f32 v[172:173], v[208:209], v[12:13], v[216:217] op_sel:[0,1,0] op_sel_hi:[1,1,1]
    v_pk_fma_f32 v[174:175], v[210:211], v[12:13], v[218:219] op_sel:[0,1,0] op_sel_hi:[1,1,1]
    v_pk_fma_f32 v[112:113], v[112:113], v[10:11], v[160:161] op_sel_hi:[1,0,1]
    v_pk_fma_f32 v[114:115], v[114:115], v[10:11], v[162:163] op_sel_hi:[1,0,1]
    v_pk_fma_f32 v[116:117], v[116:117], v[12:13], v[164:165] op_sel_hi:[1,0,1]
    v_pk_fma_f32 v[118:119], v[118:119], v[12:13], v[166:167] op_sel_hi:[1,0,1]
    v_pk_fma_f32 v[120:121], v[120:121], v[10:11], v[168:169] op_sel_hi:[1,0,1]
    v_pk_fma_f32 v[122:123], v[122:123], v[10:11], v[170:171] op_sel_hi:[1,0,1]
    v_pk_fma_f32 v[124:125], v[124:125], v[12:13], v[172:173] op_sel_hi:[1,0,1]
    v_pk_fma_f32 v[126:127], v[126:127], v[12:13], v[174:175] op_sel_hi:[1,0,1]
    v_pk_mul_f32 v[160:161], v[112:113], v[112:113]
    v_pk_mul_f32 v[162:163], v[114:115], v[114:115]
    v_pk_mul_f32 v[164:165], v[116:117], v[116:117]
    v_pk_mul_f32 v[166:167], v[118:119], v[118:119]
    v_pk_mul_f32 v[168:169], v[120:121], v[120:121]
    v_pk_mul_f32 v[170:171], v[122:123], v[122:123]
    v_pk_mul_f32 v[172:173], v[124:125], v[124:125]
    v_pk_mul_f32 v[174:175], v[126:127], v[126:127]
    v_pk_fma_f32 v[160:161], v[160:161], v[4:5], v[4:5] op_sel:[0,1,0] op_sel_hi:[1,1,0]
    v_pk_fma_f32 v[162:163], v[162:163], v[4:5], v[4:5] op_sel:[0,1,0] op_sel_hi:[1,1,0]
    v_pk_fma_f32 v[164:165], v[164:165], v[4:5], v[4:5] op_sel:[0,1,0] op_sel_hi:[1,1,0]
    v_pk_fma_f32 v[166:167], v[166:167], v[4:5], v[4:5] op_sel:[0,1,0] op_sel_hi:[1,1,0]
    v_pk_fma_f32 v[168:169], v[168:169], v[4:5], v[4:5] op_sel:[0,1,0] op_sel_hi:[1,1,0]
    v_pk_fma_f32 v[170:171], v[170:171], v[4:5], v[4:5] op_sel:[0,1,0] op_sel_hi:[1,1,0]
    v_pk_fma_f32 v[172:173], v[172:173], v[4:5], v[4:5] op_sel:[0,1,0] op_sel_hi:[1,1,0]
    v_pk_fma_f32 v[174:175], v[174:175], v[4:5], v[4:5] op_sel:[0,1,0] op_sel_hi:[1,1,0]
    v_pk_mul_f32 v[160:161], v[160:161], v[112:113]
    v_pk_mul_f32 v[162:163], v[162:163], v[114:115]
    v_pk_mul_f32 v[164:165], v[164:165], v[116:117]
    v_pk_mul_f32 v[166:167], v[166:167], v[118:119]
    v_pk_mul_f32 v[168:169], v[168:169], v[120:121]
    v_pk_mul_f32 v[170:171], v[170:171], v[122:123]
    v_pk_mul_f32 v[172:173], v[172:173], v[124:125]
    v_pk_mul_f32 v[174:175], v[174:175], v[126:127]
    v_exp_f32 v160, v160
    v_exp_f32 v161, v161
    v_exp_f32 v162, v162
    v_exp_f32 v163, v163
    v_exp_f32 v164, v164
    v_exp_f32 v165, v165
    v_exp_f32 v166, v166
    v_exp_f32 v167, v167
    v_exp_f32 v168, v168
    v_exp_f32 v169, v169
    v_exp_f32 v170, v170
    v_exp_f32 v171, v171
    v_exp_f32 v172, v172
    v_exp_f32 v173, v173
    v_exp_f32 v174, v174
    v_exp_f32 v175, v175
    v_pk_add_f32 v[160:161], v[160:161], 1.0 op_sel_hi:[1,0]
    v_pk_add_f32 v[162:163], v[162:163], 1.0 op_sel_hi:[1,0]
    v_pk_add_f32 v[164:165], v[164:165], 1.0 op_sel_hi:[1,0]
    v_pk_add_f32 v[166:167], v[166:167], 1.0 op_sel_hi:[1,0]
    v_pk_add_f32 v[168:169], v[168:169], 1.0 op_sel_hi:[1,0]
    v_pk_add_f32 v[170:171], v[170:171], 1.0 op_sel_hi:[1,0]
    v_pk_add_f32 v[172:173], v[172:173], 1.0 op_sel_hi:[1,0]
    v_pk_add_f32 v[174:175], v[174:175], 1.0 op_sel_hi:[1,0]
    v_rcp_f32 v160, v160
    v_rcp_f32 v161, v161
    v_rcp_f32 v162, v162
    v_rcp_f32 v163, v163
    v_rcp_f32 v164, v164
    v_rcp_f32 v165, v165
    v_rcp_f32 v166, v166
    v_rcp_f32 v167, v167
    v_rcp_f32 v168, v168
    v_rcp_f32 v169, v169
    v_rcp_f32 v170, v170
    v_rcp_f32 v171, v171
    v_rcp_f32 v172, v172
    v_rcp_f32 v173, v173
    v_rcp_f32 v174, v174
    v_rcp_f32 v175, v175
    v_pk_mul_f32 v[112:113], v[112:113], v[160:161]
    v_pk_mul_f32 v[114:115], v[114:115], v[162:163]
    v_pk_mul_f32 v[116:117], v[116:117], v[164:165]
    v_pk_mul_f32 v[118:119], v[118:119], v[166:167]
    v_pk_mul_f32 v[120:121], v[120:121], v[168:169]
    v_pk_mul_f32 v[122:123], v[122:123], v[170:171]
    v_pk_mul_f32 v[124:125], v[124:125], v[172:173]
    v_pk_mul_f32 v[126:127], v[126:127], v[174:175]
    v_cvt_pk_bf16_f32 v128, v64, v65
    v_cvt_pk_bf16_f32 v129, v66, v67
    v_cvt_pk_bf16_f32 v130, v72, v73
    v_cvt_pk_bf16_f32 v131, v74, v75
    v_cvt_pk_bf16_f32 v132, v68, v69
    v_cvt_pk_bf16_f32 v133, v70, v71
    v_cvt_pk_bf16_f32 v134, v76, v77
    v_cvt_pk_bf16_f32 v135, v78, v79
    v_cvt_pk_bf16_f32 v136, v80, v81
    v_cvt_pk_bf16_f32 v137, v82, v83
    v_cvt_pk_bf16_f32 v138, v88, v89
    v_cvt_pk_bf16_f32 v139, v90, v91
    v_cvt_pk_bf16_f32 v140, v84, v85
    v_cvt_pk_bf16_f32 v141, v86, v87
    v_cvt_pk_bf16_f32 v142, v92, v93
    v_cvt_pk_bf16_f32 v143, v94, v95
    v_cvt_pk_bf16_f32 v144, v96, v97
    v_cvt_pk_bf16_f32 v145, v98, v99
    v_cvt_pk_bf16_f32 v146, v104, v105
    v_cvt_pk_bf16_f32 v147, v106, v107
    v_cvt_pk_bf16_f32 v148, v100, v101
    v_cvt_pk_bf16_f32 v149, v102, v103
    v_cvt_pk_bf16_f32 v150, v108, v109
    v_cvt_pk_bf16_f32 v151, v110, v111
    v_cvt_pk_bf16_f32 v152, v112, v113
    v_cvt_pk_bf16_f32 v153, v114, v115
    v_cvt_pk_bf16_f32 v154, v120, v121
    v_cvt_pk_bf16_f32 v155, v122, v123
    v_cvt_pk_bf16_f32 v156, v116, v117
    v_cvt_pk_bf16_f32 v157, v118, v119
    v_cvt_pk_bf16_f32 v158, v124, v125
    v_cvt_pk_bf16_f32 v159, v126, v127
    s_lshl_b32 s52, s35, 2
    s_add_u32 s52, s52, s3
    s_lshl_b32 s52, s52, 7
    s_add_u32 s52, s52, 0x148000
    v_mov_b32 v6, 1
    s_waitcnt vmcnt(0)
    s_mov_b64 exec, 1
    buffer_atomic_add v6, v2, s[36:39], s52 offen sc1
    s_mov_b64 exec, -1
    s_and_b32 s64, s3, 1
    s_lshr_b32 s65, s3, 1
    v_lshlrev_b32 v4, 7, v3
    v_lshrrev_b32 v9, 3, v1
    v_xor_b32 v9, v9, v1
    v_and_b32 v10, 2, v9
    v_bfe_u32 v9, v9, 2, 1
    v_or_b32 v9, v9, v10
    v_bfe_u32 v10, v1, 3, 1
    v_lshl_add_u32 v9, v10, 2, v9
    v_lshl_add_u32 v4, v9, 4, v4
    s_lshl_b32 s52, s64, 13
    v_add_u32 v4, s52, v4
    v_xor_b32 v5, 64, v4
    v_lshrrev_b32 v10, 5, v1
    v_lshlrev_b32 v10, 9, v10
    v_and_b32 v11, 3, v1
    v_lshl_add_u32 v10, v11, 6, v10
    v_bfe_u32 v11, v1, 2, 2
    v_lshl_add_u32 v10, v11, 4, v10
    v_bfe_u32 v11, v1, 4, 1
    v_lshl_add_u32 v10, v11, 3, v10
    s_lshl_b32 s52, s65, 12
    s_add_u32 s53, s52, 16384
    v_add_u32 v6, s53, v10
    s_lshl_b32 s53, s64, 14
    s_add_u32 s53, s53, s52
    s_add_u32 s53, s53, 131072
    v_add_u32 v7, s53, v2
    s_lshl_b32 s53, s3, 13
    s_lshl_b32 s54, s63, 11
    s_add_u32 s53, s53, s54
    s_add_u32 s53, s53, 129024
    v_add_u32 v8, s53, v2
    s_mov_b32 s73, 15
    v_lshlrev_b32 v12, 16, v252
    v_and_b32 v13, 0xffff0000, v252
    v_lshlrev_b32 v14, 16, v253
    v_and_b32 v15, 0xffff0000, v253
    s_lshl_b32 s54, s34, 2
    s_lshl_b32 s53, s64, 1
    s_add_u32 s54, s54, s53
    s_mul_i32 s55, s54, 114688
    s_add_u32 s53, s61, s62
    s_lshl_b32 s53, s53, 11
    s_add_u32 s55, s55, s53
    s_add_u32 s55, s55, s52
    s_add_u32 s58, s55, 0x1c00000
    s_add_u32 s59, s58, 114688
    v_pk_mov_b32 v[16:17], v[12:13], v[12:13] op_sel:[0,0]
    v_pk_mov_b32 v[18:19], v[12:13], v[12:13] op_sel:[0,0]
    v_pk_mov_b32 v[20:21], v[12:13], v[12:13] op_sel:[1,1]
    v_pk_mov_b32 v[22:23], v[12:13], v[12:13] op_sel:[1,1]
    v_pk_mov_b32 v[24:25], v[14:15], v[14:15] op_sel:[0,0]
    v_pk_mov_b32 v[26:27], v[14:15], v[14:15] op_sel:[0,0]
    v_pk_mov_b32 v[28:29], v[14:15], v[14:15] op_sel:[1,1]
    v_pk_mov_b32 v[30:31], v[14:15], v[14:15] op_sel:[1,1]
    v_pk_mov_b32 v[32:33], v[12:13], v[12:13] op_sel:[0,0]
    v_pk_mov_b32 v[34:35], v[12:13], v[12:13] op_sel:[0,0]
    v_pk_mov_b32 v[36:37], v[12:13], v[12:13] op_sel:[1,1]
    v_pk_mov_b32 v[38:39], v[12:13], v[12:13] op_sel:[1,1]
    v_pk_mov_b32 v[40:41], v[14:15], v[14:15] op_sel:[0,0]
    v_pk_mov_b32 v[42:43], v[14:15], v[14:15] op_sel:[0,0]
    v_pk_mov_b32 v[44:45], v[14:15], v[14:15] op_sel:[1,1]
    v_pk_mov_b32 v[46:47], v[14:15], v[14:15] op_sel:[1,1]
    v_pk_mov_b32 v[48:49], v[12:13], v[12:13] op_sel:[0,0]
    v_pk_mov_b32 v[50:51], v[12:13], v[12:13] op_sel:[0,0]
    v_pk_mov_b32 v[52:53], v[12:13], v[12:13] op_sel:[1,1]
    v_pk_mov_b32 v[54:55], v[12:13], v[12:13] op_sel:[1,1]
    v_pk_mov_b32 v[56:57], v[14:15], v[14:15] op_sel:[0,0]
    v_pk_mov_b32 v[58:59], v[14:15], v[14:15] op_sel:[0,0]
    v_pk_mov_b32 v[60:61], v[14:15], v[14:15] op_sel:[1,1]
    v_pk_mov_b32 v[62:63], v[14:15], v[14:15] op_sel:[1,1]
    v_pk_mov_b32 v[64:65], v[12:13], v[12:13] op_sel:[0,0]
    v_pk_mov_b32 v[66:67], v[12:13], v[12:13] op_sel:[0,0]
    v_pk_mov_b32 v[68:69], v[12:13], v[12:13] op_sel:[1,1]
    v_pk_mov_b32 v[70:71], v[12:13], v[12:13] op_sel:[1,1]
    v_pk_mov_b32 v[72:73], v[14:15], v[14:15] op_sel:[0,0]
    v_pk_mov_b32 v[74:75], v[14:15], v[14:15] op_sel:[0,0]
    v_pk_mov_b32 v[76:77], v[14:15], v[14:15] op_sel:[1,1]
    v_pk_mov_b32 v[78:79], v[14:15], v[14:15] op_sel:[1,1]
    s_barrier
    s_cmp_eq_u32 s63, 0
    s_cbranch_scc1 L_mainc_z3
    ds_write_b128 v8, v[128:131] offset:0
    ds_write_b128 v8, v[132:135] offset:1024
L_mainc_z3:
    ds_write_b128 v8, v[136:139] offset:2048
    ds_write_b128 v8, v[140:143] offset:3072
    ds_write_b128 v8, v[144:147] offset:4096
    ds_write_b128 v8, v[148:151] offset:5120
    ds_write_b128 v8, v[152:155] offset:6144
    ds_write_b128 v8, v[156:159] offset:7168
    s_andn2_b32 s52, s65, s63
    s_waitcnt lgkmcnt(0)
    s_cbranch_scc1 L_mainn_go
    s_barrier
    s_barrier
    ds_read_b128 v[80:83], v4 offset:0
    ds_read_b64_tr_b16 v[96:97], v6 offset:0
    ds_read_b64_tr_b16 v[98:99], v6 offset:256
    ds_read_b128 v[84:87], v4 offset:2048
    ds_read_b128 v[88:91], v4 offset:4096
    ds_read_b128 v[92:95], v4 offset:6144
    ds_read_b64_tr_b16 v[100:101], v6 offset:1024
    ds_read_b64_tr_b16 v[102:103], v6 offset:1280
    ds_read_b64_tr_b16 v[104:105], v6 offset:2048
    ds_read_b64_tr_b16 v[106:107], v6 offset:2304
    ds_read_b64_tr_b16 v[108:109], v6 offset:3072
    ds_read_b64_tr_b16 v[110:111], v6 offset:3328
L_mainc_sl:
    s_waitcnt lgkmcnt(4)
    v_mfma_f32_16x16x32_bf16 v[16:19], v[96:99], v[80:83], v[16:19]
    ds_read_b128 v[112:115], v5 offset:0
    v_mfma_f32_16x16x32_bf16 v[20:23], v[96:99], v[84:87], v[20:23]
    ds_read_b64_tr_b16 v[128:129], v6 offset:8192
    v_mfma_f32_16x16x32_bf16 v[24:27], v[96:99], v[88:91], v[24:27]
    ds_read_b64_tr_b16 v[130:131], v6 offset:8448
    v_mfma_f32_16x16x32_bf16 v[28:31], v[96:99], v[92:95], v[28:31]
    ds_read_b128 v[116:119], v5 offset:2048
    v_mfma_f32_16x16x32_bf16 v[32:35], v[100:103], v[80:83], v[32:35]
    ds_read_b128 v[120:123], v5 offset:4096
    v_mfma_f32_16x16x32_bf16 v[36:39], v[100:103], v[84:87], v[36:39]
    ds_read_b128 v[124:127], v5 offset:6144
    v_mfma_f32_16x16x32_bf16 v[40:43], v[100:103], v[88:91], v[40:43]
    ds_read_b64_tr_b16 v[132:133], v6 offset:9216
    v_mfma_f32_16x16x32_bf16 v[44:47], v[100:103], v[92:95], v[44:47]
    ds_read_b64_tr_b16 v[134:135], v6 offset:9472
    s_waitcnt lgkmcnt(8)
    v_mfma_f32_16x16x32_bf16 v[48:51], v[104:107], v[80:83], v[48:51]
    ds_read_b64_tr_b16 v[136:137], v6 offset:10240
    v_mfma_f32_16x16x32_bf16 v[52:55], v[104:107], v[84:87], v[52:55]
    ds_read_b64_tr_b16 v[138:139], v6 offset:10496
    v_mfma_f32_16x16x32_bf16 v[56:59], v[104:107], v[88:91], v[56:59]
    ds_read_b64_tr_b16 v[140:141], v6 offset:11264
    v_mfma_f32_16x16x32_bf16 v[60:63], v[104:107], v[92:95], v[60:63]
    ds_read_b64_tr_b16 v[142:143], v6 offset:11520
    v_mfma_f32_16x16x32_bf16 v[64:67], v[108:111], v[80:83], v[64:67]
    v_mfma_f32_16x16x32_bf16 v[68:71], v[108:111], v[84:87], v[68:71]
    v_mfma_f32_16x16x32_bf16 v[72:75], v[108:111], v[88:91], v[72:75]
    v_mfma_f32_16x16x32_bf16 v[76:79], v[108:111], v[92:95], v[76:79]
    s_waitcnt lgkmcnt(4)
    v_mfma_f32_16x16x32_bf16 v[16:19], v[128:131], v[112:115], v[16:19]
    s_waitcnt lgkmcnt(0)
    v_mfma_f32_16x16x32_bf16 v[20:23], v[128:131], v[116:119], v[20:23]
    s_barrier
    v_mfma_f32_16x16x32_bf16 v[24:27], v[128:131], v[120:123], v[24:27]
    ds_read_b128 v[80:83], v4 offset:32768
    v_mfma_f32_16x16x32_bf16 v[28:31], v[128:131], v[124:127], v[28:31]
    ds_read_b64_tr_b16 v[96:97], v6 offset:32768
    v_mfma_f32_16x16x32_bf16 v[32:35], v[132:135], v[112:115], v[32:35]
    ds_read_b64_tr_b16 v[98:99], v6 offset:33024
    v_mfma_f32_16x16x32_bf16 v[36:39], v[132:135], v[116:119], v[36:39]
    ds_read_b128 v[84:87], v4 offset:34816
    v_mfma_f32_16x16x32_bf16 v[40:43], v[132:135], v[120:123], v[40:43]
    ds_read_b128 v[88:91], v4 offset:36864
    v_mfma_f32_16x16x32_bf16 v[44:47], v[132:135], v[124:127], v[44:47]
    ds_read_b128 v[92:95], v4 offset:38912
    v_mfma_f32_16x16x32_bf16 v[48:51], v[136:139], v[112:115], v[48:51]
    ds_read_b64_tr_b16 v[100:101], v6 offset:33792
    v_mfma_f32_16x16x32_bf16 v[52:55], v[136:139], v[116:119], v[52:55]
    ds_read_b64_tr_b16 v[102:103], v6 offset:34048
    v_mfma_f32_16x16x32_bf16 v[56:59], v[136:139], v[120:123], v[56:59]
    ds_read_b64_tr_b16 v[104:105], v6 offset:34816
    v_mfma_f32_16x16x32_bf16 v[60:63], v[136:139], v[124:127], v[60:63]
    ds_read_b64_tr_b16 v[106:107], v6 offset:35072
    v_mfma_f32_16x16x32_bf16 v[64:67], v[140:143], v[112:115], v[64:67]
    ds_read_b64_tr_b16 v[108:109], v6 offset:35840
    v_mfma_f32_16x16x32_bf16 v[68:71], v[140:143], v[116:119], v[68:71]
    ds_read_b64_tr_b16 v[110:111], v6 offset:36096
    v_mfma_f32_16x16x32_bf16 v[72:75], v[140:143], v[120:123], v[72:75]
    s_sub_u32 s73, s73, 1
    v_mfma_f32_16x16x32_bf16 v[76:79], v[140:143], v[124:127], v[76:79]
    s_waitcnt lgkmcnt(4)
    v_mfma_f32_16x16x32_bf16 v[16:19], v[96:99], v[80:83], v[16:19]
    ds_read_b128 v[112:115], v5 offset:32768
    v_mfma_f32_16x16x32_bf16 v[20:23], v[96:99], v[84:87], v[20:23]
    ds_read_b64_tr_b16 v[128:129], v6 offset:40960
    v_mfma_f32_16x16x32_bf16 v[24:27], v[96:99], v[88:91], v[24:27]
    ds_read_b64_tr_b16 v[130:131], v6 offset:41216
    v_mfma_f32_16x16x32_bf16 v[28:31], v[96:99], v[92:95], v[28:31]
    ds_read_b128 v[116:119], v5 offset:34816
    v_mfma_f32_16x16x32_bf16 v[32:35], v[100:103], v[80:83], v[32:35]
    ds_read_b128 v[120:123], v5 offset:36864
    v_mfma_f32_16x16x32_bf16 v[36:39], v[100:103], v[84:87], v[36:39]
    ds_read_b128 v[124:127], v5 offset:38912
    v_mfma_f32_16x16x32_bf16 v[40:43], v[100:103], v[88:91], v[40:43]
    ds_read_b64_tr_b16 v[132:133], v6 offset:41984
    v_mfma_f32_16x16x32_bf16 v[44:47], v[100:103], v[92:95], v[44:47]
    ds_read_b64_tr_b16 v[134:135], v6 offset:42240
    s_waitcnt lgkmcnt(8)
    v_mfma_f32_16x16x32_bf16 v[48:51], v[104:107], v[80:83], v[48:51]
    ds_read_b64_tr_b16 v[136:137], v6 offset:43008
    v_mfma_f32_16x16x32_bf16 v[52:55], v[104:107], v[84:87], v[52:55]
    ds_read_b64_tr_b16 v[138:139], v6 offset:43264
    v_mfma_f32_16x16x32_bf16 v[56:59], v[104:107], v[88:91], v[56:59]
    ds_read_b64_tr_b16 v[140:141], v6 offset:44032
    v_mfma_f32_16x16x32_bf16 v[60:63], v[104:107], v[92:95], v[60:63]
    ds_read_b64_tr_b16 v[142:143], v6 offset:44288
    v_mfma_f32_16x16x32_bf16 v[64:67], v[108:111], v[80:83], v[64:67]
    v_xor_b32 v4, 0x10000, v4
    v_mfma_f32_16x16x32_bf16 v[68:71], v[108:111], v[84:87], v[68:71]
    v_xor_b32 v5, 0x10000, v5
    v_mfma_f32_16x16x32_bf16 v[72:75], v[108:111], v[88:91], v[72:75]
    v_xor_b32 v6, 0x10000, v6
    v_mfma_f32_16x16x32_bf16 v[76:79], v[108:111], v[92:95], v[76:79]
    s_waitcnt lgkmcnt(4)
    v_mfma_f32_16x16x32_bf16 v[16:19], v[128:131], v[112:115], v[16:19]
    s_waitcnt lgkmcnt(0)
    v_mfma_f32_16x16x32_bf16 v[20:23], v[128:131], v[116:119], v[20:23]
    s_barrier
    v_mfma_f32_16x16x32_bf16 v[24:27], v[128:131], v[120:123], v[24:27]
    ds_read_b128 v[80:83], v4 offset:0
    v_mfma_f32_16x16x32_bf16 v[28:31], v[128:131], v[124:127], v[28:31]
    ds_read_b64_tr_b16 v[96:97], v6 offset:0
    v_mfma_f32_16x16x32_bf16 v[32:35], v[132:135], v[112:115], v[32:35]
    ds_read_b64_tr_b16 v[98:99], v6 offset:256
    v_mfma_f32_16x16x32_bf16 v[36:39], v[132:135], v[116:119], v[36:39]
    ds_read_b128 v[84:87], v4 offset:2048
    v_mfma_f32_16x16x32_bf16 v[40:43], v[132:135], v[120:123], v[40:43]
    ds_read_b128 v[88:91], v4 offset:4096
    v_mfma_f32_16x16x32_bf16 v[44:47], v[132:135], v[124:127], v[44:47]
    ds_read_b128 v[92:95], v4 offset:6144
    v_mfma_f32_16x16x32_bf16 v[48:51], v[136:139], v[112:115], v[48:51]
    ds_read_b64_tr_b16 v[100:101], v6 offset:1024
    v_mfma_f32_16x16x32_bf16 v[52:55], v[136:139], v[116:119], v[52:55]
    ds_read_b64_tr_b16 v[102:103], v6 offset:1280
    v_mfma_f32_16x16x32_bf16 v[56:59], v[136:139], v[120:123], v[56:59]
    ds_read_b64_tr_b16 v[104:105], v6 offset:2048
    v_mfma_f32_16x16x32_bf16 v[60:63], v[136:139], v[124:127], v[60:63]
    ds_read_b64_tr_b16 v[106:107], v6 offset:2304
    v_mfma_f32_16x16x32_bf16 v[64:67], v[140:143], v[112:115], v[64:67]
    ds_read_b64_tr_b16 v[108:109], v6 offset:3072
    v_mfma_f32_16x16x32_bf16 v[68:71], v[140:143], v[116:119], v[68:71]
    ds_read_b64_tr_b16 v[110:111], v6 offset:3328
    v_mfma_f32_16x16x32_bf16 v[72:75], v[140:143], v[120:123], v[72:75]
    s_cmp_lg_u32 s73, 0
    v_mfma_f32_16x16x32_bf16 v[76:79], v[140:143], v[124:127], v[76:79]
    s_cbranch_scc1 L_mainc_sl
    s_waitcnt lgkmcnt(4)
    v_mfma_f32_16x16x32_bf16 v[16:19], v[96:99], v[80:83], v[16:19]
    ds_read_b128 v[112:115], v5 offset:0
    v_mfma_f32_16x16x32_bf16 v[20:23], v[96:99], v[84:87], v[20:23]
    ds_read_b64_tr_b16 v[128:129], v6 offset:8192
    v_mfma_f32_16x16x32_bf16 v[24:27], v[96:99], v[88:91], v[24:27]
    ds_read_b64_tr_b16 v[130:131], v6 offset:8448
    v_mfma_f32_16x16x32_bf16 v[28:31], v[96:99], v[92:95], v[28:31]
    ds_read_b128 v[116:119], v5 offset:2048
    v_mfma_f32_16x16x32_bf16 v[32:35], v[100:103], v[80:83], v[32:35]
    ds_read_b128 v[120:123], v5 offset:4096
    v_mfma_f32_16x16x32_bf16 v[36:39], v[100:103], v[84:87], v[36:39]
    ds_read_b128 v[124:127], v5 offset:6144
    v_mfma_f32_16x16x32_bf16 v[40:43], v[100:103], v[88:91], v[40:43]
    ds_read_b64_tr_b16 v[132:133], v6 offset:9216
    v_mfma_f32_16x16x32_bf16 v[44:47], v[100:103], v[92:95], v[44:47]
    ds_read_b64_tr_b16 v[134:135], v6 offset:9472
    s_waitcnt lgkmcnt(8)
    v_mfma_f32_16x16x32_bf16 v[48:51], v[104:107], v[80:83], v[48:51]
    ds_read_b64_tr_b16 v[136:137], v6 offset:10240
    v_mfma_f32_16x16x32_bf16 v[52:55], v[104:107], v[84:87], v[52:55]
    ds_read_b64_tr_b16 v[138:139], v6 offset:10496
    v_mfma_f32_16x16x32_bf16 v[56:59], v[104:107], v[88:91], v[56:59]
    ds_read_b64_tr_b16 v[140:141], v6 offset:11264
    v_mfma_f32_16x16x32_bf16 v[60:63], v[104:107], v[92:95], v[60:63]
    ds_read_b64_tr_b16 v[142:143], v6 offset:11520
    v_mfma_f32_16x16x32_bf16 v[64:67], v[108:111], v[80:83], v[64:67]
    s_waitcnt lgkmcnt(8)
    v_mfma_f32_16x16x32_bf16 v[68:71], v[108:111], v[84:87], v[68:71]
    ds_read_b128 v[144:147], v7 offset:0
    ds_read_b128 v[148:151], v7 offset:2048
    ds_read_b128 v[152:155], v7 offset:1024
    ds_read_b128 v[156:159], v7 offset:3072
    v_mfma_f32_16x16x32_bf16 v[72:75], v[108:111], v[88:91], v[72:75]
    v_mfma_f32_16x16x32_bf16 v[76:79], v[108:111], v[92:95], v[76:79]
    s_waitcnt lgkmcnt(4)
    v_mfma_f32_16x16x32_bf16 v[16:19], v[128:131], v[112:115], v[16:19]
    s_waitcnt lgkmcnt(0)
    v_mfma_f32_16x16x32_bf16 v[20:23], v[128:131], v[116:119], v[20:23]
    s_barrier
    v_mfma_f32_16x16x32_bf16 v[24:27], v[128:131], v[120:123], v[24:27]
    ds_read_b128 v[80:83], v4 offset:32768
    v_mfma_f32_16x16x32_bf16 v[28:31], v[128:131], v[124:127], v[28:31]
    ds_read_b64_tr_b16 v[96:97], v6 offset:32768
    v_mfma_f32_16x16x32_bf16 v[32:35], v[132:135], v[112:115], v[32:35]
    ds_read_b64_tr_b16 v[98:99], v6 offset:33024
    v_mfma_f32_16x16x32_bf16 v[36:39], v[132:135], v[116:119], v[36:39]
    ds_read_b128 v[84:87], v4 offset:34816
    v_mfma_f32_16x16x32_bf16 v[40:43], v[132:135], v[120:123], v[40:43]
    ds_read_b128 v[88:91], v4 offset:36864
    v_mfma_f32_16x16x32_bf16 v[44:47], v[132:135], v[124:127], v[44:47]
    ds_read_b128 v[92:95], v4 offset:38912
    v_mfma_f32_16x16x32_bf16 v[48:51], v[136:139], v[112:115], v[48:51]
    ds_read_b64_tr_b16 v[100:101], v6 offset:33792
    v_mfma_f32_16x16x32_bf16 v[52:55], v[136:139], v[116:119], v[52:55]
    ds_read_b64_tr_b16 v[102:103], v6 offset:34048
    v_mfma_f32_16x16x32_bf16 v[56:59], v[136:139], v[120:123], v[56:59]
    ds_read_b64_tr_b16 v[104:105], v6 offset:34816
    v_mfma_f32_16x16x32_bf16 v[60:63], v[136:139], v[124:127], v[60:63]
    ds_read_b64_tr_b16 v[106:107], v6 offset:35072
    v_mfma_f32_16x16x32_bf16 v[64:67], v[140:143], v[112:115], v[64:67]
    ds_read_b64_tr_b16 v[108:109], v6 offset:35840
    v_mfma_f32_16x16x32_bf16 v[68:71], v[140:143], v[116:119], v[68:71]
    ds_read_b64_tr_b16 v[110:111], v6 offset:36096
    v_mfma_f32_16x16x32_bf16 v[72:75], v[140:143], v[120:123], v[72:75]
    v_mfma_f32_16x16x32_bf16 v[76:79], v[140:143], v[124:127], v[76:79]
    s_waitcnt lgkmcnt(4)
    v_mfma_f32_16x16x32_bf16 v[16:19], v[96:99], v[80:83], v[16:19]
    ds_read_b128 v[112:115], v5 offset:32768
    v_mfma_f32_16x16x32_bf16 v[20:23], v[96:99], v[84:87], v[20:23]
    ds_read_b64_tr_b16 v[128:129], v6 offset:40960
    v_mfma_f32_16x16x32_bf16 v[24:27], v[96:99], v[88:91], v[24:27]
    ds_read_b64_tr_b16 v[130:131], v6 offset:41216
    v_mfma_f32_16x16x32_bf16 v[28:31], v[96:99], v[92:95], v[28:31]
    ds_read_b128 v[116:119], v5 offset:34816
    v_mfma_f32_16x16x32_bf16 v[32:35], v[100:103], v[80:83], v[32:35]
    ds_read_b128 v[120:123], v5 offset:36864
    v_mfma_f32_16x16x32_bf16 v[36:39], v[100:103], v[84:87], v[36:39]
    ds_read_b128 v[124:127], v5 offset:38912
    v_mfma_f32_16x16x32_bf16 v[40:43], v[100:103], v[88:91], v[40:43]
    ds_read_b64_tr_b16 v[132:133], v6 offset:41984
    v_mfma_f32_16x16x32_bf16 v[44:47], v[100:103], v[92:95], v[44:47]
    ds_read_b64_tr_b16 v[134:135], v6 offset:42240
    s_waitcnt lgkmcnt(8)
    v_mfma_f32_16x16x32_bf16 v[48:51], v[104:107], v[80:83], v[48:51]
    ds_read_b64_tr_b16 v[136:137], v6 offset:43008
    v_mfma_f32_16x16x32_bf16 v[52:55], v[104:107], v[84:87], v[52:55]
    ds_read_b64_tr_b16 v[138:139], v6 offset:43264
    v_mfma_f32_16x16x32_bf16 v[56:59], v[104:107], v[88:91], v[56:59]
    ds_read_b64_tr_b16 v[140:141], v6 offset:44032
    v_mfma_f32_16x16x32_bf16 v[60:63], v[104:107], v[92:95], v[60:63]
    ds_read_b64_tr_b16 v[142:143], v6 offset:44288
    v_mfma_f32_16x16x32_bf16 v[64:67], v[108:111], v[80:83], v[64:67]
    s_waitcnt lgkmcnt(8)
    v_mfma_f32_16x16x32_bf16 v[68:71], v[108:111], v[84:87], v[68:71]
    ds_read_b128 v[160:163], v7 offset:8192
    ds_read_b128 v[164:167], v7 offset:10240
    ds_read_b128 v[168:171], v7 offset:9216
    ds_read_b128 v[172:175], v7 offset:11264
    v_mfma_f32_16x16x32_bf16 v[72:75], v[108:111], v[88:91], v[72:75]
    v_mfma_f32_16x16x32_bf16 v[76:79], v[108:111], v[92:95], v[76:79]
    s_waitcnt lgkmcnt(0)
    s_barrier
    v_mfma_f32_16x16x32_bf16 v[16:19], v[128:131], v[112:115], v[16:19]
    v_lshlrev_b32 v80, 16, v144
    v_and_b32 v81, 0xffff0000, v144
    v_mfma_f32_16x16x32_bf16 v[20:23], v[128:131], v[116:119], v[20:23]
    v_lshlrev_b32 v82, 16, v145
    v_and_b32 v83, 0xffff0000, v145
    v_mfma_f32_16x16x32_bf16 v[24:27], v[128:131], v[120:123], v[24:27]
    v_lshlrev_b32 v84, 16, v146
    v_and_b32 v85, 0xffff0000, v146
    v_mfma_f32_16x16x32_bf16 v[28:31], v[128:131], v[124:127], v[28:31]
    v_lshlrev_b32 v86, 16, v147
    v_and_b32 v87, 0xffff0000, v147
    v_mfma_f32_16x16x32_bf16 v[32:35], v[132:135], v[112:115], v[32:35]
    v_lshlrev_b32 v88, 16, v148
    v_and_b32 v89, 0xffff0000, v148
    v_mfma_f32_16x16x32_bf16 v[36:39], v[132:135], v[116:119], v[36:39]
    v_lshlrev_b32 v90, 16, v149
    v_and_b32 v91, 0xffff0000, v149
    v_mfma_f32_16x16x32_bf16 v[40:43], v[132:135], v[120:123], v[40:43]
    v_lshlrev_b32 v92, 16, v150
    v_and_b32 v93, 0xffff0000, v150
    v_mfma_f32_16x16x32_bf16 v[44:47], v[132:135], v[124:127], v[44:47]
    v_lshlrev_b32 v94, 16, v151
    v_and_b32 v95, 0xffff0000, v151
    v_mfma_f32_16x16x32_bf16 v[48:51], v[136:139], v[112:115], v[48:51]
    v_lshlrev_b32 v96, 16, v152
    v_and_b32 v97, 0xffff0000, v152
    v_mfma_f32_16x16x32_bf16 v[52:55], v[136:139], v[116:119], v[52:55]
    v_lshlrev_b32 v98, 16, v153
    v_and_b32 v99, 0xffff0000, v153
    v_mfma_f32_16x16x32_bf16 v[56:59], v[136:139], v[120:123], v[56:59]
    v_lshlrev_b32 v100, 16, v154
    v_and_b32 v101, 0xffff0000, v154
    v_mfma_f32_16x16x32_bf16 v[60:63], v[136:139], v[124:127], v[60:63]
    v_lshlrev_b32 v102, 16, v155
    v_and_b32 v103, 0xffff0000, v155
    v_mfma_f32_16x16x32_bf16 v[64:67], v[140:143], v[112:115], v[64:67]
    v_lshlrev_b32 v104, 16, v156
    v_and_b32 v105, 0xffff0000, v156
    v_mfma_f32_16x16x32_bf16 v[68:71], v[140:143], v[116:119], v[68:71]
    v_lshlrev_b32 v106, 16, v157
    v_and_b32 v107, 0xffff0000, v157
    v_mfma_f32_16x16x32_bf16 v[72:75], v[140:143], v[120:123], v[72:75]
    v_lshlrev_b32 v108, 16, v158
    v_and_b32 v109, 0xffff0000, v158
    v_mfma_f32_16x16x32_bf16 v[76:79], v[140:143], v[124:127], v[76:79]
    v_lshlrev_b32 v110, 16, v159
    v_and_b32 v111, 0xffff0000, v159
    v_lshlrev_b32 v176, 16, v160
    v_and_b32 v177, 0xffff0000, v160
    v_lshlrev_b32 v178, 16, v161
    v_and_b32 v179, 0xffff0000, v161
    v_lshlrev_b32 v180, 16, v162
    v_and_b32 v181, 0xffff0000, v162
    v_lshlrev_b32 v182, 16, v163
    v_and_b32 v183, 0xffff0000, v163
    v_lshlrev_b32 v184, 16, v164
    v_and_b32 v185, 0xffff0000, v164
    v_lshlrev_b32 v186, 16, v165
    v_and_b32 v187, 0xffff0000, v165
    v_lshlrev_b32 v188, 16, v166
    v_and_b32 v189, 0xffff0000, v166
    v_lshlrev_b32 v190, 16, v167
    v_and_b32 v191, 0xffff0000, v167
    v_lshlrev_b32 v192, 16, v168
    v_and_b32 v193, 0xffff0000, v168
    v_lshlrev_b32 v194, 16, v169
    v_and_b32 v195, 0xffff0000, v169
    v_lshlrev_b32 v196, 16, v170
    v_and_b32 v197, 0xffff0000, v170
    v_lshlrev_b32 v198, 16, v171
    v_and_b32 v199, 0xffff0000, v171
    v_lshlrev_b32 v200, 16, v172
    v_and_b32 v201, 0xffff0000, v172
    v_lshlrev_b32 v202, 16, v173
    v_and_b32 v203, 0xffff0000, v173
    v_lshlrev_b32 v204, 16, v174
    v_and_b32 v205, 0xffff0000, v174
    v_lshlrev_b32 v206, 16, v175
    v_and_b32 v207, 0xffff0000, v175
    v_pk_mul_f32 v[16:17], v[16:17], v[80:81]
    v_pk_mul_f32 v[18:19], v[18:19], v[82:83]
    v_pk_mul_f32 v[32:33], v[32:33], v[84:85]
    v_pk_mul_f32 v[34:35], v[34:35], v[86:87]
    v_cvt_pk_bf16_f32 v144, v16, v17
    v_cvt_pk_bf16_f32 v145, v18, v19
    v_cvt_pk_bf16_f32 v146, v32, v33
    v_cvt_pk_bf16_f32 v147, v34, v35
    buffer_store_dwordx4 v[144:147], v2, s[36:39], s58 offen offset:0 sc1
    v_pk_mul_f32 v[48:49], v[48:49], v[88:89]
    v_pk_mul_f32 v[50:51], v[50:51], v[90:91]
    v_pk_mul_f32 v[64:65], v[64:65], v[92:93]
    v_pk_mul_f32 v[66:67], v[66:67], v[94:95]
    v_cvt_pk_bf16_f32 v148, v48, v49
    v_cvt_pk_bf16_f32 v149, v50, v51
    v_cvt_pk_bf16_f32 v150, v64, v65
    v_cvt_pk_bf16_f32 v151, v66, v67
    buffer_store_dwordx4 v[148:151], v2, s[36:39], s58 offen offset:2048 sc1
    v_pk_mul_f32 v[20:21], v[20:21], v[96:97]
    v_pk_mul_f32 v[22:23], v[22:23], v[98:99]
    v_pk_mul_f32 v[36:37], v[36:37], v[100:101]
    v_pk_mul_f32 v[38:39], v[38:39], v[102:103]
    v_cvt_pk_bf16_f32 v152, v20, v21
    v_cvt_pk_bf16_f32 v153, v22, v23
    v_cvt_pk_bf16_f32 v154, v36, v37
    v_cvt_pk_bf16_f32 v155, v38, v39
    buffer_store_dwordx4 v[152:155], v2, s[36:39], s58 offen offset:1024 sc1
    v_pk_mul_f32 v[52:53], v[52:53], v[104:105]
    v_pk_mul_f32 v[54:55], v[54:55], v[106:107]
    v_pk_mul_f32 v[68:69], v[68:69], v[108:109]
    v_pk_mul_f32 v[70:71], v[70:71], v[110:111]
    v_cvt_pk_bf16_f32 v156, v52, v53
    v_cvt_pk_bf16_f32 v157, v54, v55
    v_cvt_pk_bf16_f32 v158, v68, v69
    v_cvt_pk_bf16_f32 v159, v70, v71
    buffer_store_dwordx4 v[156:159], v2, s[36:39], s58 offen offset:3072 sc1
    v_pk_mul_f32 v[24:25], v[24:25], v[176:177]
    v_pk_mul_f32 v[26:27], v[26:27], v[178:179]
    v_pk_mul_f32 v[40:41], v[40:41], v[180:181]
    v_pk_mul_f32 v[42:43], v[42:43], v[182:183]
    v_cvt_pk_bf16_f32 v160, v24, v25
    v_cvt_pk_bf16_f32 v161, v26, v27
    v_cvt_pk_bf16_f32 v162, v40, v41
    v_cvt_pk_bf16_f32 v163, v42, v43
    buffer_store_dwordx4 v[160:163], v2, s[36:39], s59 offen offset:0 sc1
    v_pk_mul_f32 v[56:57], v[56:57], v[184:185]
    v_pk_mul_f32 v[58:59], v[58:59], v[186:187]
    v_pk_mul_f32 v[72:73], v[72:73], v[188:189]
    v_pk_mul_f32 v[74:75], v[74:75], v[190:191]
    v_cvt_pk_bf16_f32 v164, v56, v57
    v_cvt_pk_bf16_f32 v165, v58, v59
    v_cvt_pk_bf16_f32 v166, v72, v73
    v_cvt_pk_bf16_f32 v167, v74, v75
    buffer_store_dwordx4 v[164:167], v2, s[36:39], s59 offen offset:2048 sc1
    v_pk_mul_f32 v[28:29], v[28:29], v[192:193]
    v_pk_mul_f32 v[30:31], v[30:31], v[194:195]
    v_pk_mul_f32 v[44:45], v[44:45], v[196:197]
    v_pk_mul_f32 v[46:47], v[46:47], v[198:199]
    v_cvt_pk_bf16_f32 v168, v28, v29
    v_cvt_pk_bf16_f32 v169, v30, v31
    v_cvt_pk_bf16_f32 v170, v44, v45
    v_cvt_pk_bf16_f32 v171, v46, v47
    buffer_store_dwordx4 v[168:171], v2, s[36:39], s59 offen offset:1024 sc1
    v_pk_mul_f32 v[60:61], v[60:61], v[200:201]
    v_pk_mul_f32 v[62:63], v[62:63], v[202:203]
    v_pk_mul_f32 v[76:77], v[76:77], v[204:205]
    v_pk_mul_f32 v[78:79], v[78:79], v[206:207]
    v_cvt_pk_bf16_f32 v172, v60, v61
    v_cvt_pk_bf16_f32 v173, v62, v63
    v_cvt_pk_bf16_f32 v174, v76, v77
    v_cvt_pk_bf16_f32 v175, v78, v79
    buffer_store_dwordx4 v[172:175], v2, s[36:39], s59 offen offset:3072 sc1
L_mainc_sy:
    s_lshl_b32 s82, s34, 1
    s_add_u32 s82, s82, s63
    s_cmp_eq_u32 s63, 1
    s_cbranch_scc1 L_mainc_yw
    s_lshl_b32 s52, s82, 2
    s_add_u32 s52, s52, s3
    s_lshl_b32 s52, s52, 7
    s_add_u32 s52, s52, 0x14c000
    v_mov_b32 v7, 1
    s_waitcnt vmcnt(0)
    s_mov_b64 exec, 1
    buffer_atomic_add v7, v2, s[36:39], s52 offen sc1
    s_mov_b64 exec, -1
L_mainc_yw:
    s_bfe_u32 s34, s2, 0x20001
    s_lshl_b32 s34, s34, 2
    s_bfe_u32 s52, s2, 0x20003
    s_add_u32 s34, s34, s52
    s_and_b32 s35, s2, 1
    s_lshl_b32 s35, s35, 3
    s_lshr_b32 s52, s2, 5
    s_add_u32 s35, s35, s52
    s_lshl_b32 s78, s34, 2
    s_add_u32 s78, s78, s3
    s_mul_i32 s52, s78, 114688
    s_add_u32 s52, s52, 0x1c00000
    s_add_u32 s40, s32, s52
    s_addc_u32 s41, s33, 0
    s_mov_b32 s42, 0x1c000
    s_mov_b32 s43, 0x00020000
    s_mov_b32 s44, s28
    s_mov_b32 s45, s29
    s_mov_b32 s46, 0x400000
    s_mov_b32 s47, 0x00020000
    s_mov_b32 s72, 65536
    s_mov_b32 s73, 6
    s_mov_b32 s74, 0
    v_lshrrev_b32 v8, 2, v1
    v_lshlrev_b32 v8, 7, v8
    v_bfe_u32 v12, v1, 3, 2
    v_lshl_add_u32 v8, v12, 5, v8
    v_and_b32 v12, 3, v1
    v_lshl_add_u32 v8, v12, 3, v8
    v_add_u32 v8, 0, v8
    v_xor_b32 v9, 32, v8
    v_xor_b32 v10, 64, v8
    v_xor_b32 v11, 96, v8
    v_pk_mov_b32 v[4:5], v[8:9], v[8:9] op_sel:[0,1]
    v_pk_mov_b32 v[6:7], v[10:11], v[10:11] op_sel:[0,1]
    v_pk_mov_b32 v[16:17], 0, 0
    v_pk_mov_b32 v[18:19], 0, 0
    v_pk_mov_b32 v[20:21], 0, 0
    v_pk_mov_b32 v[22:23], 0, 0
    v_pk_mov_b32 v[24:25], 0, 0
    v_pk_mov_b32 v[26:27], 0, 0
    v_pk_mov_b32 v[28:29], 0, 0
    v_pk_mov_b32 v[30:31], 0, 0
    v_pk_mov_b32 v[32:33], 0, 0
    v_pk_mov_b32 v[34:35], 0, 0
    v_pk_mov_b32 v[36:37], 0, 0
    v_pk_mov_b32 v[38:39], 0, 0
    v_pk_mov_b32 v[40:41], 0, 0
    v_pk_mov_b32 v[42:43], 0, 0
    v_pk_mov_b32 v[44:45], 0, 0
    v_pk_mov_b32 v[46:47], 0, 0
    s_lshl_b32 s79, s3, 13
    s_add_u32 s79, s79, 131072
    v_and_b32 v3, 15, v1
    v_lshlrev_b32 v224, 7, v3
    v_bfe_u32 v14, v1, 1, 3
    v_lshrrev_b32 v15, 5, v1
    v_xor_b32 v14, v14, v15
    v_lshl_add_u32 v224, v14, 4, v224
    v_bfe_u32 v14, v1, 4, 1
    v_lshl_add_u32 v224, v14, 3, v224
    v_add_u32 v224, s79, v224
    v_xor_b32 v225, 32, v224
    v_xor_b32 v226, 64, v224
    v_xor_b32 v227, 96, v224
    v_lshlrev_b32 v192, 16, v236
    v_and_b32 v193, 0xffff0000, v236
    v_lshlrev_b32 v194, 16, v237
    v_and_b32 v195, 0xffff0000, v237
    v_lshlrev_b32 v196, 16, v238
    v_and_b32 v197, 0xffff0000, v238
    v_lshlrev_b32 v198, 16, v239
    v_and_b32 v199, 0xffff0000, v239
    v_lshlrev_b32 v200, 16, v240
    v_and_b32 v201, 0xffff0000, v240
    v_lshlrev_b32 v202, 16, v241
    v_and_b32 v203, 0xffff0000, v241
    v_lshlrev_b32 v204, 16, v242
    v_and_b32 v205, 0xffff0000, v242
    v_lshlrev_b32 v206, 16, v243
    v_and_b32 v207, 0xffff0000, v243
    v_lshlrev_b32 v208, 16, v244
    v_and_b32 v209, 0xffff0000, v244
    v_lshlrev_b32 v210, 16, v245
    v_and_b32 v211, 0xffff0000, v245
    v_lshlrev_b32 v212, 16, v246
    v_and_b32 v213, 0xffff0000, v246
    v_lshlrev_b32 v214, 16, v247
    v_and_b32 v215, 0xffff0000, v247
    v_lshlrev_b32 v216, 16, v248
    v_and_b32 v217, 0xffff0000, v248
    v_lshlrev_b32 v218, 16, v249
    v_and_b32 v219, 0xffff0000, v249
    v_lshlrev_b32 v220, 16, v250
    v_and_b32 v221, 0xffff0000, v250
    v_lshlrev_b32 v222, 16, v251
    v_and_b32 v223, 0xffff0000, v251
    v_and_b32 v14, 48, v1
    v_add_u32 v14, 159744, v14
    s_lshl_b32 s80, s78, 16
    s_lshl_b32 s53, s35, 7
    s_add_u32 s80, s80, s53
    v_lshrrev_b32 v228, 3, v1
    v_lshlrev_b32 v228, 11, v228
    v_lshrrev_b32 v15, 4, v1
    v_xor_b32 v15, v15, v1
    v_and_b32 v15, 7, v15
    v_lshl_add_u32 v228, v15, 4, v228
    v_xor_b32 v229, 64, v228
    v_add_u32 v230, s79, v2
    s_nop 0
    s_barrier
    ds_read_b128 v[176:179], v14 offset:0
    ds_read_b128 v[180:183], v14 offset:64
    ds_read_b128 v[184:187], v14 offset:128
    ds_read_b128 v[188:191], v14 offset:192
    s_waitcnt lgkmcnt(0)
    s_barrier
    buffer_load_dwordx4 v[80:83], v2, s[40:43], s72 offen offset:0 sc1
    buffer_load_dwordx4 v[84:87], v2, s[40:43], s72 offen offset:1024 sc1
    buffer_load_dwordx4 v[88:91], v2, s[40:43], s72 offen offset:2048 sc1
    buffer_load_dwordx4 v[92:95], v2, s[40:43], s72 offen offset:3072 sc1
    s_add_u32 s72, s72, 4096
    s_cmp_eq_u32 s72, 114688
    s_cselect_b32 s72, 0, s72
    ds_read_b64_tr_b16 v[48:49], v4 offset:0
    ds_read_b64_tr_b16 v[50:51], v4 offset:2048
    ds_read_b64_tr_b16 v[52:53], v5 offset:0
    ds_read_b64_tr_b16 v[54:55], v5 offset:2048
    ds_read_b64_tr_b16 v[56:57], v6 offset:0
    ds_read_b64_tr_b16 v[58:59], v6 offset:2048
    ds_read_b64_tr_b16 v[60:61], v7 offset:0
    ds_read_b64_tr_b16 v[62:63], v7 offset:2048
    ds_read_b64_tr_b16 v[64:65], v4 offset:4096
    ds_read_b64_tr_b16 v[66:67], v4 offset:6144
    ds_read_b64_tr_b16 v[68:69], v5 offset:4096
    ds_read_b64_tr_b16 v[70:71], v5 offset:6144
    ds_read_b64_tr_b16 v[72:73], v6 offset:4096
    ds_read_b64_tr_b16 v[74:75], v6 offset:6144
    buffer_load_dwordx4 v[96:99], v2, s[40:43], s72 offen offset:0 sc1
    buffer_load_dwordx4 v[100:103], v2, s[40:43], s72 offen offset:1024 sc1
    buffer_load_dwordx4 v[104:107], v2, s[40:43], s72 offen offset:2048 sc1
    buffer_load_dwordx4 v[108:111], v2, s[40:43], s72 offen offset:3072 sc1
    s_add_u32 s72, s72, 4096
    s_cmp_eq_u32 s72, 114688
    s_cselect_b32 s72, 0, s72
    buffer_load_dwordx4 v[112:115], v2, s[40:43], s72 offen offset:0 sc1
    buffer_load_dwordx4 v[116:119], v2, s[40:43], s72 offen offset:1024 sc1
    buffer_load_dwordx4 v[120:123], v2, s[40:43], s72 offen offset:2048 sc1
    buffer_load_dwordx4 v[124:127], v2, s[40:43], s72 offen offset:3072 sc1
    s_add_u32 s72, s72, 4096
    s_cmp_eq_u32 s72, 114688
    s_cselect_b32 s72, 0, s72
    s_cmp_eq_u32 s63, 0
    s_cbranch_scc1 L_mainc_yn
    s_lshl_b32 s52, s82, 2
    s_add_u32 s52, s52, s3
    s_lshl_b32 s52, s52, 7
    s_add_u32 s52, s52, 0x14c000
    v_mov_b32 v15, 1
    s_waitcnt vmcnt(12)
    s_mov_b64 exec, 1
    buffer_atomic_add v15, v2, s[36:39], s52 offen sc1
    s_mov_b64 exec, -1
L_mainc_yn:
L_mainc_ul:
    s_waitcnt vmcnt(10) lgkmcnt(10)
    v_mfma_f32_16x16x32_bf16 v[16:19], v[48:51], v[80:83], v[16:19]
    buffer_load_dwordx4 v[128:131], v2, s[40:43], s72 offen offset:0 sc1
    ds_read_b64_tr_b16 v[76:77], v7 offset:4096
    v_mfma_f32_16x16x32_bf16 v[32:35], v[48:51], v[84:87], v[32:35]
    ds_read_b64_tr_b16 v[78:79], v7 offset:6144
    v_mfma_f32_16x16x32_bf16 v[20:23], v[52:55], v[80:83], v[20:23]
    ds_read_b64_tr_b16 v[48:49], v4 offset:8192
    v_mfma_f32_16x16x32_bf16 v[36:39], v[52:55], v[84:87], v[36:39]
    ds_read_b64_tr_b16 v[50:51], v4 offset:10240
    s_waitcnt lgkmcnt(10)
    v_mfma_f32_16x16x32_bf16 v[24:27], v[56:59], v[80:83], v[24:27]
    buffer_load_dwordx4 v[132:135], v2, s[40:43], s72 offen offset:1024 sc1
    ds_read_b64_tr_b16 v[52:53], v5 offset:8192
    v_mfma_f32_16x16x32_bf16 v[40:43], v[56:59], v[84:87], v[40:43]
    ds_read_b64_tr_b16 v[54:55], v5 offset:10240
    v_mfma_f32_16x16x32_bf16 v[28:31], v[60:63], v[80:83], v[28:31]
    ds_read_b64_tr_b16 v[56:57], v6 offset:8192
    v_mfma_f32_16x16x32_bf16 v[44:47], v[60:63], v[84:87], v[44:47]
    ds_read_b64_tr_b16 v[58:59], v6 offset:10240
    s_waitcnt vmcnt(10) lgkmcnt(10)
    v_mfma_f32_16x16x32_bf16 v[16:19], v[64:67], v[88:91], v[16:19]
    buffer_load_dwordx4 v[136:139], v2, s[40:43], s72 offen offset:2048 sc1
    ds_read_b64_tr_b16 v[60:61], v7 offset:8192
    v_mfma_f32_16x16x32_bf16 v[32:35], v[64:67], v[92:95], v[32:35]
    ds_read_b64_tr_b16 v[62:63], v7 offset:10240
    v_mfma_f32_16x16x32_bf16 v[20:23], v[68:71], v[88:91], v[20:23]
    ds_read_b64_tr_b16 v[64:65], v4 offset:12288
    v_mfma_f32_16x16x32_bf16 v[36:39], v[68:71], v[92:95], v[36:39]
    ds_read_b64_tr_b16 v[66:67], v4 offset:14336
    s_waitcnt lgkmcnt(10)
    v_mfma_f32_16x16x32_bf16 v[24:27], v[72:75], v[88:91], v[24:27]
    buffer_load_dwordx4 v[140:143], v2, s[40:43], s72 offen offset:3072 sc1
    ds_read_b64_tr_b16 v[68:69], v5 offset:12288
    v_mfma_f32_16x16x32_bf16 v[40:43], v[72:75], v[92:95], v[40:43]
    s_add_u32 s72, s72, 4096
    ds_read_b64_tr_b16 v[70:71], v5 offset:14336
    v_mfma_f32_16x16x32_bf16 v[28:31], v[76:79], v[88:91], v[28:31]
    s_cmp_eq_u32 s72, 114688
    s_cselect_b32 s72, 0, s72
    ds_read_b64_tr_b16 v[72:73], v6 offset:12288
    v_mfma_f32_16x16x32_bf16 v[44:47], v[76:79], v[92:95], v[44:47]
    ds_read_b64_tr_b16 v[74:75], v6 offset:14336
    s_waitcnt vmcnt(10) lgkmcnt(10)
    v_mfma_f32_16x16x32_bf16 v[16:19], v[48:51], v[96:99], v[16:19]
    buffer_load_dwordx4 v[80:83], v2, s[40:43], s72 offen offset:0 sc1
    ds_read_b64_tr_b16 v[76:77], v7 offset:12288
    v_mfma_f32_16x16x32_bf16 v[32:35], v[48:51], v[100:103], v[32:35]
    ds_read_b64_tr_b16 v[78:79], v7 offset:14336
    v_mfma_f32_16x16x32_bf16 v[20:23], v[52:55], v[96:99], v[20:23]
    ds_read_b64_tr_b16 v[48:49], v4 offset:16384
    v_mfma_f32_16x16x32_bf16 v[36:39], v[52:55], v[100:103], v[36:39]
    ds_read_b64_tr_b16 v[50:51], v4 offset:18432
    s_waitcnt lgkmcnt(10)
    v_mfma_f32_16x16x32_bf16 v[24:27], v[56:59], v[96:99], v[24:27]
    buffer_load_dwordx4 v[84:87], v2, s[40:43], s72 offen offset:1024 sc1
    ds_read_b64_tr_b16 v[52:53], v5 offset:16384
    v_mfma_f32_16x16x32_bf16 v[40:43], v[56:59], v[100:103], v[40:43]
    ds_read_b64_tr_b16 v[54:55], v5 offset:18432
    v_mfma_f32_16x16x32_bf16 v[28:31], v[60:63], v[96:99], v[28:31]
    ds_read_b64_tr_b16 v[56:57], v6 offset:16384
    v_mfma_f32_16x16x32_bf16 v[44:47], v[60:63], v[100:103], v[44:47]
    ds_read_b64_tr_b16 v[58:59], v6 offset:18432
    s_waitcnt vmcnt(10) lgkmcnt(10)
    v_mfma_f32_16x16x32_bf16 v[16:19], v[64:67], v[104:107], v[16:19]
    buffer_load_dwordx4 v[88:91], v2, s[40:43], s72 offen offset:2048 sc1
    ds_read_b64_tr_b16 v[60:61], v7 offset:16384
    v_mfma_f32_16x16x32_bf16 v[32:35], v[64:67], v[108:111], v[32:35]
    ds_read_b64_tr_b16 v[62:63], v7 offset:18432
    v_mfma_f32_16x16x32_bf16 v[20:23], v[68:71], v[104:107], v[20:23]
    ds_read_b64_tr_b16 v[64:65], v4 offset:20480
    v_mfma_f32_16x16x32_bf16 v[36:39], v[68:71], v[108:111], v[36:39]
    ds_read_b64_tr_b16 v[66:67], v4 offset:22528
    s_waitcnt lgkmcnt(10)
    v_mfma_f32_16x16x32_bf16 v[24:27], v[72:75], v[104:107], v[24:27]
    buffer_load_dwordx4 v[92:95], v2, s[40:43], s72 offen offset:3072 sc1
    ds_read_b64_tr_b16 v[68:69], v5 offset:20480
    v_mfma_f32_16x16x32_bf16 v[40:43], v[72:75], v[108:111], v[40:43]
    s_add_u32 s72, s72, 4096
    ds_read_b64_tr_b16 v[70:71], v5 offset:22528
    v_mfma_f32_16x16x32_bf16 v[28:31], v[76:79], v[104:107], v[28:31]
    s_cmp_eq_u32 s72, 114688
    s_cselect_b32 s72, 0, s72
    ds_read_b64_tr_b16 v[72:73], v6 offset:20480
    v_mfma_f32_16x16x32_bf16 v[44:47], v[76:79], v[108:111], v[44:47]
    ds_read_b64_tr_b16 v[74:75], v6 offset:22528
    s_waitcnt vmcnt(10) lgkmcnt(10)
    v_mfma_f32_16x16x32_bf16 v[16:19], v[48:51], v[112:115], v[16:19]
    buffer_load_dwordx4 v[96:99], v2, s[40:43], s72 offen offset:0 sc1
    ds_read_b64_tr_b16 v[76:77], v7 offset:20480
    v_mfma_f32_16x16x32_bf16 v[32:35], v[48:51], v[116:119], v[32:35]
    ds_read_b64_tr_b16 v[78:79], v7 offset:22528
    v_mfma_f32_16x16x32_bf16 v[20:23], v[52:55], v[112:115], v[20:23]
    s_add_u32 s74, s74, 0x8000
    ds_read_b64_tr_b16 v[48:49], v4 offset:24576
    v_mfma_f32_16x16x32_bf16 v[36:39], v[52:55], v[116:119], v[36:39]
    ds_read_b64_tr_b16 v[50:51], v4 offset:26624
    s_waitcnt lgkmcnt(10)
    v_mfma_f32_16x16x32_bf16 v[24:27], v[56:59], v[112:115], v[24:27]
    buffer_load_dwordx4 v[100:103], v2, s[40:43], s72 offen offset:1024 sc1
    ds_read_b64_tr_b16 v[52:53], v5 offset:24576
    v_mfma_f32_16x16x32_bf16 v[40:43], v[56:59], v[116:119], v[40:43]
    ds_read_b64_tr_b16 v[54:55], v5 offset:26624
    v_mfma_f32_16x16x32_bf16 v[28:31], v[60:63], v[112:115], v[28:31]
    s_and_b32 s74, s74, 0x1ffff
    ds_read_b64_tr_b16 v[56:57], v6 offset:24576
    v_mfma_f32_16x16x32_bf16 v[44:47], v[60:63], v[116:119], v[44:47]
    ds_read_b64_tr_b16 v[58:59], v6 offset:26624
    s_waitcnt vmcnt(10) lgkmcnt(10)
    v_mfma_f32_16x16x32_bf16 v[16:19], v[64:67], v[120:123], v[16:19]
    buffer_load_dwordx4 v[104:107], v2, s[40:43], s72 offen offset:2048 sc1
    ds_read_b64_tr_b16 v[60:61], v7 offset:24576
    v_mfma_f32_16x16x32_bf16 v[32:35], v[64:67], v[124:127], v[32:35]
    ds_read_b64_tr_b16 v[62:63], v7 offset:26624
    v_mfma_f32_16x16x32_bf16 v[20:23], v[68:71], v[120:123], v[20:23]
    ds_read_b64_tr_b16 v[64:65], v4 offset:28672
    v_mfma_f32_16x16x32_bf16 v[36:39], v[68:71], v[124:127], v[36:39]
    ds_read_b64_tr_b16 v[66:67], v4 offset:30720
    s_waitcnt lgkmcnt(10)
    v_mfma_f32_16x16x32_bf16 v[24:27], v[72:75], v[120:123], v[24:27]
    buffer_load_dwordx4 v[108:111], v2, s[40:43], s72 offen offset:3072 sc1
    ds_read_b64_tr_b16 v[68:69], v5 offset:28672
    v_mfma_f32_16x16x32_bf16 v[40:43], v[72:75], v[124:127], v[40:43]
    s_add_u32 s72, s72, 4096
    v_add_u32 v4, s74, v8
    ds_read_b64_tr_b16 v[70:71], v5 offset:30720
    v_mfma_f32_16x16x32_bf16 v[28:31], v[76:79], v[120:123], v[28:31]
    s_cmp_eq_u32 s72, 114688
    s_cselect_b32 s72, 0, s72
    ds_read_b64_tr_b16 v[72:73], v6 offset:28672
    v_mfma_f32_16x16x32_bf16 v[44:47], v[76:79], v[124:127], v[44:47]
    ds_read_b64_tr_b16 v[74:75], v6 offset:30720
    s_waitcnt vmcnt(10) lgkmcnt(10)
    v_mfma_f32_16x16x32_bf16 v[16:19], v[48:51], v[128:131], v[16:19]
    buffer_load_dwordx4 v[112:115], v2, s[40:43], s72 offen offset:0 sc1
    ds_read_b64_tr_b16 v[76:77], v7 offset:28672
    v_mfma_f32_16x16x32_bf16 v[32:35], v[48:51], v[132:135], v[32:35]
    v_add_u32 v5, s74, v9
    ds_read_b64_tr_b16 v[78:79], v7 offset:30720
    v_mfma_f32_16x16x32_bf16 v[20:23], v[52:55], v[128:131], v[20:23]
    s_barrier
    ds_read_b64_tr_b16 v[48:49], v4 offset:0
    v_mfma_f32_16x16x32_bf16 v[36:39], v[52:55], v[132:135], v[36:39]
    ds_read_b64_tr_b16 v[50:51], v4 offset:2048
    s_waitcnt lgkmcnt(10)
    v_mfma_f32_16x16x32_bf16 v[24:27], v[56:59], v[128:131], v[24:27]
    buffer_load_dwordx4 v[116:119], v2, s[40:43], s72 offen offset:1024 sc1
    ds_read_b64_tr_b16 v[52:53], v5 offset:0
    v_mfma_f32_16x16x32_bf16 v[40:43], v[56:59], v[132:135], v[40:43]
    v_add_u32 v6, s74, v10
    ds_read_b64_tr_b16 v[54:55], v5 offset:2048
    v_mfma_f32_16x16x32_bf16 v[28:31], v[60:63], v[128:131], v[28:31]
    v_add_u32 v7, s74, v11
    ds_read_b64_tr_b16 v[56:57], v6 offset:0
    v_mfma_f32_16x16x32_bf16 v[44:47], v[60:63], v[132:135], v[44:47]
    ds_read_b64_tr_b16 v[58:59], v6 offset:2048
    s_waitcnt vmcnt(10) lgkmcnt(10)
    v_mfma_f32_16x16x32_bf16 v[16:19], v[64:67], v[136:139], v[16:19]
    buffer_load_dwordx4 v[120:123], v2, s[40:43], s72 offen offset:2048 sc1
    ds_read_b64_tr_b16 v[60:61], v7 offset:0
    v_mfma_f32_16x16x32_bf16 v[32:35], v[64:67], v[140:143], v[32:35]
    ds_read_b64_tr_b16 v[62:63], v7 offset:2048
    v_mfma_f32_16x16x32_bf16 v[20:23], v[68:71], v[136:139], v[20:23]
    s_sub_u32 s73, s73, 1
    ds_read_b64_tr_b16 v[64:65], v4 offset:4096
    v_mfma_f32_16x16x32_bf16 v[36:39], v[68:71], v[140:143], v[36:39]
    ds_read_b64_tr_b16 v[66:67], v4 offset:6144
    s_waitcnt lgkmcnt(10)
    v_mfma_f32_16x16x32_bf16 v[24:27], v[72:75], v[136:139], v[24:27]
    buffer_load_dwordx4 v[124:127], v2, s[40:43], s72 offen offset:3072 sc1
    ds_read_b64_tr_b16 v[68:69], v5 offset:4096
    v_mfma_f32_16x16x32_bf16 v[40:43], v[72:75], v[140:143], v[40:43]
    s_add_u32 s72, s72, 4096
    ds_read_b64_tr_b16 v[70:71], v5 offset:6144
    v_mfma_f32_16x16x32_bf16 v[28:31], v[76:79], v[136:139], v[28:31]
    s_cmp_eq_u32 s72, 114688
    s_cselect_b32 s72, 0, s72
    ds_read_b64_tr_b16 v[72:73], v6 offset:4096
    v_mfma_f32_16x16x32_bf16 v[44:47], v[76:79], v[140:143], v[44:47]
    ds_read_b64_tr_b16 v[74:75], v6 offset:6144
    s_cmp_lg_u32 s73, 0
    s_cbranch_scc1 L_mainc_ul
    s_waitcnt vmcnt(10) lgkmcnt(10)
    v_mfma_f32_16x16x32_bf16 v[16:19], v[48:51], v[80:83], v[16:19]
    buffer_load_dwordx4 v[128:131], v2, s[40:43], s72 offen offset:0 sc1
    ds_read_b64_tr_b16 v[76:77], v7 offset:4096
    v_mfma_f32_16x16x32_bf16 v[32:35], v[48:51], v[84:87], v[32:35]
    ds_read_b64_tr_b16 v[78:79], v7 offset:6144
    v_mfma_f32_16x16x32_bf16 v[20:23], v[52:55], v[80:83], v[20:23]
    ds_read_b64_tr_b16 v[48:49], v4 offset:8192
    v_mfma_f32_16x16x32_bf16 v[36:39], v[52:55], v[84:87], v[36:39]
    ds_read_b64_tr_b16 v[50:51], v4 offset:10240
    s_waitcnt lgkmcnt(10)
    v_mfma_f32_16x16x32_bf16 v[24:27], v[56:59], v[80:83], v[24:27]
    buffer_load_dwordx4 v[132:135], v2, s[40:43], s72 offen offset:1024 sc1
    ds_read_b64_tr_b16 v[52:53], v5 offset:8192
    v_mfma_f32_16x16x32_bf16 v[40:43], v[56:59], v[84:87], v[40:43]
    ds_read_b64_tr_b16 v[54:55], v5 offset:10240
    v_mfma_f32_16x16x32_bf16 v[28:31], v[60:63], v[80:83], v[28:31]
    ds_read_b64_tr_b16 v[56:57], v6 offset:8192
    v_mfma_f32_16x16x32_bf16 v[44:47], v[60:63], v[84:87], v[44:47]
    ds_read_b64_tr_b16 v[58:59], v6 offset:10240
    s_waitcnt vmcnt(10) lgkmcnt(10)
    v_mfma_f32_16x16x32_bf16 v[16:19], v[64:67], v[88:91], v[16:19]
    buffer_load_dwordx4 v[136:139], v2, s[40:43], s72 offen offset:2048 sc1
    ds_read_b64_tr_b16 v[60:61], v7 offset:8192
    v_mfma_f32_16x16x32_bf16 v[32:35], v[64:67], v[92:95], v[32:35]
    ds_read_b64_tr_b16 v[62:63], v7 offset:10240
    v_mfma_f32_16x16x32_bf16 v[20:23], v[68:71], v[88:91], v[20:23]
    ds_read_b64_tr_b16 v[64:65], v4 offset:12288
    v_mfma_f32_16x16x32_bf16 v[36:39], v[68:71], v[92:95], v[36:39]
    ds_read_b64_tr_b16 v[66:67], v4 offset:14336
    s_waitcnt lgkmcnt(10)
    v_mfma_f32_16x16x32_bf16 v[24:27], v[72:75], v[88:91], v[24:27]
    buffer_load_dwordx4 v[140:143], v2, s[40:43], s72 offen offset:3072 sc1
    ds_read_b64_tr_b16 v[68:69], v5 offset:12288
    v_mfma_f32_16x16x32_bf16 v[40:43], v[72:75], v[92:95], v[40:43]
    s_add_u32 s72, s72, 4096
    ds_read_b64_tr_b16 v[70:71], v5 offset:14336
    v_mfma_f32_16x16x32_bf16 v[28:31], v[76:79], v[88:91], v[28:31]
    s_cmp_eq_u32 s72, 114688
    s_cselect_b32 s72, 0, s72
    ds_read_b64_tr_b16 v[72:73], v6 offset:12288
    v_mfma_f32_16x16x32_bf16 v[44:47], v[76:79], v[92:95], v[44:47]
    ds_read_b64_tr_b16 v[74:75], v6 offset:14336
    s_waitcnt vmcnt(10) lgkmcnt(10)
    v_mfma_f32_16x16x32_bf16 v[16:19], v[48:51], v[96:99], v[16:19]
    ds_read_b64_tr_b16 v[76:77], v7 offset:12288
    v_mfma_f32_16x16x32_bf16 v[32:35], v[48:51], v[100:103], v[32:35]
    ds_read_b64_tr_b16 v[78:79], v7 offset:14336
    v_mfma_f32_16x16x32_bf16 v[20:23], v[52:55], v[96:99], v[20:23]
    ds_read_b64_tr_b16 v[48:49], v4 offset:16384
    v_mfma_f32_16x16x32_bf16 v[36:39], v[52:55], v[100:103], v[36:39]
    ds_read_b64_tr_b16 v[50:51], v4 offset:18432
    s_waitcnt lgkmcnt(10)
    v_mfma_f32_16x16x32_bf16 v[24:27], v[56:59], v[96:99], v[24:27]
    ds_read_b64_tr_b16 v[52:53], v5 offset:16384
    v_mfma_f32_16x16x32_bf16 v[40:43], v[56:59], v[100:103], v[40:43]
    ds_read_b64_tr_b16 v[54:55], v5 offset:18432
    v_mfma_f32_16x16x32_bf16 v[28:31], v[60:63], v[96:99], v[28:31]
    ds_read_b64_tr_b16 v[56:57], v6 offset:16384
    v_mfma_f32_16x16x32_bf16 v[44:47], v[60:63], v[100:103], v[44:47]
    ds_read_b64_tr_b16 v[58:59], v6 offset:18432
    s_waitcnt vmcnt(8) lgkmcnt(10)
    v_mfma_f32_16x16x32_bf16 v[16:19], v[64:67], v[104:107], v[16:19]
    ds_read_b64_tr_b16 v[60:61], v7 offset:16384
    v_mfma_f32_16x16x32_bf16 v[32:35], v[64:67], v[108:111], v[32:35]
    ds_read_b64_tr_b16 v[62:63], v7 offset:18432
    v_mfma_f32_16x16x32_bf16 v[20:23], v[68:71], v[104:107], v[20:23]
    ds_read_b64_tr_b16 v[64:65], v4 offset:20480
    v_mfma_f32_16x16x32_bf16 v[36:39], v[68:71], v[108:111], v[36:39]
    ds_read_b64_tr_b16 v[66:67], v4 offset:22528
    s_waitcnt lgkmcnt(10)
    v_mfma_f32_16x16x32_bf16 v[24:27], v[72:75], v[104:107], v[24:27]
    ds_read_b64_tr_b16 v[68:69], v5 offset:20480
    v_mfma_f32_16x16x32_bf16 v[40:43], v[72:75], v[108:111], v[40:43]
    ds_read_b64_tr_b16 v[70:71], v5 offset:22528
    v_mfma_f32_16x16x32_bf16 v[28:31], v[76:79], v[104:107], v[28:31]
    ds_read_b64_tr_b16 v[72:73], v6 offset:20480
    v_mfma_f32_16x16x32_bf16 v[44:47], v[76:79], v[108:111], v[44:47]
    ds_read_b64_tr_b16 v[74:75], v6 offset:22528
    s_waitcnt vmcnt(6) lgkmcnt(10)
    v_mfma_f32_16x16x32_bf16 v[16:19], v[48:51], v[112:115], v[16:19]
    ds_read_b64_tr_b16 v[76:77], v7 offset:20480
    v_mfma_f32_16x16x32_bf16 v[32:35], v[48:51], v[116:119], v[32:35]
    ds_read_b64_tr_b16 v[78:79], v7 offset:22528
    v_mfma_f32_16x16x32_bf16 v[20:23], v[52:55], v[112:115], v[20:23]
    ds_read_b64_tr_b16 v[48:49], v4 offset:24576
    v_mfma_f32_16x16x32_bf16 v[36:39], v[52:55], v[116:119], v[36:39]
    ds_read_b64_tr_b16 v[50:51], v4 offset:26624
    s_waitcnt lgkmcnt(10)
    v_mfma_f32_16x16x32_bf16 v[24:27], v[56:59], v[112:115], v[24:27]
    ds_read_b64_tr_b16 v[52:53], v5 offset:24576
    v_mfma_f32_16x16x32_bf16 v[40:43], v[56:59], v[116:119], v[40:43]
    ds_read_b64_tr_b16 v[54:55], v5 offset:26624
    v_mfma_f32_16x16x32_bf16 v[28:31], v[60:63], v[112:115], v[28:31]
    ds_read_b64_tr_b16 v[56:57], v6 offset:24576
    v_mfma_f32_16x16x32_bf16 v[44:47], v[60:63], v[116:119], v[44:47]
    ds_read_b64_tr_b16 v[58:59], v6 offset:26624
    s_waitcnt vmcnt(4) lgkmcnt(10)
    v_mfma_f32_16x16x32_bf16 v[16:19], v[64:67], v[120:123], v[16:19]
    ds_read_b64_tr_b16 v[60:61], v7 offset:24576
    v_mfma_f32_16x16x32_bf16 v[32:35], v[64:67], v[124:127], v[32:35]
    ds_read_b64_tr_b16 v[62:63], v7 offset:26624
    v_mfma_f32_16x16x32_bf16 v[20:23], v[68:71], v[120:123], v[20:23]
    ds_read_b64_tr_b16 v[64:65], v4 offset:28672
    v_mfma_f32_16x16x32_bf16 v[36:39], v[68:71], v[124:127], v[36:39]
    ds_read_b64_tr_b16 v[66:67], v4 offset:30720
    s_waitcnt lgkmcnt(10)
    v_mfma_f32_16x16x32_bf16 v[24:27], v[72:75], v[120:123], v[24:27]
    ds_read_b64_tr_b16 v[68:69], v5 offset:28672
    v_mfma_f32_16x16x32_bf16 v[40:43], v[72:75], v[124:127], v[40:43]
    ds_read_b64_tr_b16 v[70:71], v5 offset:30720
    v_mfma_f32_16x16x32_bf16 v[28:31], v[76:79], v[120:123], v[28:31]
    ds_read_b64_tr_b16 v[72:73], v6 offset:28672
    v_mfma_f32_16x16x32_bf16 v[44:47], v[76:79], v[124:127], v[44:47]
    ds_read_b64_tr_b16 v[74:75], v6 offset:30720
    s_waitcnt vmcnt(2) lgkmcnt(10)
    v_mfma_f32_16x16x32_bf16 v[16:19], v[48:51], v[128:131], v[16:19]
    ds_read_b64_tr_b16 v[76:77], v7 offset:28672
    v_mfma_f32_16x16x32_bf16 v[32:35], v[48:51], v[132:135], v[32:35]
    ds_read_b64_tr_b16 v[78:79], v7 offset:30720
    v_mfma_f32_16x16x32_bf16 v[20:23], v[52:55], v[128:131], v[20:23]
    v_mfma_f32_16x16x32_bf16 v[36:39], v[52:55], v[132:135], v[36:39]
    s_waitcnt lgkmcnt(8)
    v_mfma_f32_16x16x32_bf16 v[24:27], v[56:59], v[128:131], v[24:27]
    v_mfma_f32_16x16x32_bf16 v[40:43], v[56:59], v[132:135], v[40:43]
    v_mfma_f32_16x16x32_bf16 v[28:31], v[60:63], v[128:131], v[28:31]
    v_mfma_f32_16x16x32_bf16 v[44:47], v[60:63], v[132:135], v[44:47]
    s_waitcnt vmcnt(0) lgkmcnt(4)
    v_mfma_f32_16x16x32_bf16 v[16:19], v[64:67], v[136:139], v[16:19]
    v_mfma_f32_16x16x32_bf16 v[32:35], v[64:67], v[140:143], v[32:35]
    v_mfma_f32_16x16x32_bf16 v[20:23], v[68:71], v[136:139], v[20:23]
    v_mfma_f32_16x16x32_bf16 v[36:39], v[68:71], v[140:143], v[36:39]
    s_waitcnt lgkmcnt(0)
    v_mfma_f32_16x16x32_bf16 v[24:27], v[72:75], v[136:139], v[24:27]
    v_mfma_f32_16x16x32_bf16 v[40:43], v[72:75], v[140:143], v[40:43]
    v_mfma_f32_16x16x32_bf16 v[28:31], v[76:79], v[136:139], v[28:31]
    v_mfma_f32_16x16x32_bf16 v[44:47], v[76:79], v[140:143], v[44:47]
    s_nop 1
    v_pk_fma_f32 v[16:17], v[16:17], v[176:177], v[192:193]
    v_pk_fma_f32 v[18:19], v[18:19], v[178:179], v[194:195]
    v_cvt_pk_bf16_f32 v112, v16, v17
    v_cvt_pk_bf16_f32 v113, v18, v19
    v_pk_fma_f32 v[20:21], v[20:21], v[180:181], v[196:197]
    v_pk_fma_f32 v[22:23], v[22:23], v[182:183], v[198:199]
    v_cvt_pk_bf16_f32 v114, v20, v21
    v_cvt_pk_bf16_f32 v115, v22, v23
    v_pk_fma_f32 v[24:25], v[24:25], v[184:185], v[200:201]
    v_pk_fma_f32 v[26:27], v[26:27], v[186:187], v[202:203]
    v_cvt_pk_bf16_f32 v116, v24, v25
    v_cvt_pk_bf16_f32 v117, v26, v27
    v_pk_fma_f32 v[28:29], v[28:29], v[188:189], v[204:205]
    v_pk_fma_f32 v[30:31], v[30:31], v[190:191], v[206:207]
    v_cvt_pk_bf16_f32 v118, v28, v29
    v_cvt_pk_bf16_f32 v119, v30, v31
    ds_write_b64 v224, v[112:113] offset:0
    ds_write_b64 v225, v[114:115] offset:0
    ds_write_b64 v226, v[116:117] offset:0
    ds_write_b64 v227, v[118:119] offset:0
    ds_read_b128 v[80:83], v230 offset:0
    ds_read_b128 v[84:87], v230 offset:1024
    v_pk_fma_f32 v[32:33], v[32:33], v[176:177], v[208:209]
    v_pk_fma_f32 v[34:35], v[34:35], v[178:179], v[210:211]
    v_cvt_pk_bf16_f32 v120, v32, v33
    v_cvt_pk_bf16_f32 v121, v34, v35
    v_pk_fma_f32 v[36:37], v[36:37], v[180:181], v[212:213]
    v_pk_fma_f32 v[38:39], v[38:39], v[182:183], v[214:215]
    v_cvt_pk_bf16_f32 v122, v36, v37
    v_cvt_pk_bf16_f32 v123, v38, v39
    v_pk_fma_f32 v[40:41], v[40:41], v[184:185], v[216:217]
    v_pk_fma_f32 v[42:43], v[42:43], v[186:187], v[218:219]
    v_cvt_pk_bf16_f32 v124, v40, v41
    v_cvt_pk_bf16_f32 v125, v42, v43
    v_pk_fma_f32 v[44:45], v[44:45], v[188:189], v[220:221]
    v_pk_fma_f32 v[46:47], v[46:47], v[190:191], v[222:223]
    v_cvt_pk_bf16_f32 v126, v44, v45
    v_cvt_pk_bf16_f32 v127, v46, v47
    ds_write_b64 v224, v[120:121] offset:2048
    ds_write_b64 v225, v[122:123] offset:2048
    ds_write_b64 v226, v[124:125] offset:2048
    ds_write_b64 v227, v[126:127] offset:2048
    ds_read_b128 v[88:91], v230 offset:2048
    ds_read_b128 v[92:95], v230 offset:3072
    s_waitcnt lgkmcnt(7)
    buffer_store_dwordx4 v[80:83], v228, s[44:47], s80 offen sc1
    s_add_u32 s80, s80, 16384
    s_waitcnt lgkmcnt(6)
    buffer_store_dwordx4 v[84:87], v229, s[44:47], s80 offen sc1
    s_add_u32 s80, s80, 16384
    s_waitcnt lgkmcnt(1)
    buffer_store_dwordx4 v[88:91], v228, s[44:47], s80 offen sc1
    s_add_u32 s80, s80, 16384
    s_waitcnt lgkmcnt(0)
    buffer_store_dwordx4 v[92:95], v229, s[44:47], s80 offen sc1
    s_add_u32 s80, s80, 16384
L_main_end:
L_main_exit:
    s_endpgm
.section .rodata,"a"
.p2align 6
.amdhsa_kernel adaLN_cond__grouped_kv_mqa__mixer_gmlp__prompt_kernel
  .amdhsa_next_free_vgpr 256
  .amdhsa_next_free_sgpr 102
  .amdhsa_accum_offset 256
  .amdhsa_group_segment_fixed_size 0
  .amdhsa_kernarg_size 120
  .amdhsa_user_sgpr_count 2
  .amdhsa_user_sgpr_kernarg_segment_ptr 1
  .amdhsa_system_sgpr_workgroup_id_x 1
.end_amdhsa_kernel
```
